```python
import torch

def _softmax(x, axis=-1):
    return torch.softmax(x, dim=axis)
def _gelu(x):
    return torch.nn.functional.gelu(x, approximate="tanh")
def _silu(x):
    return torch.nn.functional.silu(x)
def _sigmoid(x):
    return torch.sigmoid(x)
def _layernorm(x, axis=-1, eps=1e-5):
    m = x.mean(dim=axis, keepdim=True)
    v = x.var(dim=axis, keepdim=True, unbiased=False)
    return (x - m) / torch.sqrt(v + eps)
def _scatter_add(tgt, idx, src, axis=0):
    return tgt.clone().index_add_(axis, idx, src)
def _segment_sum(src, seg, n):
    out = torch.zeros((n,) + src.shape[1:], dtype=src.dtype)
    return out.index_add_(0, seg, src)
def _pad(x, pw):
    flat = tuple(v for pair in reversed(pw) for v in pair)
    return torch.nn.functional.pad(x, flat)

kernel_name = 'standalone__gqa_block_cached__sampling'

def setup_inputs():

    _w = (lambda a: (lambda t: t.to(torch.bfloat16) if t.is_floating_point() else t)(torch.as_tensor(a)))
    B, Sq, D = 32, 32, 1024
    Hq, Hkv, Sk, Dh = 32, 4, 2048, 128
    assert Hq % Hkv == 0, (Hq, Hkv)
    return {
        "x": _w((lambda *s: torch.randn(*s, dtype=torch.bfloat16) * 0.8)(B, Sq, D)),
        "k_cache": _w((lambda *s: torch.randn(*s, dtype=torch.bfloat16) * 0.8)(B, Hkv, Sk, Dh)),
        "v_cache": _w((lambda *s: torch.randn(*s, dtype=torch.bfloat16) * 0.05)(B, Hkv, Sk, Dh)),
        "wq": _w((lambda *s: torch.randn(*s, dtype=torch.bfloat16) * 0.8)(D, Hq * Dh) * (D ** -0.5)),
        "wo": _w((lambda *s: torch.randn(*s, dtype=torch.bfloat16) * 0.05)(Hq * Dh, D) * ((Hq * Dh) ** -0.5)),
    }

def reference(x, k_cache, v_cache, wq, wo):
    B, Sq, D = x.shape
    Hq, Dh = 32, 128
    Hkv = k_cache.shape[1]
    rep = Hq // Hkv
    q = (lambda x, *d: x.permute(*d))((x @ wq).reshape(B, Sq, Hq, Dh), 0, 2, 1, 3)
    k = (lambda x, n, axis: torch.repeat_interleave(x, n, dim=axis))(k_cache, rep, axis=1)
    v = (lambda x, n, axis: torch.repeat_interleave(x, n, dim=axis))(v_cache, rep, axis=1)
    scores = torch.einsum("bhqd,bhkd->bhqk", q, k) * (Dh ** -0.5)
    p = _softmax(scores, axis=-1)
    o = torch.einsum("bhqk,bhkd->bhqd", p, v)
    return (lambda x, *d: x.permute(*d))(o, 0, 2, 1, 3).reshape(B, Sq, Hq * Dh) @ wo
```

```asm
; @launch kernel=gqa_attn_kernel grid=(256,1,1) block=(512,1,1) lds=163840
; @launch kernel=gqa_oproj_kernel grid=(256,1,1) block=(256,1,1) lds=131072
.amdgcn_target "amdgcn-amd-amdhsa--gfx950"
.text
.globl gqa_attn_kernel
.p2align 8
.type gqa_attn_kernel,@function
gqa_attn_kernel:
    s_cmp_ge_u32 s2, 256
    s_cbranch_scc1 L_gqa_attn_kernel_end
    s_load_dwordx2 s[4:5], s[0:1], 8
    s_load_dwordx2 s[6:7], s[0:1], 16
    s_load_dwordx2 s[30:31], s[0:1], 56
    s_load_dwordx2 s[40:41], s[0:1], 0
    s_load_dwordx2 s[42:43], s[0:1], 24
    v_and_b32 v1, 63, v0
    v_lshrrev_b32 v2, 6, v0
    s_nop 0
    v_readfirstlane_b32 s29, v2
    s_and_b32 s33, s2, 127
    s_lshr_b32 s34, s2, 7
    s_lshl_b32 s35, s33, 19
    s_waitcnt lgkmcnt(0)
    s_add_u32 s8, s4, s35
    s_addc_u32 s9, s5, 0
    s_and_b32 s9, s9, 0xffff
    s_mov_b32 s10, 0x80000
    s_mov_b32 s11, 0x00020000
    s_add_u32 s12, s6, s35
    s_addc_u32 s13, s7, 0
    s_and_b32 s13, s13, 0xffff
    s_mov_b32 s14, 0x80000
    s_mov_b32 s15, 0x00020000
    s_mov_b32 s16, s40
    s_and_b32 s17, s41, 0xffff
    s_mov_b32 s18, 2097152
    s_mov_b32 s19, 0x00020000
    s_add_u32 s20, s30, 8388608
    s_addc_u32 s21, s31, 0
    s_and_b32 s21, s21, 0xffff
    s_mov_b32 s22, 8388608
    s_mov_b32 s23, 0x00020000
    s_mov_b32 s44, s42
    s_and_b32 s45, s43, 0xffff
    s_mov_b32 s46, 8388608
    s_mov_b32 s47, 0x00020000
    s_mov_b32 s24, 0x3e0293ee
    s_mov_b32 s25, 0x43800000
    s_and_b32 s37, s33, 3
    s_lshl_b32 s37, s37, 3
    s_lshl_b32 s38, s34, 2
    s_add_u32 s37, s37, s38
    s_lshl_b32 s48, s37, 8
    s_and_b32 s38, s29, 3
    s_add_u32 s37, s37, s38
    s_lshl_b32 s37, s37, 8
    s_lshr_b32 s38, s33, 2
    s_lshl_b32 s49, s38, 16
    s_lshl_b32 s38, s38, 18
    s_add_u32 s32, s37, s38
    v_and_b32 v2, 31, v1
    v_lshlrev_b32 v2, 13, v2
    v_lshrrev_b32 v3, 5, v1
    v_lshlrev_b32 v3, 4, v3
    v_add_u32 v255, v2, v3
    v_lshrrev_b32 v2, 4, v1
    s_lshl_b32 s37, s29, 2
    v_add_u32 v3, s37, v2
    v_and_b32 v3, 15, v3
    v_and_b32 v4, 15, v1
    v_xor_b32 v3, v3, v4
    v_lshlrev_b32 v3, 4, v3
    v_lshlrev_b32 v5, 8, v2
    v_add_u32 v244, v5, v3
    v_lshlrev_b32 v3, 2, v2
    v_xor_b32 v3, v3, v4
    v_lshlrev_b32 v3, 4, v3
    v_add_u32 v245, v5, v3
    s_and_b32 s37, s29, 3
    s_lshl_b32 s37, s37, 2
    v_xor_b32 v2, s37, v1
    v_lshlrev_b32 v172, 4, v2
    s_mul_i32 s37, s29, 8192
    s_add_u32 s48, s48, s37
    s_lshr_b32 s50, s33, 3
    s_and_b32 s50, s50, 7
    s_lshl_b32 s51, s50, 20
    s_lshl_b32 s50, s50, 8
    s_lshl_b32 s37, s29, 13
    s_add_u32 s49, s49, s37
    v_lshrrev_b32 v2, 4, v1
    v_lshlrev_b32 v3, 8, v2
    v_sub_u32 v4, v244, v3
    v_lshlrev_b32 v3, 11, v2
    v_add_u32 v173, v3, v4
    v_and_b32 v2, 15, v1
    v_lshrrev_b32 v3, 2, v2
    v_lshrrev_b32 v4, 5, v1
    v_lshlrev_b32 v4, 3, v4
    v_add_u32 v4, v4, v3
    v_lshlrev_b32 v4, 10, v4
    s_and_b32 s37, s29, 3
    s_lshl_b32 s37, s37, 2
    s_lshr_b32 s38, s29, 2
    s_lshl_b32 s38, s38, 1
    s_add_u32 s37, s37, s38
    v_xor_b32 v5, s37, v3
    v_lshlrev_b32 v5, 6, v5
    v_add_u32 v4, v4, v5
    v_lshrrev_b32 v5, 4, v1
    v_and_b32 v5, 1, v5
    v_lshlrev_b32 v5, 5, v5
    v_add_u32 v4, v4, v5
    v_and_b32 v5, 3, v1
    v_lshlrev_b32 v5, 3, v5
    v_add_u32 v168, v4, v5
    v_xor_b32 v169, 64, v168
    v_and_b32 v2, 31, v1
    v_lshrrev_b32 v3, 5, v1
    v_and_b32 v4, 15, v2
    v_xor_b32 v4, v4, v3
    v_lshlrev_b32 v4, 4, v4
    v_lshlrev_b32 v5, 8, v2
    v_add_u32 v170, v5, v4
    v_add_u32 v170, 131072, v170
    v_mov_b32 v104, 0
    v_mov_b32 v105, 0
    v_mov_b32 v106, 0
    v_mov_b32 v107, 0
    v_mov_b32 v108, 0
    v_mov_b32 v109, 0
    v_mov_b32 v110, 0
    v_mov_b32 v111, 0
    v_mov_b32 v112, 0
    v_mov_b32 v113, 0
    v_mov_b32 v114, 0
    v_mov_b32 v115, 0
    v_mov_b32 v116, 0
    v_mov_b32 v117, 0
    v_mov_b32 v118, 0
    v_mov_b32 v119, 0
    v_mov_b32 v120, 0
    v_mov_b32 v121, 0
    v_mov_b32 v122, 0
    v_mov_b32 v123, 0
    v_mov_b32 v124, 0
    v_mov_b32 v125, 0
    v_mov_b32 v126, 0
    v_mov_b32 v127, 0
    v_mov_b32 v128, 0
    v_mov_b32 v129, 0
    v_mov_b32 v130, 0
    v_mov_b32 v131, 0
    v_mov_b32 v132, 0
    v_mov_b32 v133, 0
    v_mov_b32 v134, 0
    v_mov_b32 v135, 0
    s_lshl_b32 s26, s29, 10
    s_sub_u32 s26, s26, 16384
    s_lshl_b32 s37, s29, 10
    s_add_u32 s37, s37, 131072
    s_mov_b32 m0, s37
    s_add_u32 s38, s49, s50
    buffer_load_dwordx4 v173, s[16:19], s38 offen lds
    s_add_u32 s50, s50, 256
    s_and_b32 s50, s50, 0x7ff
    s_lshl_b32 s37, s29, 10
    s_add_u32 s37, s37, 139264
    s_mov_b32 m0, s37
    s_add_u32 s38, s49, s50
    buffer_load_dwordx4 v173, s[16:19], s38 offen lds
    s_add_u32 s50, s50, 256
    s_and_b32 s50, s50, 0x7ff
    s_lshl_b32 s37, s29, 10
    s_add_u32 s37, s37, 0
    s_mov_b32 m0, s37
    s_add_u32 s38, s48, 0
    s_add_u32 s38, s38, s51
    buffer_load_dwordx4 v172, s[44:47], s38 offen lds
    s_lshl_b32 s37, s29, 10
    s_add_u32 s37, s37, 8192
    s_mov_b32 m0, s37
    s_add_u32 s38, s48, 65536
    s_add_u32 s38, s38, s51
    buffer_load_dwordx4 v172, s[44:47], s38 offen lds
    s_lshl_b32 s37, s29, 10
    s_add_u32 s37, s37, 16384
    s_mov_b32 m0, s37
    s_add_u32 s38, s48, 131072
    s_add_u32 s38, s38, s51
    buffer_load_dwordx4 v172, s[44:47], s38 offen lds
    s_lshl_b32 s37, s29, 10
    s_add_u32 s37, s37, 24576
    s_mov_b32 m0, s37
    s_add_u32 s38, s48, 196608
    s_add_u32 s38, s38, s51
    buffer_load_dwordx4 v172, s[44:47], s38 offen lds
    s_add_u32 s51, s51, 262144
    s_and_b32 s51, s51, 0x7fffff
    s_lshl_b32 s37, s29, 10
    s_add_u32 s37, s37, 32768
    s_mov_b32 m0, s37
    s_add_u32 s38, s48, 0
    s_add_u32 s38, s38, s51
    buffer_load_dwordx4 v172, s[44:47], s38 offen lds
    s_lshl_b32 s37, s29, 10
    s_add_u32 s37, s37, 40960
    s_mov_b32 m0, s37
    s_add_u32 s38, s48, 65536
    s_add_u32 s38, s38, s51
    buffer_load_dwordx4 v172, s[44:47], s38 offen lds
    s_lshl_b32 s37, s29, 10
    s_add_u32 s37, s37, 49152
    s_mov_b32 m0, s37
    s_add_u32 s38, s48, 131072
    s_add_u32 s38, s38, s51
    buffer_load_dwordx4 v172, s[44:47], s38 offen lds
    s_lshl_b32 s37, s29, 10
    s_add_u32 s37, s37, 57344
    s_mov_b32 m0, s37
    s_add_u32 s38, s48, 196608
    s_add_u32 s38, s38, s51
    buffer_load_dwordx4 v172, s[44:47], s38 offen lds
    s_add_u32 s51, s51, 262144
    s_and_b32 s51, s51, 0x7fffff
    s_lshl_b32 s37, s29, 10
    s_add_u32 s37, s37, 65536
    s_mov_b32 m0, s37
    s_add_u32 s38, s48, 0
    s_add_u32 s38, s38, s51
    buffer_load_dwordx4 v172, s[44:47], s38 offen lds
    s_lshl_b32 s37, s29, 10
    s_add_u32 s37, s37, 73728
    s_mov_b32 m0, s37
    s_add_u32 s38, s48, 65536
    s_add_u32 s38, s38, s51
    buffer_load_dwordx4 v172, s[44:47], s38 offen lds
    s_lshl_b32 s37, s29, 10
    s_add_u32 s37, s37, 81920
    s_mov_b32 m0, s37
    s_add_u32 s38, s48, 131072
    s_add_u32 s38, s38, s51
    buffer_load_dwordx4 v172, s[44:47], s38 offen lds
    s_lshl_b32 s37, s29, 10
    s_add_u32 s37, s37, 90112
    s_mov_b32 m0, s37
    s_add_u32 s38, s48, 196608
    s_add_u32 s38, s38, s51
    buffer_load_dwordx4 v172, s[44:47], s38 offen lds
    s_add_u32 s51, s51, 262144
    s_and_b32 s51, s51, 0x7fffff
    s_waitcnt lgkmcnt(0)
    s_waitcnt vmcnt(8)
    s_barrier
    s_lshl_b32 s37, s29, 10
    s_add_u32 s37, s37, 98304
    s_mov_b32 m0, s37
    s_add_u32 s38, s48, 0
    s_add_u32 s38, s38, s51
    buffer_load_dwordx4 v172, s[44:47], s38 offen lds
    s_lshl_b32 s37, s29, 10
    s_add_u32 s37, s37, 106496
    s_mov_b32 m0, s37
    s_add_u32 s38, s48, 65536
    s_add_u32 s38, s38, s51
    buffer_load_dwordx4 v172, s[44:47], s38 offen lds
    s_lshl_b32 s37, s29, 10
    s_add_u32 s37, s37, 114688
    s_mov_b32 m0, s37
    s_add_u32 s38, s48, 131072
    s_add_u32 s38, s38, s51
    buffer_load_dwordx4 v172, s[44:47], s38 offen lds
    s_lshl_b32 s37, s29, 10
    s_add_u32 s37, s37, 122880
    s_mov_b32 m0, s37
    s_add_u32 s38, s48, 196608
    s_add_u32 s38, s38, s51
    buffer_load_dwordx4 v172, s[44:47], s38 offen lds
    s_add_u32 s51, s51, 262144
    s_and_b32 s51, s51, 0x7fffff
    v_xor_b32 v171, 0, v170
    ds_read_b128 v[152:155], v171 offset:0
    ds_read_b64_tr_b16 v[136:137], v168 offset:0
    ds_read_b64_tr_b16 v[138:139], v168 offset:4096
    ds_read_b64_tr_b16 v[140:141], v169 offset:0
    ds_read_b64_tr_b16 v[142:143], v169 offset:4096
    v_xor_b32 v171, 32, v170
    ds_read_b128 v[156:159], v171 offset:0
    ds_read_b64_tr_b16 v[144:145], v168 offset:16384
    ds_read_b64_tr_b16 v[146:147], v168 offset:20480
    ds_read_b64_tr_b16 v[148:149], v169 offset:16384
    ds_read_b64_tr_b16 v[150:151], v169 offset:20480
    s_waitcnt lgkmcnt(5)
    v_mfma_f32_32x32x16_bf16 v[104:119], v[136:139], v[152:155], v[104:119]
    v_mfma_f32_32x32x16_bf16 v[120:135], v[140:143], v[152:155], v[120:135]
    s_waitcnt lgkmcnt(0)
    v_mfma_f32_32x32x16_bf16 v[104:119], v[144:147], v[156:159], v[104:119]
    v_mfma_f32_32x32x16_bf16 v[120:135], v[148:151], v[156:159], v[120:135]
    s_waitcnt lgkmcnt(0)
    s_waitcnt vmcnt(8)
    s_barrier
    s_lshl_b32 s37, s29, 10
    s_add_u32 s37, s37, 0
    s_mov_b32 m0, s37
    s_add_u32 s38, s48, 0
    s_add_u32 s38, s38, s51
    buffer_load_dwordx4 v172, s[44:47], s38 offen lds
    s_lshl_b32 s37, s29, 10
    s_add_u32 s37, s37, 8192
    s_mov_b32 m0, s37
    s_add_u32 s38, s48, 65536
    s_add_u32 s38, s38, s51
    buffer_load_dwordx4 v172, s[44:47], s38 offen lds
    s_lshl_b32 s37, s29, 10
    s_add_u32 s37, s37, 16384
    s_mov_b32 m0, s37
    s_add_u32 s38, s48, 131072
    s_add_u32 s38, s38, s51
    buffer_load_dwordx4 v172, s[44:47], s38 offen lds
    s_lshl_b32 s37, s29, 10
    s_add_u32 s37, s37, 24576
    s_mov_b32 m0, s37
    s_add_u32 s38, s48, 196608
    s_add_u32 s38, s38, s51
    buffer_load_dwordx4 v172, s[44:47], s38 offen lds
    s_add_u32 s51, s51, 262144
    s_and_b32 s51, s51, 0x7fffff
    v_xor_b32 v171, 64, v170
    ds_read_b128 v[152:155], v171 offset:0
    ds_read_b64_tr_b16 v[136:137], v168 offset:32768
    ds_read_b64_tr_b16 v[138:139], v168 offset:36864
    ds_read_b64_tr_b16 v[140:141], v169 offset:32768
    ds_read_b64_tr_b16 v[142:143], v169 offset:36864
    v_xor_b32 v171, 96, v170
    ds_read_b128 v[156:159], v171 offset:0
    ds_read_b64_tr_b16 v[144:145], v168 offset:49152
    ds_read_b64_tr_b16 v[146:147], v168 offset:53248
    ds_read_b64_tr_b16 v[148:149], v169 offset:49152
    ds_read_b64_tr_b16 v[150:151], v169 offset:53248
    s_waitcnt lgkmcnt(5)
    v_mfma_f32_32x32x16_bf16 v[104:119], v[136:139], v[152:155], v[104:119]
    v_mfma_f32_32x32x16_bf16 v[120:135], v[140:143], v[152:155], v[120:135]
    s_waitcnt lgkmcnt(0)
    v_mfma_f32_32x32x16_bf16 v[104:119], v[144:147], v[156:159], v[104:119]
    v_mfma_f32_32x32x16_bf16 v[120:135], v[148:151], v[156:159], v[120:135]
    s_waitcnt lgkmcnt(0)
    s_waitcnt vmcnt(8)
    s_barrier
    s_lshl_b32 s37, s29, 10
    s_add_u32 s37, s37, 32768
    s_mov_b32 m0, s37
    s_add_u32 s38, s48, 0
    s_add_u32 s38, s38, s51
    buffer_load_dwordx4 v172, s[44:47], s38 offen lds
    s_lshl_b32 s37, s29, 10
    s_add_u32 s37, s37, 40960
    s_mov_b32 m0, s37
    s_add_u32 s38, s48, 65536
    s_add_u32 s38, s38, s51
    buffer_load_dwordx4 v172, s[44:47], s38 offen lds
    s_lshl_b32 s37, s29, 10
    s_add_u32 s37, s37, 49152
    s_mov_b32 m0, s37
    s_add_u32 s38, s48, 131072
    s_add_u32 s38, s38, s51
    buffer_load_dwordx4 v172, s[44:47], s38 offen lds
    s_lshl_b32 s37, s29, 10
    s_add_u32 s37, s37, 57344
    s_mov_b32 m0, s37
    s_add_u32 s38, s48, 196608
    s_add_u32 s38, s38, s51
    buffer_load_dwordx4 v172, s[44:47], s38 offen lds
    s_add_u32 s51, s51, 262144
    s_and_b32 s51, s51, 0x7fffff
    v_add_u32 v168, 0x10000, v168
    v_add_u32 v169, 0x10000, v169
    v_xor_b32 v171, 128, v170
    ds_read_b128 v[152:155], v171 offset:0
    ds_read_b64_tr_b16 v[136:137], v168 offset:0
    ds_read_b64_tr_b16 v[138:139], v168 offset:4096
    ds_read_b64_tr_b16 v[140:141], v169 offset:0
    ds_read_b64_tr_b16 v[142:143], v169 offset:4096
    v_xor_b32 v171, 160, v170
    ds_read_b128 v[156:159], v171 offset:0
    ds_read_b64_tr_b16 v[144:145], v168 offset:16384
    ds_read_b64_tr_b16 v[146:147], v168 offset:20480
    ds_read_b64_tr_b16 v[148:149], v169 offset:16384
    ds_read_b64_tr_b16 v[150:151], v169 offset:20480
    s_waitcnt lgkmcnt(5)
    v_mfma_f32_32x32x16_bf16 v[104:119], v[136:139], v[152:155], v[104:119]
    v_mfma_f32_32x32x16_bf16 v[120:135], v[140:143], v[152:155], v[120:135]
    s_waitcnt lgkmcnt(0)
    v_mfma_f32_32x32x16_bf16 v[104:119], v[144:147], v[156:159], v[104:119]
    v_mfma_f32_32x32x16_bf16 v[120:135], v[148:151], v[156:159], v[120:135]
    s_waitcnt lgkmcnt(0)
    s_waitcnt vmcnt(8)
    s_barrier
    s_lshl_b32 s37, s29, 10
    s_add_u32 s37, s37, 65536
    s_mov_b32 m0, s37
    s_add_u32 s38, s48, 0
    s_add_u32 s38, s38, s51
    buffer_load_dwordx4 v172, s[44:47], s38 offen lds
    s_lshl_b32 s37, s29, 10
    s_add_u32 s37, s37, 73728
    s_mov_b32 m0, s37
    s_add_u32 s38, s48, 65536
    s_add_u32 s38, s38, s51
    buffer_load_dwordx4 v172, s[44:47], s38 offen lds
    s_lshl_b32 s37, s29, 10
    s_add_u32 s37, s37, 81920
    s_mov_b32 m0, s37
    s_add_u32 s38, s48, 131072
    s_add_u32 s38, s38, s51
    buffer_load_dwordx4 v172, s[44:47], s38 offen lds
    s_lshl_b32 s37, s29, 10
    s_add_u32 s37, s37, 90112
    s_mov_b32 m0, s37
    s_add_u32 s38, s48, 196608
    s_add_u32 s38, s38, s51
    buffer_load_dwordx4 v172, s[44:47], s38 offen lds
    s_add_u32 s51, s51, 262144
    s_and_b32 s51, s51, 0x7fffff
    v_xor_b32 v171, 192, v170
    ds_read_b128 v[152:155], v171 offset:0
    ds_read_b64_tr_b16 v[136:137], v168 offset:32768
    ds_read_b64_tr_b16 v[138:139], v168 offset:36864
    ds_read_b64_tr_b16 v[140:141], v169 offset:32768
    ds_read_b64_tr_b16 v[142:143], v169 offset:36864
    v_xor_b32 v171, 224, v170
    ds_read_b128 v[156:159], v171 offset:0
    ds_read_b64_tr_b16 v[144:145], v168 offset:49152
    ds_read_b64_tr_b16 v[146:147], v168 offset:53248
    ds_read_b64_tr_b16 v[148:149], v169 offset:49152
    ds_read_b64_tr_b16 v[150:151], v169 offset:53248
    s_waitcnt lgkmcnt(5)
    v_mfma_f32_32x32x16_bf16 v[104:119], v[136:139], v[152:155], v[104:119]
    v_mfma_f32_32x32x16_bf16 v[120:135], v[140:143], v[152:155], v[120:135]
    s_waitcnt lgkmcnt(0)
    v_mfma_f32_32x32x16_bf16 v[104:119], v[144:147], v[156:159], v[104:119]
    v_mfma_f32_32x32x16_bf16 v[120:135], v[148:151], v[156:159], v[120:135]
    s_waitcnt lgkmcnt(0)
    s_waitcnt vmcnt(8)
    s_barrier
    s_lshl_b32 s37, s29, 10
    s_add_u32 s37, s37, 98304
    s_mov_b32 m0, s37
    s_add_u32 s38, s48, 0
    s_add_u32 s38, s38, s51
    buffer_load_dwordx4 v172, s[44:47], s38 offen lds
    s_lshl_b32 s37, s29, 10
    s_add_u32 s37, s37, 106496
    s_mov_b32 m0, s37
    s_add_u32 s38, s48, 65536
    s_add_u32 s38, s38, s51
    buffer_load_dwordx4 v172, s[44:47], s38 offen lds
    s_lshl_b32 s37, s29, 10
    s_add_u32 s37, s37, 114688
    s_mov_b32 m0, s37
    s_add_u32 s38, s48, 131072
    s_add_u32 s38, s38, s51
    buffer_load_dwordx4 v172, s[44:47], s38 offen lds
    s_lshl_b32 s37, s29, 10
    s_add_u32 s37, s37, 122880
    s_mov_b32 m0, s37
    s_add_u32 s38, s48, 196608
    s_add_u32 s38, s38, s51
    buffer_load_dwordx4 v172, s[44:47], s38 offen lds
    s_add_u32 s51, s51, 262144
    s_and_b32 s51, s51, 0x7fffff
    s_lshl_b32 s37, s29, 10
    s_add_u32 s37, s37, 131072
    s_mov_b32 m0, s37
    s_add_u32 s38, s49, s50
    buffer_load_dwordx4 v173, s[16:19], s38 offen lds
    s_add_u32 s50, s50, 256
    s_and_b32 s50, s50, 0x7ff
    v_subrev_u32 v168, 0x10000, v168
    v_subrev_u32 v169, 0x10000, v169
    v_xor_b32 v171, 0, v170
    ds_read_b128 v[152:155], v171 offset:8192
    ds_read_b64_tr_b16 v[136:137], v168 offset:0
    ds_read_b64_tr_b16 v[138:139], v168 offset:4096
    ds_read_b64_tr_b16 v[140:141], v169 offset:0
    ds_read_b64_tr_b16 v[142:143], v169 offset:4096
    v_xor_b32 v171, 32, v170
    ds_read_b128 v[156:159], v171 offset:8192
    ds_read_b64_tr_b16 v[144:145], v168 offset:16384
    ds_read_b64_tr_b16 v[146:147], v168 offset:20480
    ds_read_b64_tr_b16 v[148:149], v169 offset:16384
    ds_read_b64_tr_b16 v[150:151], v169 offset:20480
    s_waitcnt lgkmcnt(5)
    v_mfma_f32_32x32x16_bf16 v[104:119], v[136:139], v[152:155], v[104:119]
    v_mfma_f32_32x32x16_bf16 v[120:135], v[140:143], v[152:155], v[120:135]
    s_waitcnt lgkmcnt(0)
    v_mfma_f32_32x32x16_bf16 v[104:119], v[144:147], v[156:159], v[104:119]
    v_mfma_f32_32x32x16_bf16 v[120:135], v[148:151], v[156:159], v[120:135]
    s_waitcnt lgkmcnt(0)
    s_waitcnt vmcnt(9)
    s_barrier
    s_lshl_b32 s37, s29, 10
    s_add_u32 s37, s37, 0
    s_mov_b32 m0, s37
    s_add_u32 s38, s48, 0
    s_add_u32 s38, s38, s51
    buffer_load_dwordx4 v172, s[44:47], s38 offen lds
    s_lshl_b32 s37, s29, 10
    s_add_u32 s37, s37, 8192
    s_mov_b32 m0, s37
    s_add_u32 s38, s48, 65536
    s_add_u32 s38, s38, s51
    buffer_load_dwordx4 v172, s[44:47], s38 offen lds
    s_lshl_b32 s37, s29, 10
    s_add_u32 s37, s37, 16384
    s_mov_b32 m0, s37
    s_add_u32 s38, s48, 131072
    s_add_u32 s38, s38, s51
    buffer_load_dwordx4 v172, s[44:47], s38 offen lds
    s_lshl_b32 s37, s29, 10
    s_add_u32 s37, s37, 24576
    s_mov_b32 m0, s37
    s_add_u32 s38, s48, 196608
    s_add_u32 s38, s38, s51
    buffer_load_dwordx4 v172, s[44:47], s38 offen lds
    s_add_u32 s51, s51, 262144
    s_and_b32 s51, s51, 0x7fffff
    v_xor_b32 v171, 64, v170
    ds_read_b128 v[152:155], v171 offset:8192
    ds_read_b64_tr_b16 v[136:137], v168 offset:32768
    ds_read_b64_tr_b16 v[138:139], v168 offset:36864
    ds_read_b64_tr_b16 v[140:141], v169 offset:32768
    ds_read_b64_tr_b16 v[142:143], v169 offset:36864
    v_xor_b32 v171, 96, v170
    ds_read_b128 v[156:159], v171 offset:8192
    ds_read_b64_tr_b16 v[144:145], v168 offset:49152
    ds_read_b64_tr_b16 v[146:147], v168 offset:53248
    ds_read_b64_tr_b16 v[148:149], v169 offset:49152
    ds_read_b64_tr_b16 v[150:151], v169 offset:53248
    s_waitcnt lgkmcnt(5)
    v_mfma_f32_32x32x16_bf16 v[104:119], v[136:139], v[152:155], v[104:119]
    v_mfma_f32_32x32x16_bf16 v[120:135], v[140:143], v[152:155], v[120:135]
    s_waitcnt lgkmcnt(0)
    v_mfma_f32_32x32x16_bf16 v[104:119], v[144:147], v[156:159], v[104:119]
    v_mfma_f32_32x32x16_bf16 v[120:135], v[148:151], v[156:159], v[120:135]
    s_waitcnt lgkmcnt(0)
    s_waitcnt vmcnt(9)
    s_barrier
    s_lshl_b32 s37, s29, 10
    s_add_u32 s37, s37, 32768
    s_mov_b32 m0, s37
    s_add_u32 s38, s48, 0
    s_add_u32 s38, s38, s51
    buffer_load_dwordx4 v172, s[44:47], s38 offen lds
    s_lshl_b32 s37, s29, 10
    s_add_u32 s37, s37, 40960
    s_mov_b32 m0, s37
    s_add_u32 s38, s48, 65536
    s_add_u32 s38, s38, s51
    buffer_load_dwordx4 v172, s[44:47], s38 offen lds
    s_lshl_b32 s37, s29, 10
    s_add_u32 s37, s37, 49152
    s_mov_b32 m0, s37
    s_add_u32 s38, s48, 131072
    s_add_u32 s38, s38, s51
    buffer_load_dwordx4 v172, s[44:47], s38 offen lds
    s_lshl_b32 s37, s29, 10
    s_add_u32 s37, s37, 57344
    s_mov_b32 m0, s37
    s_add_u32 s38, s48, 196608
    s_add_u32 s38, s38, s51
    buffer_load_dwordx4 v172, s[44:47], s38 offen lds
    s_add_u32 s51, s51, 262144
    s_and_b32 s51, s51, 0x7fffff
    v_add_u32 v168, 0x10000, v168
    v_add_u32 v169, 0x10000, v169
    v_xor_b32 v171, 128, v170
    ds_read_b128 v[152:155], v171 offset:8192
    ds_read_b64_tr_b16 v[136:137], v168 offset:0
    ds_read_b64_tr_b16 v[138:139], v168 offset:4096
    ds_read_b64_tr_b16 v[140:141], v169 offset:0
    ds_read_b64_tr_b16 v[142:143], v169 offset:4096
    v_xor_b32 v171, 160, v170
    ds_read_b128 v[156:159], v171 offset:8192
    ds_read_b64_tr_b16 v[144:145], v168 offset:16384
    ds_read_b64_tr_b16 v[146:147], v168 offset:20480
    ds_read_b64_tr_b16 v[148:149], v169 offset:16384
    ds_read_b64_tr_b16 v[150:151], v169 offset:20480
    s_waitcnt lgkmcnt(5)
    v_mfma_f32_32x32x16_bf16 v[104:119], v[136:139], v[152:155], v[104:119]
    v_mfma_f32_32x32x16_bf16 v[120:135], v[140:143], v[152:155], v[120:135]
    s_waitcnt lgkmcnt(0)
    v_mfma_f32_32x32x16_bf16 v[104:119], v[144:147], v[156:159], v[104:119]
    v_mfma_f32_32x32x16_bf16 v[120:135], v[148:151], v[156:159], v[120:135]
    s_waitcnt lgkmcnt(0)
    s_waitcnt vmcnt(9)
    s_barrier
    s_lshl_b32 s37, s29, 10
    s_add_u32 s37, s37, 65536
    s_mov_b32 m0, s37
    s_add_u32 s38, s48, 0
    s_add_u32 s38, s38, s51
    buffer_load_dwordx4 v172, s[44:47], s38 offen lds
    s_lshl_b32 s37, s29, 10
    s_add_u32 s37, s37, 73728
    s_mov_b32 m0, s37
    s_add_u32 s38, s48, 65536
    s_add_u32 s38, s38, s51
    buffer_load_dwordx4 v172, s[44:47], s38 offen lds
    s_lshl_b32 s37, s29, 10
    s_add_u32 s37, s37, 81920
    s_mov_b32 m0, s37
    s_add_u32 s38, s48, 131072
    s_add_u32 s38, s38, s51
    buffer_load_dwordx4 v172, s[44:47], s38 offen lds
    s_lshl_b32 s37, s29, 10
    s_add_u32 s37, s37, 90112
    s_mov_b32 m0, s37
    s_add_u32 s38, s48, 196608
    s_add_u32 s38, s38, s51
    buffer_load_dwordx4 v172, s[44:47], s38 offen lds
    s_add_u32 s51, s51, 262144
    s_and_b32 s51, s51, 0x7fffff
    v_xor_b32 v171, 192, v170
    ds_read_b128 v[152:155], v171 offset:8192
    ds_read_b64_tr_b16 v[136:137], v168 offset:32768
    ds_read_b64_tr_b16 v[138:139], v168 offset:36864
    ds_read_b64_tr_b16 v[140:141], v169 offset:32768
    ds_read_b64_tr_b16 v[142:143], v169 offset:36864
    v_xor_b32 v171, 224, v170
    ds_read_b128 v[156:159], v171 offset:8192
    ds_read_b64_tr_b16 v[144:145], v168 offset:49152
    ds_read_b64_tr_b16 v[146:147], v168 offset:53248
    ds_read_b64_tr_b16 v[148:149], v169 offset:49152
    ds_read_b64_tr_b16 v[150:151], v169 offset:53248
    s_waitcnt lgkmcnt(5)
    v_mfma_f32_32x32x16_bf16 v[104:119], v[136:139], v[152:155], v[104:119]
    v_mfma_f32_32x32x16_bf16 v[120:135], v[140:143], v[152:155], v[120:135]
    s_waitcnt lgkmcnt(0)
    v_mfma_f32_32x32x16_bf16 v[104:119], v[144:147], v[156:159], v[104:119]
    v_mfma_f32_32x32x16_bf16 v[120:135], v[148:151], v[156:159], v[120:135]
    s_waitcnt lgkmcnt(0)
    s_waitcnt vmcnt(8)
    s_barrier
    s_lshl_b32 s37, s29, 10
    s_add_u32 s37, s37, 98304
    s_mov_b32 m0, s37
    s_add_u32 s38, s48, 0
    s_add_u32 s38, s38, s51
    buffer_load_dwordx4 v172, s[44:47], s38 offen lds
    s_lshl_b32 s37, s29, 10
    s_add_u32 s37, s37, 106496
    s_mov_b32 m0, s37
    s_add_u32 s38, s48, 65536
    s_add_u32 s38, s38, s51
    buffer_load_dwordx4 v172, s[44:47], s38 offen lds
    s_lshl_b32 s37, s29, 10
    s_add_u32 s37, s37, 114688
    s_mov_b32 m0, s37
    s_add_u32 s38, s48, 131072
    s_add_u32 s38, s38, s51
    buffer_load_dwordx4 v172, s[44:47], s38 offen lds
    s_lshl_b32 s37, s29, 10
    s_add_u32 s37, s37, 122880
    s_mov_b32 m0, s37
    s_add_u32 s38, s48, 196608
    s_add_u32 s38, s38, s51
    buffer_load_dwordx4 v172, s[44:47], s38 offen lds
    s_add_u32 s51, s51, 262144
    s_and_b32 s51, s51, 0x7fffff
    s_lshl_b32 s37, s29, 10
    s_add_u32 s37, s37, 139264
    s_mov_b32 m0, s37
    s_add_u32 s38, s49, s50
    buffer_load_dwordx4 v173, s[16:19], s38 offen lds
    s_add_u32 s50, s50, 256
    s_and_b32 s50, s50, 0x7ff
    v_subrev_u32 v168, 0x10000, v168
    v_subrev_u32 v169, 0x10000, v169
    v_xor_b32 v171, 0, v170
    ds_read_b128 v[152:155], v171 offset:0
    ds_read_b64_tr_b16 v[136:137], v168 offset:0
    ds_read_b64_tr_b16 v[138:139], v168 offset:4096
    ds_read_b64_tr_b16 v[140:141], v169 offset:0
    ds_read_b64_tr_b16 v[142:143], v169 offset:4096
    v_xor_b32 v171, 32, v170
    ds_read_b128 v[156:159], v171 offset:0
    ds_read_b64_tr_b16 v[144:145], v168 offset:16384
    ds_read_b64_tr_b16 v[146:147], v168 offset:20480
    ds_read_b64_tr_b16 v[148:149], v169 offset:16384
    ds_read_b64_tr_b16 v[150:151], v169 offset:20480
    s_waitcnt lgkmcnt(5)
    v_mfma_f32_32x32x16_bf16 v[104:119], v[136:139], v[152:155], v[104:119]
    v_mfma_f32_32x32x16_bf16 v[120:135], v[140:143], v[152:155], v[120:135]
    s_waitcnt lgkmcnt(0)
    v_mfma_f32_32x32x16_bf16 v[104:119], v[144:147], v[156:159], v[104:119]
    v_mfma_f32_32x32x16_bf16 v[120:135], v[148:151], v[156:159], v[120:135]
    s_waitcnt lgkmcnt(0)
    s_waitcnt vmcnt(9)
    s_barrier
    s_lshl_b32 s37, s29, 10
    s_add_u32 s37, s37, 0
    s_mov_b32 m0, s37
    s_add_u32 s38, s48, 0
    s_add_u32 s38, s38, s51
    buffer_load_dwordx4 v172, s[44:47], s38 offen lds
    s_lshl_b32 s37, s29, 10
    s_add_u32 s37, s37, 8192
    s_mov_b32 m0, s37
    s_add_u32 s38, s48, 65536
    s_add_u32 s38, s38, s51
    buffer_load_dwordx4 v172, s[44:47], s38 offen lds
    s_lshl_b32 s37, s29, 10
    s_add_u32 s37, s37, 16384
    s_mov_b32 m0, s37
    s_add_u32 s38, s48, 131072
    s_add_u32 s38, s38, s51
    buffer_load_dwordx4 v172, s[44:47], s38 offen lds
    s_lshl_b32 s37, s29, 10
    s_add_u32 s37, s37, 24576
    s_mov_b32 m0, s37
    s_add_u32 s38, s48, 196608
    s_add_u32 s38, s38, s51
    buffer_load_dwordx4 v172, s[44:47], s38 offen lds
    s_add_u32 s51, s51, 262144
    s_and_b32 s51, s51, 0x7fffff
    v_xor_b32 v171, 64, v170
    ds_read_b128 v[152:155], v171 offset:0
    ds_read_b64_tr_b16 v[136:137], v168 offset:32768
    ds_read_b64_tr_b16 v[138:139], v168 offset:36864
    ds_read_b64_tr_b16 v[140:141], v169 offset:32768
    ds_read_b64_tr_b16 v[142:143], v169 offset:36864
    v_xor_b32 v171, 96, v170
    ds_read_b128 v[156:159], v171 offset:0
    ds_read_b64_tr_b16 v[144:145], v168 offset:49152
    ds_read_b64_tr_b16 v[146:147], v168 offset:53248
    ds_read_b64_tr_b16 v[148:149], v169 offset:49152
    ds_read_b64_tr_b16 v[150:151], v169 offset:53248
    s_waitcnt lgkmcnt(5)
    v_mfma_f32_32x32x16_bf16 v[104:119], v[136:139], v[152:155], v[104:119]
    v_mfma_f32_32x32x16_bf16 v[120:135], v[140:143], v[152:155], v[120:135]
    s_waitcnt lgkmcnt(0)
    v_mfma_f32_32x32x16_bf16 v[104:119], v[144:147], v[156:159], v[104:119]
    v_mfma_f32_32x32x16_bf16 v[120:135], v[148:151], v[156:159], v[120:135]
    s_waitcnt lgkmcnt(0)
    s_waitcnt vmcnt(9)
    s_barrier
    s_lshl_b32 s37, s29, 10
    s_add_u32 s37, s37, 32768
    s_mov_b32 m0, s37
    s_add_u32 s38, s48, 0
    s_add_u32 s38, s38, s51
    buffer_load_dwordx4 v172, s[44:47], s38 offen lds
    s_lshl_b32 s37, s29, 10
    s_add_u32 s37, s37, 40960
    s_mov_b32 m0, s37
    s_add_u32 s38, s48, 65536
    s_add_u32 s38, s38, s51
    buffer_load_dwordx4 v172, s[44:47], s38 offen lds
    s_lshl_b32 s37, s29, 10
    s_add_u32 s37, s37, 49152
    s_mov_b32 m0, s37
    s_add_u32 s38, s48, 131072
    s_add_u32 s38, s38, s51
    buffer_load_dwordx4 v172, s[44:47], s38 offen lds
    s_lshl_b32 s37, s29, 10
    s_add_u32 s37, s37, 57344
    s_mov_b32 m0, s37
    s_add_u32 s38, s48, 196608
    s_add_u32 s38, s38, s51
    buffer_load_dwordx4 v172, s[44:47], s38 offen lds
    s_add_u32 s51, s51, 262144
    s_and_b32 s51, s51, 0x7fffff
    v_add_u32 v168, 0x10000, v168
    v_add_u32 v169, 0x10000, v169
    v_xor_b32 v171, 128, v170
    ds_read_b128 v[152:155], v171 offset:0
    ds_read_b64_tr_b16 v[136:137], v168 offset:0
    ds_read_b64_tr_b16 v[138:139], v168 offset:4096
    ds_read_b64_tr_b16 v[140:141], v169 offset:0
    ds_read_b64_tr_b16 v[142:143], v169 offset:4096
    v_xor_b32 v171, 160, v170
    ds_read_b128 v[156:159], v171 offset:0
    ds_read_b64_tr_b16 v[144:145], v168 offset:16384
    ds_read_b64_tr_b16 v[146:147], v168 offset:20480
    ds_read_b64_tr_b16 v[148:149], v169 offset:16384
    ds_read_b64_tr_b16 v[150:151], v169 offset:20480
    s_waitcnt lgkmcnt(5)
    v_mfma_f32_32x32x16_bf16 v[104:119], v[136:139], v[152:155], v[104:119]
    v_mfma_f32_32x32x16_bf16 v[120:135], v[140:143], v[152:155], v[120:135]
    s_waitcnt lgkmcnt(0)
    v_mfma_f32_32x32x16_bf16 v[104:119], v[144:147], v[156:159], v[104:119]
    v_mfma_f32_32x32x16_bf16 v[120:135], v[148:151], v[156:159], v[120:135]
    s_waitcnt lgkmcnt(0)
    s_waitcnt vmcnt(9)
    s_barrier
    s_lshl_b32 s37, s29, 10
    s_add_u32 s37, s37, 65536
    s_mov_b32 m0, s37
    s_add_u32 s38, s48, 0
    s_add_u32 s38, s38, s51
    buffer_load_dwordx4 v172, s[44:47], s38 offen lds
    s_lshl_b32 s37, s29, 10
    s_add_u32 s37, s37, 73728
    s_mov_b32 m0, s37
    s_add_u32 s38, s48, 65536
    s_add_u32 s38, s38, s51
    buffer_load_dwordx4 v172, s[44:47], s38 offen lds
    s_lshl_b32 s37, s29, 10
    s_add_u32 s37, s37, 81920
    s_mov_b32 m0, s37
    s_add_u32 s38, s48, 131072
    s_add_u32 s38, s38, s51
    buffer_load_dwordx4 v172, s[44:47], s38 offen lds
    s_lshl_b32 s37, s29, 10
    s_add_u32 s37, s37, 90112
    s_mov_b32 m0, s37
    s_add_u32 s38, s48, 196608
    s_add_u32 s38, s38, s51
    buffer_load_dwordx4 v172, s[44:47], s38 offen lds
    s_add_u32 s51, s51, 262144
    s_and_b32 s51, s51, 0x7fffff
    v_xor_b32 v171, 192, v170
    ds_read_b128 v[152:155], v171 offset:0
    ds_read_b64_tr_b16 v[136:137], v168 offset:32768
    ds_read_b64_tr_b16 v[138:139], v168 offset:36864
    ds_read_b64_tr_b16 v[140:141], v169 offset:32768
    ds_read_b64_tr_b16 v[142:143], v169 offset:36864
    v_xor_b32 v171, 224, v170
    ds_read_b128 v[156:159], v171 offset:0
    ds_read_b64_tr_b16 v[144:145], v168 offset:49152
    ds_read_b64_tr_b16 v[146:147], v168 offset:53248
    ds_read_b64_tr_b16 v[148:149], v169 offset:49152
    ds_read_b64_tr_b16 v[150:151], v169 offset:53248
    s_waitcnt lgkmcnt(5)
    v_mfma_f32_32x32x16_bf16 v[104:119], v[136:139], v[152:155], v[104:119]
    v_mfma_f32_32x32x16_bf16 v[120:135], v[140:143], v[152:155], v[120:135]
    s_waitcnt lgkmcnt(0)
    v_mfma_f32_32x32x16_bf16 v[104:119], v[144:147], v[156:159], v[104:119]
    v_mfma_f32_32x32x16_bf16 v[120:135], v[148:151], v[156:159], v[120:135]
    s_waitcnt lgkmcnt(0)
    s_waitcnt vmcnt(8)
    s_barrier
    s_lshl_b32 s37, s29, 10
    s_add_u32 s37, s37, 98304
    s_mov_b32 m0, s37
    s_add_u32 s38, s48, 0
    s_add_u32 s38, s38, s51
    buffer_load_dwordx4 v172, s[44:47], s38 offen lds
    s_lshl_b32 s37, s29, 10
    s_add_u32 s37, s37, 106496
    s_mov_b32 m0, s37
    s_add_u32 s38, s48, 65536
    s_add_u32 s38, s38, s51
    buffer_load_dwordx4 v172, s[44:47], s38 offen lds
    s_lshl_b32 s37, s29, 10
    s_add_u32 s37, s37, 114688
    s_mov_b32 m0, s37
    s_add_u32 s38, s48, 131072
    s_add_u32 s38, s38, s51
    buffer_load_dwordx4 v172, s[44:47], s38 offen lds
    s_lshl_b32 s37, s29, 10
    s_add_u32 s37, s37, 122880
    s_mov_b32 m0, s37
    s_add_u32 s38, s48, 196608
    s_add_u32 s38, s38, s51
    buffer_load_dwordx4 v172, s[44:47], s38 offen lds
    s_add_u32 s51, s51, 262144
    s_and_b32 s51, s51, 0x7fffff
    s_lshl_b32 s37, s29, 10
    s_add_u32 s37, s37, 131072
    s_mov_b32 m0, s37
    s_add_u32 s38, s49, s50
    buffer_load_dwordx4 v173, s[16:19], s38 offen lds
    s_add_u32 s50, s50, 256
    s_and_b32 s50, s50, 0x7ff
    v_subrev_u32 v168, 0x10000, v168
    v_subrev_u32 v169, 0x10000, v169
    v_xor_b32 v171, 0, v170
    ds_read_b128 v[152:155], v171 offset:8192
    ds_read_b64_tr_b16 v[136:137], v168 offset:0
    ds_read_b64_tr_b16 v[138:139], v168 offset:4096
    ds_read_b64_tr_b16 v[140:141], v169 offset:0
    ds_read_b64_tr_b16 v[142:143], v169 offset:4096
    v_xor_b32 v171, 32, v170
    ds_read_b128 v[156:159], v171 offset:8192
    ds_read_b64_tr_b16 v[144:145], v168 offset:16384
    ds_read_b64_tr_b16 v[146:147], v168 offset:20480
    ds_read_b64_tr_b16 v[148:149], v169 offset:16384
    ds_read_b64_tr_b16 v[150:151], v169 offset:20480
    s_waitcnt lgkmcnt(5)
    v_mfma_f32_32x32x16_bf16 v[104:119], v[136:139], v[152:155], v[104:119]
    v_mfma_f32_32x32x16_bf16 v[120:135], v[140:143], v[152:155], v[120:135]
    s_waitcnt lgkmcnt(0)
    v_mfma_f32_32x32x16_bf16 v[104:119], v[144:147], v[156:159], v[104:119]
    v_mfma_f32_32x32x16_bf16 v[120:135], v[148:151], v[156:159], v[120:135]
    s_waitcnt lgkmcnt(0)
    s_waitcnt vmcnt(9)
    s_barrier
    s_lshl_b32 s37, s29, 10
    s_add_u32 s37, s37, 0
    s_mov_b32 m0, s37
    s_add_u32 s38, s48, 0
    s_add_u32 s38, s38, s51
    buffer_load_dwordx4 v172, s[44:47], s38 offen lds
    s_lshl_b32 s37, s29, 10
    s_add_u32 s37, s37, 8192
    s_mov_b32 m0, s37
    s_add_u32 s38, s48, 65536
    s_add_u32 s38, s38, s51
    buffer_load_dwordx4 v172, s[44:47], s38 offen lds
    s_lshl_b32 s37, s29, 10
    s_add_u32 s37, s37, 16384
    s_mov_b32 m0, s37
    s_add_u32 s38, s48, 131072
    s_add_u32 s38, s38, s51
    buffer_load_dwordx4 v172, s[44:47], s38 offen lds
    s_lshl_b32 s37, s29, 10
    s_add_u32 s37, s37, 24576
    s_mov_b32 m0, s37
    s_add_u32 s38, s48, 196608
    s_add_u32 s38, s38, s51
    buffer_load_dwordx4 v172, s[44:47], s38 offen lds
    s_add_u32 s51, s51, 262144
    s_and_b32 s51, s51, 0x7fffff
    v_xor_b32 v171, 64, v170
    ds_read_b128 v[152:155], v171 offset:8192
    ds_read_b64_tr_b16 v[136:137], v168 offset:32768
    ds_read_b64_tr_b16 v[138:139], v168 offset:36864
    ds_read_b64_tr_b16 v[140:141], v169 offset:32768
    ds_read_b64_tr_b16 v[142:143], v169 offset:36864
    v_xor_b32 v171, 96, v170
    ds_read_b128 v[156:159], v171 offset:8192
    ds_read_b64_tr_b16 v[144:145], v168 offset:49152
    ds_read_b64_tr_b16 v[146:147], v168 offset:53248
    ds_read_b64_tr_b16 v[148:149], v169 offset:49152
    ds_read_b64_tr_b16 v[150:151], v169 offset:53248
    s_waitcnt lgkmcnt(5)
    v_mfma_f32_32x32x16_bf16 v[104:119], v[136:139], v[152:155], v[104:119]
    v_mfma_f32_32x32x16_bf16 v[120:135], v[140:143], v[152:155], v[120:135]
    s_waitcnt lgkmcnt(0)
    v_mfma_f32_32x32x16_bf16 v[104:119], v[144:147], v[156:159], v[104:119]
    v_mfma_f32_32x32x16_bf16 v[120:135], v[148:151], v[156:159], v[120:135]
    s_waitcnt lgkmcnt(0)
    s_waitcnt vmcnt(9)
    s_barrier
    s_lshl_b32 s37, s29, 10
    s_add_u32 s37, s37, 32768
    s_mov_b32 m0, s37
    s_add_u32 s38, s48, 0
    s_add_u32 s38, s38, s51
    buffer_load_dwordx4 v172, s[44:47], s38 offen lds
    s_lshl_b32 s37, s29, 10
    s_add_u32 s37, s37, 40960
    s_mov_b32 m0, s37
    s_add_u32 s38, s48, 65536
    s_add_u32 s38, s38, s51
    buffer_load_dwordx4 v172, s[44:47], s38 offen lds
    s_lshl_b32 s37, s29, 10
    s_add_u32 s37, s37, 49152
    s_mov_b32 m0, s37
    s_add_u32 s38, s48, 131072
    s_add_u32 s38, s38, s51
    buffer_load_dwordx4 v172, s[44:47], s38 offen lds
    s_lshl_b32 s37, s29, 10
    s_add_u32 s37, s37, 57344
    s_mov_b32 m0, s37
    s_add_u32 s38, s48, 196608
    s_add_u32 s38, s38, s51
    buffer_load_dwordx4 v172, s[44:47], s38 offen lds
    s_add_u32 s51, s51, 262144
    s_and_b32 s51, s51, 0x7fffff
    v_add_u32 v168, 0x10000, v168
    v_add_u32 v169, 0x10000, v169
    v_xor_b32 v171, 128, v170
    ds_read_b128 v[152:155], v171 offset:8192
    ds_read_b64_tr_b16 v[136:137], v168 offset:0
    ds_read_b64_tr_b16 v[138:139], v168 offset:4096
    ds_read_b64_tr_b16 v[140:141], v169 offset:0
    ds_read_b64_tr_b16 v[142:143], v169 offset:4096
    v_xor_b32 v171, 160, v170
    ds_read_b128 v[156:159], v171 offset:8192
    ds_read_b64_tr_b16 v[144:145], v168 offset:16384
    ds_read_b64_tr_b16 v[146:147], v168 offset:20480
    ds_read_b64_tr_b16 v[148:149], v169 offset:16384
    ds_read_b64_tr_b16 v[150:151], v169 offset:20480
    s_waitcnt lgkmcnt(5)
    v_mfma_f32_32x32x16_bf16 v[104:119], v[136:139], v[152:155], v[104:119]
    v_mfma_f32_32x32x16_bf16 v[120:135], v[140:143], v[152:155], v[120:135]
    s_waitcnt lgkmcnt(0)
    v_mfma_f32_32x32x16_bf16 v[104:119], v[144:147], v[156:159], v[104:119]
    v_mfma_f32_32x32x16_bf16 v[120:135], v[148:151], v[156:159], v[120:135]
    s_waitcnt lgkmcnt(0)
    s_waitcnt vmcnt(9)
    s_barrier
    s_lshl_b32 s37, s29, 10
    s_add_u32 s37, s37, 65536
    s_mov_b32 m0, s37
    s_add_u32 s38, s48, 0
    s_add_u32 s38, s38, s51
    buffer_load_dwordx4 v172, s[44:47], s38 offen lds
    s_lshl_b32 s37, s29, 10
    s_add_u32 s37, s37, 73728
    s_mov_b32 m0, s37
    s_add_u32 s38, s48, 65536
    s_add_u32 s38, s38, s51
    buffer_load_dwordx4 v172, s[44:47], s38 offen lds
    s_lshl_b32 s37, s29, 10
    s_add_u32 s37, s37, 81920
    s_mov_b32 m0, s37
    s_add_u32 s38, s48, 131072
    s_add_u32 s38, s38, s51
    buffer_load_dwordx4 v172, s[44:47], s38 offen lds
    s_lshl_b32 s37, s29, 10
    s_add_u32 s37, s37, 90112
    s_mov_b32 m0, s37
    s_add_u32 s38, s48, 196608
    s_add_u32 s38, s38, s51
    buffer_load_dwordx4 v172, s[44:47], s38 offen lds
    s_add_u32 s51, s51, 262144
    s_and_b32 s51, s51, 0x7fffff
    v_xor_b32 v171, 192, v170
    ds_read_b128 v[152:155], v171 offset:8192
    ds_read_b64_tr_b16 v[136:137], v168 offset:32768
    ds_read_b64_tr_b16 v[138:139], v168 offset:36864
    ds_read_b64_tr_b16 v[140:141], v169 offset:32768
    ds_read_b64_tr_b16 v[142:143], v169 offset:36864
    v_xor_b32 v171, 224, v170
    ds_read_b128 v[156:159], v171 offset:8192
    ds_read_b64_tr_b16 v[144:145], v168 offset:49152
    ds_read_b64_tr_b16 v[146:147], v168 offset:53248
    ds_read_b64_tr_b16 v[148:149], v169 offset:49152
    ds_read_b64_tr_b16 v[150:151], v169 offset:53248
    s_waitcnt lgkmcnt(5)
    v_mfma_f32_32x32x16_bf16 v[104:119], v[136:139], v[152:155], v[104:119]
    v_mfma_f32_32x32x16_bf16 v[120:135], v[140:143], v[152:155], v[120:135]
    s_waitcnt lgkmcnt(0)
    v_mfma_f32_32x32x16_bf16 v[104:119], v[144:147], v[156:159], v[104:119]
    v_mfma_f32_32x32x16_bf16 v[120:135], v[148:151], v[156:159], v[120:135]
    s_waitcnt lgkmcnt(0)
    s_waitcnt vmcnt(8)
    s_barrier
    s_lshl_b32 s37, s29, 10
    s_add_u32 s37, s37, 98304
    s_mov_b32 m0, s37
    s_add_u32 s38, s48, 0
    s_add_u32 s38, s38, s51
    buffer_load_dwordx4 v172, s[44:47], s38 offen lds
    s_lshl_b32 s37, s29, 10
    s_add_u32 s37, s37, 106496
    s_mov_b32 m0, s37
    s_add_u32 s38, s48, 65536
    s_add_u32 s38, s38, s51
    buffer_load_dwordx4 v172, s[44:47], s38 offen lds
    s_lshl_b32 s37, s29, 10
    s_add_u32 s37, s37, 114688
    s_mov_b32 m0, s37
    s_add_u32 s38, s48, 131072
    s_add_u32 s38, s38, s51
    buffer_load_dwordx4 v172, s[44:47], s38 offen lds
    s_lshl_b32 s37, s29, 10
    s_add_u32 s37, s37, 122880
    s_mov_b32 m0, s37
    s_add_u32 s38, s48, 196608
    s_add_u32 s38, s38, s51
    buffer_load_dwordx4 v172, s[44:47], s38 offen lds
    s_add_u32 s51, s51, 262144
    s_and_b32 s51, s51, 0x7fffff
    s_lshl_b32 s37, s29, 10
    s_add_u32 s37, s37, 139264
    s_mov_b32 m0, s37
    s_add_u32 s38, s49, s50
    buffer_load_dwordx4 v173, s[16:19], s38 offen lds
    s_add_u32 s50, s50, 256
    s_and_b32 s50, s50, 0x7ff
    v_subrev_u32 v168, 0x10000, v168
    v_subrev_u32 v169, 0x10000, v169
    v_xor_b32 v171, 0, v170
    ds_read_b128 v[152:155], v171 offset:0
    ds_read_b64_tr_b16 v[136:137], v168 offset:0
    ds_read_b64_tr_b16 v[138:139], v168 offset:4096
    ds_read_b64_tr_b16 v[140:141], v169 offset:0
    ds_read_b64_tr_b16 v[142:143], v169 offset:4096
    v_xor_b32 v171, 32, v170
    ds_read_b128 v[156:159], v171 offset:0
    ds_read_b64_tr_b16 v[144:145], v168 offset:16384
    ds_read_b64_tr_b16 v[146:147], v168 offset:20480
    ds_read_b64_tr_b16 v[148:149], v169 offset:16384
    ds_read_b64_tr_b16 v[150:151], v169 offset:20480
    s_waitcnt lgkmcnt(5)
    v_mfma_f32_32x32x16_bf16 v[104:119], v[136:139], v[152:155], v[104:119]
    v_mfma_f32_32x32x16_bf16 v[120:135], v[140:143], v[152:155], v[120:135]
    s_waitcnt lgkmcnt(0)
    v_mfma_f32_32x32x16_bf16 v[104:119], v[144:147], v[156:159], v[104:119]
    v_mfma_f32_32x32x16_bf16 v[120:135], v[148:151], v[156:159], v[120:135]
    s_waitcnt lgkmcnt(0)
    s_waitcnt vmcnt(9)
    s_barrier
    s_lshl_b32 s37, s29, 10
    s_add_u32 s37, s37, 0
    s_mov_b32 m0, s37
    s_add_u32 s38, s48, 0
    s_add_u32 s38, s38, s51
    buffer_load_dwordx4 v172, s[44:47], s38 offen lds
    s_lshl_b32 s37, s29, 10
    s_add_u32 s37, s37, 8192
    s_mov_b32 m0, s37
    s_add_u32 s38, s48, 65536
    s_add_u32 s38, s38, s51
    buffer_load_dwordx4 v172, s[44:47], s38 offen lds
    s_lshl_b32 s37, s29, 10
    s_add_u32 s37, s37, 16384
    s_mov_b32 m0, s37
    s_add_u32 s38, s48, 131072
    s_add_u32 s38, s38, s51
    buffer_load_dwordx4 v172, s[44:47], s38 offen lds
    s_lshl_b32 s37, s29, 10
    s_add_u32 s37, s37, 24576
    s_mov_b32 m0, s37
    s_add_u32 s38, s48, 196608
    s_add_u32 s38, s38, s51
    buffer_load_dwordx4 v172, s[44:47], s38 offen lds
    s_add_u32 s51, s51, 262144
    s_and_b32 s51, s51, 0x7fffff
    v_xor_b32 v171, 64, v170
    ds_read_b128 v[152:155], v171 offset:0
    ds_read_b64_tr_b16 v[136:137], v168 offset:32768
    ds_read_b64_tr_b16 v[138:139], v168 offset:36864
    ds_read_b64_tr_b16 v[140:141], v169 offset:32768
    ds_read_b64_tr_b16 v[142:143], v169 offset:36864
    v_xor_b32 v171, 96, v170
    ds_read_b128 v[156:159], v171 offset:0
    ds_read_b64_tr_b16 v[144:145], v168 offset:49152
    ds_read_b64_tr_b16 v[146:147], v168 offset:53248
    ds_read_b64_tr_b16 v[148:149], v169 offset:49152
    ds_read_b64_tr_b16 v[150:151], v169 offset:53248
    s_waitcnt lgkmcnt(5)
    v_mfma_f32_32x32x16_bf16 v[104:119], v[136:139], v[152:155], v[104:119]
    v_mfma_f32_32x32x16_bf16 v[120:135], v[140:143], v[152:155], v[120:135]
    s_waitcnt lgkmcnt(0)
    v_mfma_f32_32x32x16_bf16 v[104:119], v[144:147], v[156:159], v[104:119]
    v_mfma_f32_32x32x16_bf16 v[120:135], v[148:151], v[156:159], v[120:135]
    s_waitcnt lgkmcnt(0)
    s_waitcnt vmcnt(9)
    s_barrier
    s_lshl_b32 s37, s29, 10
    s_add_u32 s37, s37, 32768
    s_mov_b32 m0, s37
    s_add_u32 s38, s48, 0
    s_add_u32 s38, s38, s51
    buffer_load_dwordx4 v172, s[44:47], s38 offen lds
    s_lshl_b32 s37, s29, 10
    s_add_u32 s37, s37, 40960
    s_mov_b32 m0, s37
    s_add_u32 s38, s48, 65536
    s_add_u32 s38, s38, s51
    buffer_load_dwordx4 v172, s[44:47], s38 offen lds
    s_lshl_b32 s37, s29, 10
    s_add_u32 s37, s37, 49152
    s_mov_b32 m0, s37
    s_add_u32 s38, s48, 131072
    s_add_u32 s38, s38, s51
    buffer_load_dwordx4 v172, s[44:47], s38 offen lds
    s_lshl_b32 s37, s29, 10
    s_add_u32 s37, s37, 57344
    s_mov_b32 m0, s37
    s_add_u32 s38, s48, 196608
    s_add_u32 s38, s38, s51
    buffer_load_dwordx4 v172, s[44:47], s38 offen lds
    s_add_u32 s51, s51, 262144
    s_and_b32 s51, s51, 0x7fffff
    v_add_u32 v168, 0x10000, v168
    v_add_u32 v169, 0x10000, v169
    v_xor_b32 v171, 128, v170
    ds_read_b128 v[152:155], v171 offset:0
    ds_read_b64_tr_b16 v[136:137], v168 offset:0
    ds_read_b64_tr_b16 v[138:139], v168 offset:4096
    ds_read_b64_tr_b16 v[140:141], v169 offset:0
    ds_read_b64_tr_b16 v[142:143], v169 offset:4096
    v_xor_b32 v171, 160, v170
    ds_read_b128 v[156:159], v171 offset:0
    ds_read_b64_tr_b16 v[144:145], v168 offset:16384
    ds_read_b64_tr_b16 v[146:147], v168 offset:20480
    ds_read_b64_tr_b16 v[148:149], v169 offset:16384
    ds_read_b64_tr_b16 v[150:151], v169 offset:20480
    s_waitcnt lgkmcnt(5)
    v_mfma_f32_32x32x16_bf16 v[104:119], v[136:139], v[152:155], v[104:119]
    v_mfma_f32_32x32x16_bf16 v[120:135], v[140:143], v[152:155], v[120:135]
    s_waitcnt lgkmcnt(0)
    v_mfma_f32_32x32x16_bf16 v[104:119], v[144:147], v[156:159], v[104:119]
    v_mfma_f32_32x32x16_bf16 v[120:135], v[148:151], v[156:159], v[120:135]
    s_waitcnt lgkmcnt(0)
    s_waitcnt vmcnt(9)
    s_barrier
    s_lshl_b32 s37, s29, 10
    s_add_u32 s37, s37, 65536
    s_mov_b32 m0, s37
    s_add_u32 s38, s48, 0
    s_add_u32 s38, s38, s51
    buffer_load_dwordx4 v172, s[44:47], s38 offen lds
    s_lshl_b32 s37, s29, 10
    s_add_u32 s37, s37, 73728
    s_mov_b32 m0, s37
    s_add_u32 s38, s48, 65536
    s_add_u32 s38, s38, s51
    buffer_load_dwordx4 v172, s[44:47], s38 offen lds
    s_lshl_b32 s37, s29, 10
    s_add_u32 s37, s37, 81920
    s_mov_b32 m0, s37
    s_add_u32 s38, s48, 131072
    s_add_u32 s38, s38, s51
    buffer_load_dwordx4 v172, s[44:47], s38 offen lds
    s_lshl_b32 s37, s29, 10
    s_add_u32 s37, s37, 90112
    s_mov_b32 m0, s37
    s_add_u32 s38, s48, 196608
    s_add_u32 s38, s38, s51
    buffer_load_dwordx4 v172, s[44:47], s38 offen lds
    s_add_u32 s51, s51, 262144
    s_and_b32 s51, s51, 0x7fffff
    v_xor_b32 v171, 192, v170
    ds_read_b128 v[152:155], v171 offset:0
    ds_read_b64_tr_b16 v[136:137], v168 offset:32768
    ds_read_b64_tr_b16 v[138:139], v168 offset:36864
    ds_read_b64_tr_b16 v[140:141], v169 offset:32768
    ds_read_b64_tr_b16 v[142:143], v169 offset:36864
    v_xor_b32 v171, 224, v170
    ds_read_b128 v[156:159], v171 offset:0
    ds_read_b64_tr_b16 v[144:145], v168 offset:49152
    ds_read_b64_tr_b16 v[146:147], v168 offset:53248
    ds_read_b64_tr_b16 v[148:149], v169 offset:49152
    ds_read_b64_tr_b16 v[150:151], v169 offset:53248
    s_waitcnt lgkmcnt(5)
    v_mfma_f32_32x32x16_bf16 v[104:119], v[136:139], v[152:155], v[104:119]
    v_mfma_f32_32x32x16_bf16 v[120:135], v[140:143], v[152:155], v[120:135]
    s_waitcnt lgkmcnt(0)
    v_mfma_f32_32x32x16_bf16 v[104:119], v[144:147], v[156:159], v[104:119]
    v_mfma_f32_32x32x16_bf16 v[120:135], v[148:151], v[156:159], v[120:135]
    s_waitcnt lgkmcnt(0)
    s_waitcnt vmcnt(8)
    s_barrier
    s_lshl_b32 s37, s29, 10
    s_add_u32 s37, s37, 98304
    s_mov_b32 m0, s37
    s_add_u32 s38, s48, 0
    s_add_u32 s38, s38, s51
    buffer_load_dwordx4 v172, s[44:47], s38 offen lds
    s_lshl_b32 s37, s29, 10
    s_add_u32 s37, s37, 106496
    s_mov_b32 m0, s37
    s_add_u32 s38, s48, 65536
    s_add_u32 s38, s38, s51
    buffer_load_dwordx4 v172, s[44:47], s38 offen lds
    s_lshl_b32 s37, s29, 10
    s_add_u32 s37, s37, 114688
    s_mov_b32 m0, s37
    s_add_u32 s38, s48, 131072
    s_add_u32 s38, s38, s51
    buffer_load_dwordx4 v172, s[44:47], s38 offen lds
    s_lshl_b32 s37, s29, 10
    s_add_u32 s37, s37, 122880
    s_mov_b32 m0, s37
    s_add_u32 s38, s48, 196608
    s_add_u32 s38, s38, s51
    buffer_load_dwordx4 v172, s[44:47], s38 offen lds
    s_add_u32 s51, s51, 262144
    s_and_b32 s51, s51, 0x7fffff
    s_lshl_b32 s37, s29, 10
    s_add_u32 s37, s37, 131072
    s_mov_b32 m0, s37
    s_add_u32 s38, s49, s50
    buffer_load_dwordx4 v173, s[16:19], s38 offen lds
    s_add_u32 s50, s50, 256
    s_and_b32 s50, s50, 0x7ff
    v_subrev_u32 v168, 0x10000, v168
    v_subrev_u32 v169, 0x10000, v169
    v_xor_b32 v171, 0, v170
    ds_read_b128 v[152:155], v171 offset:8192
    ds_read_b64_tr_b16 v[136:137], v168 offset:0
    ds_read_b64_tr_b16 v[138:139], v168 offset:4096
    ds_read_b64_tr_b16 v[140:141], v169 offset:0
    ds_read_b64_tr_b16 v[142:143], v169 offset:4096
    v_xor_b32 v171, 32, v170
    ds_read_b128 v[156:159], v171 offset:8192
    ds_read_b64_tr_b16 v[144:145], v168 offset:16384
    ds_read_b64_tr_b16 v[146:147], v168 offset:20480
    ds_read_b64_tr_b16 v[148:149], v169 offset:16384
    ds_read_b64_tr_b16 v[150:151], v169 offset:20480
    s_waitcnt lgkmcnt(5)
    v_mfma_f32_32x32x16_bf16 v[104:119], v[136:139], v[152:155], v[104:119]
    v_mfma_f32_32x32x16_bf16 v[120:135], v[140:143], v[152:155], v[120:135]
    s_waitcnt lgkmcnt(0)
    v_mfma_f32_32x32x16_bf16 v[104:119], v[144:147], v[156:159], v[104:119]
    v_mfma_f32_32x32x16_bf16 v[120:135], v[148:151], v[156:159], v[120:135]
    s_waitcnt lgkmcnt(0)
    s_waitcnt vmcnt(9)
    s_barrier
    s_lshl_b32 s37, s29, 10
    s_add_u32 s37, s37, 0
    s_mov_b32 m0, s37
    s_add_u32 s38, s48, 0
    s_add_u32 s38, s38, s51
    buffer_load_dwordx4 v172, s[44:47], s38 offen lds
    s_lshl_b32 s37, s29, 10
    s_add_u32 s37, s37, 8192
    s_mov_b32 m0, s37
    s_add_u32 s38, s48, 65536
    s_add_u32 s38, s38, s51
    buffer_load_dwordx4 v172, s[44:47], s38 offen lds
    s_lshl_b32 s37, s29, 10
    s_add_u32 s37, s37, 16384
    s_mov_b32 m0, s37
    s_add_u32 s38, s48, 131072
    s_add_u32 s38, s38, s51
    buffer_load_dwordx4 v172, s[44:47], s38 offen lds
    s_lshl_b32 s37, s29, 10
    s_add_u32 s37, s37, 24576
    s_mov_b32 m0, s37
    s_add_u32 s38, s48, 196608
    s_add_u32 s38, s38, s51
    buffer_load_dwordx4 v172, s[44:47], s38 offen lds
    s_add_u32 s51, s51, 262144
    s_and_b32 s51, s51, 0x7fffff
    v_xor_b32 v171, 64, v170
    ds_read_b128 v[152:155], v171 offset:8192
    ds_read_b64_tr_b16 v[136:137], v168 offset:32768
    ds_read_b64_tr_b16 v[138:139], v168 offset:36864
    ds_read_b64_tr_b16 v[140:141], v169 offset:32768
    ds_read_b64_tr_b16 v[142:143], v169 offset:36864
    v_xor_b32 v171, 96, v170
    ds_read_b128 v[156:159], v171 offset:8192
    ds_read_b64_tr_b16 v[144:145], v168 offset:49152
    ds_read_b64_tr_b16 v[146:147], v168 offset:53248
    ds_read_b64_tr_b16 v[148:149], v169 offset:49152
    ds_read_b64_tr_b16 v[150:151], v169 offset:53248
    s_waitcnt lgkmcnt(5)
    v_mfma_f32_32x32x16_bf16 v[104:119], v[136:139], v[152:155], v[104:119]
    v_mfma_f32_32x32x16_bf16 v[120:135], v[140:143], v[152:155], v[120:135]
    s_waitcnt lgkmcnt(0)
    v_mfma_f32_32x32x16_bf16 v[104:119], v[144:147], v[156:159], v[104:119]
    v_mfma_f32_32x32x16_bf16 v[120:135], v[148:151], v[156:159], v[120:135]
    s_waitcnt lgkmcnt(0)
    s_waitcnt vmcnt(9)
    s_barrier
    s_lshl_b32 s37, s29, 10
    s_add_u32 s37, s37, 32768
    s_mov_b32 m0, s37
    s_add_u32 s38, s48, 0
    s_add_u32 s38, s38, s51
    buffer_load_dwordx4 v172, s[44:47], s38 offen lds
    s_lshl_b32 s37, s29, 10
    s_add_u32 s37, s37, 40960
    s_mov_b32 m0, s37
    s_add_u32 s38, s48, 65536
    s_add_u32 s38, s38, s51
    buffer_load_dwordx4 v172, s[44:47], s38 offen lds
    s_lshl_b32 s37, s29, 10
    s_add_u32 s37, s37, 49152
    s_mov_b32 m0, s37
    s_add_u32 s38, s48, 131072
    s_add_u32 s38, s38, s51
    buffer_load_dwordx4 v172, s[44:47], s38 offen lds
    s_lshl_b32 s37, s29, 10
    s_add_u32 s37, s37, 57344
    s_mov_b32 m0, s37
    s_add_u32 s38, s48, 196608
    s_add_u32 s38, s38, s51
    buffer_load_dwordx4 v172, s[44:47], s38 offen lds
    s_add_u32 s51, s51, 262144
    s_and_b32 s51, s51, 0x7fffff
    v_add_u32 v168, 0x10000, v168
    v_add_u32 v169, 0x10000, v169
    v_xor_b32 v171, 128, v170
    ds_read_b128 v[152:155], v171 offset:8192
    ds_read_b64_tr_b16 v[136:137], v168 offset:0
    ds_read_b64_tr_b16 v[138:139], v168 offset:4096
    ds_read_b64_tr_b16 v[140:141], v169 offset:0
    ds_read_b64_tr_b16 v[142:143], v169 offset:4096
    v_xor_b32 v171, 160, v170
    ds_read_b128 v[156:159], v171 offset:8192
    ds_read_b64_tr_b16 v[144:145], v168 offset:16384
    ds_read_b64_tr_b16 v[146:147], v168 offset:20480
    ds_read_b64_tr_b16 v[148:149], v169 offset:16384
    ds_read_b64_tr_b16 v[150:151], v169 offset:20480
    s_waitcnt lgkmcnt(5)
    v_mfma_f32_32x32x16_bf16 v[104:119], v[136:139], v[152:155], v[104:119]
    v_mfma_f32_32x32x16_bf16 v[120:135], v[140:143], v[152:155], v[120:135]
    s_waitcnt lgkmcnt(0)
    v_mfma_f32_32x32x16_bf16 v[104:119], v[144:147], v[156:159], v[104:119]
    v_mfma_f32_32x32x16_bf16 v[120:135], v[148:151], v[156:159], v[120:135]
    s_waitcnt lgkmcnt(0)
    s_waitcnt vmcnt(9)
    s_barrier
    s_lshl_b32 s37, s29, 10
    s_add_u32 s37, s37, 65536
    s_mov_b32 m0, s37
    s_add_u32 s38, s48, 0
    s_add_u32 s38, s38, s51
    buffer_load_dwordx4 v172, s[44:47], s38 offen lds
    s_lshl_b32 s37, s29, 10
    s_add_u32 s37, s37, 73728
    s_mov_b32 m0, s37
    s_add_u32 s38, s48, 65536
    s_add_u32 s38, s38, s51
    buffer_load_dwordx4 v172, s[44:47], s38 offen lds
    s_lshl_b32 s37, s29, 10
    s_add_u32 s37, s37, 81920
    s_mov_b32 m0, s37
    s_add_u32 s38, s48, 131072
    s_add_u32 s38, s38, s51
    buffer_load_dwordx4 v172, s[44:47], s38 offen lds
    s_lshl_b32 s37, s29, 10
    s_add_u32 s37, s37, 90112
    s_mov_b32 m0, s37
    s_add_u32 s38, s48, 196608
    s_add_u32 s38, s38, s51
    buffer_load_dwordx4 v172, s[44:47], s38 offen lds
    s_add_u32 s51, s51, 262144
    s_and_b32 s51, s51, 0x7fffff
    v_xor_b32 v171, 192, v170
    ds_read_b128 v[152:155], v171 offset:8192
    ds_read_b64_tr_b16 v[136:137], v168 offset:32768
    ds_read_b64_tr_b16 v[138:139], v168 offset:36864
    ds_read_b64_tr_b16 v[140:141], v169 offset:32768
    ds_read_b64_tr_b16 v[142:143], v169 offset:36864
    v_xor_b32 v171, 224, v170
    ds_read_b128 v[156:159], v171 offset:8192
    ds_read_b64_tr_b16 v[144:145], v168 offset:49152
    ds_read_b64_tr_b16 v[146:147], v168 offset:53248
    ds_read_b64_tr_b16 v[148:149], v169 offset:49152
    ds_read_b64_tr_b16 v[150:151], v169 offset:53248
    s_waitcnt lgkmcnt(5)
    v_mfma_f32_32x32x16_bf16 v[104:119], v[136:139], v[152:155], v[104:119]
    v_mfma_f32_32x32x16_bf16 v[120:135], v[140:143], v[152:155], v[120:135]
    s_waitcnt lgkmcnt(0)
    v_mfma_f32_32x32x16_bf16 v[104:119], v[144:147], v[156:159], v[104:119]
    v_mfma_f32_32x32x16_bf16 v[120:135], v[148:151], v[156:159], v[120:135]
    s_waitcnt lgkmcnt(0)
    s_waitcnt vmcnt(8)
    s_barrier
    s_lshl_b32 s37, s29, 10
    s_add_u32 s37, s37, 98304
    s_mov_b32 m0, s37
    s_add_u32 s38, s48, 0
    s_add_u32 s38, s38, s51
    buffer_load_dwordx4 v172, s[44:47], s38 offen lds
    s_lshl_b32 s37, s29, 10
    s_add_u32 s37, s37, 106496
    s_mov_b32 m0, s37
    s_add_u32 s38, s48, 65536
    s_add_u32 s38, s38, s51
    buffer_load_dwordx4 v172, s[44:47], s38 offen lds
    s_lshl_b32 s37, s29, 10
    s_add_u32 s37, s37, 114688
    s_mov_b32 m0, s37
    s_add_u32 s38, s48, 131072
    s_add_u32 s38, s38, s51
    buffer_load_dwordx4 v172, s[44:47], s38 offen lds
    s_lshl_b32 s37, s29, 10
    s_add_u32 s37, s37, 122880
    s_mov_b32 m0, s37
    s_add_u32 s38, s48, 196608
    s_add_u32 s38, s38, s51
    buffer_load_dwordx4 v172, s[44:47], s38 offen lds
    s_add_u32 s51, s51, 262144
    s_and_b32 s51, s51, 0x7fffff
    s_lshl_b32 s37, s29, 10
    s_add_u32 s37, s37, 139264
    s_mov_b32 m0, s37
    s_add_u32 s38, s49, s50
    buffer_load_dwordx4 v173, s[16:19], s38 offen lds
    s_add_u32 s50, s50, 256
    s_and_b32 s50, s50, 0x7ff
    v_subrev_u32 v168, 0x10000, v168
    v_subrev_u32 v169, 0x10000, v169
    v_xor_b32 v171, 0, v170
    ds_read_b128 v[152:155], v171 offset:0
    ds_read_b64_tr_b16 v[136:137], v168 offset:0
    ds_read_b64_tr_b16 v[138:139], v168 offset:4096
    ds_read_b64_tr_b16 v[140:141], v169 offset:0
    ds_read_b64_tr_b16 v[142:143], v169 offset:4096
    v_xor_b32 v171, 32, v170
    ds_read_b128 v[156:159], v171 offset:0
    ds_read_b64_tr_b16 v[144:145], v168 offset:16384
    ds_read_b64_tr_b16 v[146:147], v168 offset:20480
    ds_read_b64_tr_b16 v[148:149], v169 offset:16384
    ds_read_b64_tr_b16 v[150:151], v169 offset:20480
    s_waitcnt lgkmcnt(5)
    v_mfma_f32_32x32x16_bf16 v[104:119], v[136:139], v[152:155], v[104:119]
    v_mfma_f32_32x32x16_bf16 v[120:135], v[140:143], v[152:155], v[120:135]
    s_waitcnt lgkmcnt(0)
    v_mfma_f32_32x32x16_bf16 v[104:119], v[144:147], v[156:159], v[104:119]
    v_mfma_f32_32x32x16_bf16 v[120:135], v[148:151], v[156:159], v[120:135]
    s_waitcnt lgkmcnt(0)
    s_waitcnt vmcnt(9)
    s_barrier
    s_lshl_b32 s37, s29, 10
    s_add_u32 s37, s37, 0
    s_mov_b32 m0, s37
    s_add_u32 s38, s48, 0
    s_add_u32 s38, s38, s51
    buffer_load_dwordx4 v172, s[44:47], s38 offen lds
    s_lshl_b32 s37, s29, 10
    s_add_u32 s37, s37, 8192
    s_mov_b32 m0, s37
    s_add_u32 s38, s48, 65536
    s_add_u32 s38, s38, s51
    buffer_load_dwordx4 v172, s[44:47], s38 offen lds
    s_lshl_b32 s37, s29, 10
    s_add_u32 s37, s37, 16384
    s_mov_b32 m0, s37
    s_add_u32 s38, s48, 131072
    s_add_u32 s38, s38, s51
    buffer_load_dwordx4 v172, s[44:47], s38 offen lds
    s_lshl_b32 s37, s29, 10
    s_add_u32 s37, s37, 24576
    s_mov_b32 m0, s37
    s_add_u32 s38, s48, 196608
    s_add_u32 s38, s38, s51
    buffer_load_dwordx4 v172, s[44:47], s38 offen lds
    s_add_u32 s51, s51, 262144
    s_and_b32 s51, s51, 0x7fffff
    v_xor_b32 v171, 64, v170
    ds_read_b128 v[152:155], v171 offset:0
    ds_read_b64_tr_b16 v[136:137], v168 offset:32768
    ds_read_b64_tr_b16 v[138:139], v168 offset:36864
    ds_read_b64_tr_b16 v[140:141], v169 offset:32768
    ds_read_b64_tr_b16 v[142:143], v169 offset:36864
    v_xor_b32 v171, 96, v170
    ds_read_b128 v[156:159], v171 offset:0
    ds_read_b64_tr_b16 v[144:145], v168 offset:49152
    ds_read_b64_tr_b16 v[146:147], v168 offset:53248
    ds_read_b64_tr_b16 v[148:149], v169 offset:49152
    ds_read_b64_tr_b16 v[150:151], v169 offset:53248
    s_waitcnt lgkmcnt(5)
    v_mfma_f32_32x32x16_bf16 v[104:119], v[136:139], v[152:155], v[104:119]
    v_mfma_f32_32x32x16_bf16 v[120:135], v[140:143], v[152:155], v[120:135]
    s_waitcnt lgkmcnt(0)
    v_mfma_f32_32x32x16_bf16 v[104:119], v[144:147], v[156:159], v[104:119]
    v_mfma_f32_32x32x16_bf16 v[120:135], v[148:151], v[156:159], v[120:135]
    s_waitcnt lgkmcnt(0)
    s_waitcnt vmcnt(9)
    s_barrier
    s_lshl_b32 s37, s29, 10
    s_add_u32 s37, s37, 32768
    s_mov_b32 m0, s37
    s_add_u32 s38, s48, 0
    s_add_u32 s38, s38, s51
    buffer_load_dwordx4 v172, s[44:47], s38 offen lds
    s_lshl_b32 s37, s29, 10
    s_add_u32 s37, s37, 40960
    s_mov_b32 m0, s37
    s_add_u32 s38, s48, 65536
    s_add_u32 s38, s38, s51
    buffer_load_dwordx4 v172, s[44:47], s38 offen lds
    s_lshl_b32 s37, s29, 10
    s_add_u32 s37, s37, 49152
    s_mov_b32 m0, s37
    s_add_u32 s38, s48, 131072
    s_add_u32 s38, s38, s51
    buffer_load_dwordx4 v172, s[44:47], s38 offen lds
    s_lshl_b32 s37, s29, 10
    s_add_u32 s37, s37, 57344
    s_mov_b32 m0, s37
    s_add_u32 s38, s48, 196608
    s_add_u32 s38, s38, s51
    buffer_load_dwordx4 v172, s[44:47], s38 offen lds
    s_add_u32 s51, s51, 262144
    s_and_b32 s51, s51, 0x7fffff
    v_add_u32 v168, 0x10000, v168
    v_add_u32 v169, 0x10000, v169
    v_xor_b32 v171, 128, v170
    ds_read_b128 v[152:155], v171 offset:0
    ds_read_b64_tr_b16 v[136:137], v168 offset:0
    ds_read_b64_tr_b16 v[138:139], v168 offset:4096
    ds_read_b64_tr_b16 v[140:141], v169 offset:0
    ds_read_b64_tr_b16 v[142:143], v169 offset:4096
    v_xor_b32 v171, 160, v170
    ds_read_b128 v[156:159], v171 offset:0
    ds_read_b64_tr_b16 v[144:145], v168 offset:16384
    ds_read_b64_tr_b16 v[146:147], v168 offset:20480
    ds_read_b64_tr_b16 v[148:149], v169 offset:16384
    ds_read_b64_tr_b16 v[150:151], v169 offset:20480
    s_waitcnt lgkmcnt(5)
    v_mfma_f32_32x32x16_bf16 v[104:119], v[136:139], v[152:155], v[104:119]
    v_mfma_f32_32x32x16_bf16 v[120:135], v[140:143], v[152:155], v[120:135]
    s_waitcnt lgkmcnt(0)
    v_mfma_f32_32x32x16_bf16 v[104:119], v[144:147], v[156:159], v[104:119]
    v_mfma_f32_32x32x16_bf16 v[120:135], v[148:151], v[156:159], v[120:135]
    s_waitcnt lgkmcnt(0)
    s_waitcnt vmcnt(9)
    s_barrier
    s_lshl_b32 s37, s29, 10
    s_add_u32 s37, s37, 65536
    s_mov_b32 m0, s37
    s_add_u32 s38, s48, 0
    s_add_u32 s38, s38, s51
    buffer_load_dwordx4 v172, s[44:47], s38 offen lds
    s_lshl_b32 s37, s29, 10
    s_add_u32 s37, s37, 73728
    s_mov_b32 m0, s37
    s_add_u32 s38, s48, 65536
    s_add_u32 s38, s38, s51
    buffer_load_dwordx4 v172, s[44:47], s38 offen lds
    s_lshl_b32 s37, s29, 10
    s_add_u32 s37, s37, 81920
    s_mov_b32 m0, s37
    s_add_u32 s38, s48, 131072
    s_add_u32 s38, s38, s51
    buffer_load_dwordx4 v172, s[44:47], s38 offen lds
    s_lshl_b32 s37, s29, 10
    s_add_u32 s37, s37, 90112
    s_mov_b32 m0, s37
    s_add_u32 s38, s48, 196608
    s_add_u32 s38, s38, s51
    buffer_load_dwordx4 v172, s[44:47], s38 offen lds
    s_add_u32 s51, s51, 262144
    s_and_b32 s51, s51, 0x7fffff
    v_xor_b32 v171, 192, v170
    ds_read_b128 v[152:155], v171 offset:0
    ds_read_b64_tr_b16 v[136:137], v168 offset:32768
    ds_read_b64_tr_b16 v[138:139], v168 offset:36864
    ds_read_b64_tr_b16 v[140:141], v169 offset:32768
    ds_read_b64_tr_b16 v[142:143], v169 offset:36864
    v_xor_b32 v171, 224, v170
    ds_read_b128 v[156:159], v171 offset:0
    ds_read_b64_tr_b16 v[144:145], v168 offset:49152
    ds_read_b64_tr_b16 v[146:147], v168 offset:53248
    ds_read_b64_tr_b16 v[148:149], v169 offset:49152
    ds_read_b64_tr_b16 v[150:151], v169 offset:53248
    s_waitcnt lgkmcnt(5)
    v_mfma_f32_32x32x16_bf16 v[104:119], v[136:139], v[152:155], v[104:119]
    v_mfma_f32_32x32x16_bf16 v[120:135], v[140:143], v[152:155], v[120:135]
    s_waitcnt lgkmcnt(0)
    v_mfma_f32_32x32x16_bf16 v[104:119], v[144:147], v[156:159], v[104:119]
    v_mfma_f32_32x32x16_bf16 v[120:135], v[148:151], v[156:159], v[120:135]
    s_waitcnt lgkmcnt(0)
    s_waitcnt vmcnt(8)
    s_barrier
    s_lshl_b32 s37, s29, 10
    s_add_u32 s37, s37, 98304
    s_mov_b32 m0, s37
    s_add_u32 s38, s48, 0
    s_add_u32 s38, s38, s51
    buffer_load_dwordx4 v172, s[44:47], s38 offen lds
    s_lshl_b32 s37, s29, 10
    s_add_u32 s37, s37, 106496
    s_mov_b32 m0, s37
    s_add_u32 s38, s48, 65536
    s_add_u32 s38, s38, s51
    buffer_load_dwordx4 v172, s[44:47], s38 offen lds
    s_lshl_b32 s37, s29, 10
    s_add_u32 s37, s37, 114688
    s_mov_b32 m0, s37
    s_add_u32 s38, s48, 131072
    s_add_u32 s38, s38, s51
    buffer_load_dwordx4 v172, s[44:47], s38 offen lds
    s_lshl_b32 s37, s29, 10
    s_add_u32 s37, s37, 122880
    s_mov_b32 m0, s37
    s_add_u32 s38, s48, 196608
    s_add_u32 s38, s38, s51
    buffer_load_dwordx4 v172, s[44:47], s38 offen lds
    s_add_u32 s51, s51, 262144
    s_and_b32 s51, s51, 0x7fffff
    v_subrev_u32 v168, 0x10000, v168
    v_subrev_u32 v169, 0x10000, v169
    v_xor_b32 v171, 0, v170
    ds_read_b128 v[152:155], v171 offset:8192
    ds_read_b64_tr_b16 v[136:137], v168 offset:0
    ds_read_b64_tr_b16 v[138:139], v168 offset:4096
    ds_read_b64_tr_b16 v[140:141], v169 offset:0
    ds_read_b64_tr_b16 v[142:143], v169 offset:4096
    v_xor_b32 v171, 32, v170
    ds_read_b128 v[156:159], v171 offset:8192
    ds_read_b64_tr_b16 v[144:145], v168 offset:16384
    ds_read_b64_tr_b16 v[146:147], v168 offset:20480
    ds_read_b64_tr_b16 v[148:149], v169 offset:16384
    ds_read_b64_tr_b16 v[150:151], v169 offset:20480
    s_waitcnt lgkmcnt(5)
    v_mfma_f32_32x32x16_bf16 v[104:119], v[136:139], v[152:155], v[104:119]
    v_mfma_f32_32x32x16_bf16 v[120:135], v[140:143], v[152:155], v[120:135]
    s_waitcnt lgkmcnt(0)
    v_mfma_f32_32x32x16_bf16 v[104:119], v[144:147], v[156:159], v[104:119]
    v_mfma_f32_32x32x16_bf16 v[120:135], v[148:151], v[156:159], v[120:135]
    s_waitcnt lgkmcnt(0)
    s_waitcnt vmcnt(8)
    s_barrier
    s_lshl_b32 s37, s29, 10
    s_add_u32 s37, s37, 0
    s_mov_b32 m0, s37
    s_add_u32 s38, s26, 16384
    buffer_load_dwordx4 v244, s[8:11], s38 offen nt lds
    s_lshl_b32 s37, s29, 10
    s_add_u32 s37, s37, 8192
    s_mov_b32 m0, s37
    s_add_u32 s38, s26, 24576
    buffer_load_dwordx4 v244, s[8:11], s38 offen nt lds
    s_add_u32 s26, s26, 16384
    v_xor_b32 v171, 64, v170
    ds_read_b128 v[152:155], v171 offset:8192
    ds_read_b64_tr_b16 v[136:137], v168 offset:32768
    ds_read_b64_tr_b16 v[138:139], v168 offset:36864
    ds_read_b64_tr_b16 v[140:141], v169 offset:32768
    ds_read_b64_tr_b16 v[142:143], v169 offset:36864
    v_xor_b32 v171, 96, v170
    ds_read_b128 v[156:159], v171 offset:8192
    ds_read_b64_tr_b16 v[144:145], v168 offset:49152
    ds_read_b64_tr_b16 v[146:147], v168 offset:53248
    ds_read_b64_tr_b16 v[148:149], v169 offset:49152
    ds_read_b64_tr_b16 v[150:151], v169 offset:53248
    s_waitcnt lgkmcnt(5)
    v_mfma_f32_32x32x16_bf16 v[104:119], v[136:139], v[152:155], v[104:119]
    v_mfma_f32_32x32x16_bf16 v[120:135], v[140:143], v[152:155], v[120:135]
    s_waitcnt lgkmcnt(0)
    v_mfma_f32_32x32x16_bf16 v[104:119], v[144:147], v[156:159], v[104:119]
    v_mfma_f32_32x32x16_bf16 v[120:135], v[148:151], v[156:159], v[120:135]
    s_waitcnt lgkmcnt(0)
    s_waitcnt vmcnt(6)
    s_barrier
    s_lshl_b32 s37, s29, 10
    s_add_u32 s37, s37, 32768
    s_mov_b32 m0, s37
    s_add_u32 s38, s26, 16384
    buffer_load_dwordx4 v244, s[8:11], s38 offen nt lds
    s_lshl_b32 s37, s29, 10
    s_add_u32 s37, s37, 40960
    s_mov_b32 m0, s37
    s_add_u32 s38, s26, 24576
    buffer_load_dwordx4 v244, s[8:11], s38 offen nt lds
    s_lshl_b32 s37, s29, 10
    s_add_u32 s37, s37, 49152
    s_mov_b32 m0, s37
    s_add_u32 s38, s26, 0
    buffer_load_dwordx4 v245, s[12:15], s38 offen nt lds
    s_add_u32 s26, s26, 16384
    v_add_u32 v168, 0x10000, v168
    v_add_u32 v169, 0x10000, v169
    v_xor_b32 v171, 128, v170
    ds_read_b128 v[152:155], v171 offset:8192
    ds_read_b64_tr_b16 v[136:137], v168 offset:0
    ds_read_b64_tr_b16 v[138:139], v168 offset:4096
    ds_read_b64_tr_b16 v[140:141], v169 offset:0
    ds_read_b64_tr_b16 v[142:143], v169 offset:4096
    v_xor_b32 v171, 160, v170
    ds_read_b128 v[156:159], v171 offset:8192
    ds_read_b64_tr_b16 v[144:145], v168 offset:16384
    ds_read_b64_tr_b16 v[146:147], v168 offset:20480
    ds_read_b64_tr_b16 v[148:149], v169 offset:16384
    ds_read_b64_tr_b16 v[150:151], v169 offset:20480
    s_waitcnt lgkmcnt(5)
    v_mfma_f32_32x32x16_bf16 v[104:119], v[136:139], v[152:155], v[104:119]
    v_mfma_f32_32x32x16_bf16 v[120:135], v[140:143], v[152:155], v[120:135]
    s_waitcnt lgkmcnt(0)
    v_mfma_f32_32x32x16_bf16 v[104:119], v[144:147], v[156:159], v[104:119]
    v_mfma_f32_32x32x16_bf16 v[120:135], v[148:151], v[156:159], v[120:135]
    s_waitcnt lgkmcnt(0)
    s_waitcnt vmcnt(5)
    s_barrier
    s_lshl_b32 s37, s29, 10
    s_add_u32 s37, s37, 65536
    s_mov_b32 m0, s37
    s_add_u32 s38, s26, 16384
    buffer_load_dwordx4 v244, s[8:11], s38 offen nt lds
    s_lshl_b32 s37, s29, 10
    s_add_u32 s37, s37, 73728
    s_mov_b32 m0, s37
    s_add_u32 s38, s26, 24576
    buffer_load_dwordx4 v244, s[8:11], s38 offen nt lds
    s_lshl_b32 s37, s29, 10
    s_add_u32 s37, s37, 81920
    s_mov_b32 m0, s37
    s_add_u32 s38, s26, 0
    buffer_load_dwordx4 v245, s[12:15], s38 offen nt lds
    s_lshl_b32 s37, s29, 10
    s_add_u32 s37, s37, 90112
    s_mov_b32 m0, s37
    s_sub_u32 s38, s26, 8192
    buffer_load_dwordx4 v245, s[12:15], s38 offen nt lds
    s_add_u32 s26, s26, 16384
    v_xor_b32 v171, 192, v170
    ds_read_b128 v[152:155], v171 offset:8192
    ds_read_b64_tr_b16 v[136:137], v168 offset:32768
    ds_read_b64_tr_b16 v[138:139], v168 offset:36864
    ds_read_b64_tr_b16 v[140:141], v169 offset:32768
    ds_read_b64_tr_b16 v[142:143], v169 offset:36864
    v_xor_b32 v171, 224, v170
    ds_read_b128 v[156:159], v171 offset:8192
    ds_read_b64_tr_b16 v[144:145], v168 offset:49152
    ds_read_b64_tr_b16 v[146:147], v168 offset:53248
    ds_read_b64_tr_b16 v[148:149], v169 offset:49152
    ds_read_b64_tr_b16 v[150:151], v169 offset:53248
    s_waitcnt lgkmcnt(5)
    v_mfma_f32_32x32x16_bf16 v[104:119], v[136:139], v[152:155], v[104:119]
    v_mfma_f32_32x32x16_bf16 v[120:135], v[140:143], v[152:155], v[120:135]
    s_waitcnt lgkmcnt(0)
    v_mfma_f32_32x32x16_bf16 v[104:119], v[144:147], v[156:159], v[104:119]
    v_mfma_f32_32x32x16_bf16 v[120:135], v[148:151], v[156:159], v[120:135]
    s_nop 15
    s_nop 3
    v_cvt_pk_bf16_f32 v136, v104, v105
    v_cvt_pk_bf16_f32 v137, v106, v107
    v_cvt_pk_bf16_f32 v138, v108, v109
    v_cvt_pk_bf16_f32 v139, v110, v111
    s_nop 1
    v_permlane32_swap_b32 v136, v138
    v_permlane32_swap_b32 v137, v139
    v_cvt_pk_bf16_f32 v140, v112, v113
    v_cvt_pk_bf16_f32 v141, v114, v115
    v_cvt_pk_bf16_f32 v142, v116, v117
    v_cvt_pk_bf16_f32 v143, v118, v119
    s_nop 1
    v_permlane32_swap_b32 v140, v142
    v_permlane32_swap_b32 v141, v143
    v_cvt_pk_bf16_f32 v144, v120, v121
    v_cvt_pk_bf16_f32 v145, v122, v123
    v_cvt_pk_bf16_f32 v146, v124, v125
    v_cvt_pk_bf16_f32 v147, v126, v127
    s_nop 1
    v_permlane32_swap_b32 v144, v146
    v_permlane32_swap_b32 v145, v147
    v_cvt_pk_bf16_f32 v148, v128, v129
    v_cvt_pk_bf16_f32 v149, v130, v131
    v_cvt_pk_bf16_f32 v150, v132, v133
    v_cvt_pk_bf16_f32 v151, v134, v135
    s_nop 1
    v_permlane32_swap_b32 v148, v150
    v_permlane32_swap_b32 v149, v151
    s_waitcnt lgkmcnt(0)
    s_barrier
    v_lshlrev_b32 v2, 4, v1
    s_lshl_b32 s37, s29, 12
    s_add_u32 s37, s37, 131072
    v_add_u32 v2, s37, v2
    ds_write_b128 v2, v[136:139] offset:0
    ds_write_b128 v2, v[140:143] offset:1024
    ds_write_b128 v2, v[144:147] offset:2048
    ds_write_b128 v2, v[148:151] offset:3072
    s_waitcnt lgkmcnt(0)
    s_barrier
    s_xor_b32 s37, s29, 4
    s_lshl_b32 s37, s37, 12
    s_add_u32 s37, s37, 131072
    v_lshlrev_b32 v2, 4, v1
    v_add_u32 v2, s37, v2
    s_cmp_ge_u32 s29, 4
    s_cbranch_scc1 L_gqa_attn_kernel_qx1
    ds_read_b128 v[24:27], v2 offset:0
    ds_read_b128 v[28:31], v2 offset:1024
    ds_read_b128 v[32:35], v2 offset:2048
    ds_read_b128 v[36:39], v2 offset:3072
    v_mov_b32 v8, v136
    v_mov_b32 v9, v137
    v_mov_b32 v10, v138
    v_mov_b32 v11, v139
    v_mov_b32 v12, v140
    v_mov_b32 v13, v141
    v_mov_b32 v14, v142
    v_mov_b32 v15, v143
    v_mov_b32 v16, v144
    v_mov_b32 v17, v145
    v_mov_b32 v18, v146
    v_mov_b32 v19, v147
    v_mov_b32 v20, v148
    v_mov_b32 v21, v149
    v_mov_b32 v22, v150
    v_mov_b32 v23, v151
    s_branch L_gqa_attn_kernel_qx2
L_gqa_attn_kernel_qx1:
    ds_read_b128 v[8:11], v2 offset:0
    ds_read_b128 v[12:15], v2 offset:1024
    ds_read_b128 v[16:19], v2 offset:2048
    ds_read_b128 v[20:23], v2 offset:3072
    v_mov_b32 v24, v136
    v_mov_b32 v25, v137
    v_mov_b32 v26, v138
    v_mov_b32 v27, v139
    v_mov_b32 v28, v140
    v_mov_b32 v29, v141
    v_mov_b32 v30, v142
    v_mov_b32 v31, v143
    v_mov_b32 v32, v144
    v_mov_b32 v33, v145
    v_mov_b32 v34, v146
    v_mov_b32 v35, v147
    v_mov_b32 v36, v148
    v_mov_b32 v37, v149
    v_mov_b32 v38, v150
    v_mov_b32 v39, v151
L_gqa_attn_kernel_qx2:
    s_lshr_b32 s37, s29, 2
    s_lshl_b32 s37, s37, 13
    v_and_b32 v2, 31, v1
    v_lshrrev_b32 v3, 5, v1
    v_and_b32 v4, 15, v2
    v_xor_b32 v4, v4, v3
    v_lshlrev_b32 v4, 4, v4
    v_lshlrev_b32 v5, 8, v2
    v_add_u32 v232, v5, v4
    v_add_u32 v232, s37, v232
    v_xor_b32 v233, 32, v232
    v_xor_b32 v234, 64, v232
    v_xor_b32 v235, 96, v232
    v_xor_b32 v236, 128, v232
    v_xor_b32 v237, 160, v232
    v_xor_b32 v238, 192, v232
    v_xor_b32 v239, 224, v232
    v_and_b32 v2, 15, v1
    v_lshrrev_b32 v3, 2, v2
    v_lshrrev_b32 v4, 5, v1
    v_lshlrev_b32 v4, 2, v4
    v_add_u32 v4, v4, v3
    v_lshlrev_b32 v4, 8, v4
    v_lshlrev_b32 v5, 6, v3
    v_add_u32 v4, v4, v5
    v_lshrrev_b32 v5, 4, v1
    v_and_b32 v5, 1, v5
    v_lshlrev_b32 v5, 5, v5
    v_add_u32 v4, v4, v5
    v_and_b32 v5, 3, v1
    v_lshlrev_b32 v5, 3, v5
    v_add_u32 v240, v4, v5
    s_add_u32 s37, s37, 16384
    v_add_u32 v240, s37, v240
    v_xor_b32 v241, 64, v240
    v_xor_b32 v242, 128, v240
    v_xor_b32 v243, 192, v240
    v_mov_b32 v246, 0xf149f2ca
    v_mul_f32 v247, s24, v246
    v_mov_b32 v248, 0
    v_mov_b32 v40, 0
    v_mov_b32 v41, 0
    v_mov_b32 v42, 0
    v_mov_b32 v43, 0
    v_mov_b32 v44, 0
    v_mov_b32 v45, 0
    v_mov_b32 v46, 0
    v_mov_b32 v47, 0
    v_mov_b32 v48, 0
    v_mov_b32 v49, 0
    v_mov_b32 v50, 0
    v_mov_b32 v51, 0
    v_mov_b32 v52, 0
    v_mov_b32 v53, 0
    v_mov_b32 v54, 0
    v_mov_b32 v55, 0
    v_mov_b32 v56, 0
    v_mov_b32 v57, 0
    v_mov_b32 v58, 0
    v_mov_b32 v59, 0
    v_mov_b32 v60, 0
    v_mov_b32 v61, 0
    v_mov_b32 v62, 0
    v_mov_b32 v63, 0
    v_mov_b32 v64, 0
    v_mov_b32 v65, 0
    v_mov_b32 v66, 0
    v_mov_b32 v67, 0
    v_mov_b32 v68, 0
    v_mov_b32 v69, 0
    v_mov_b32 v70, 0
    v_mov_b32 v71, 0
    v_mov_b32 v72, 0
    v_mov_b32 v73, 0
    v_mov_b32 v74, 0
    v_mov_b32 v75, 0
    v_mov_b32 v76, 0
    v_mov_b32 v77, 0
    v_mov_b32 v78, 0
    v_mov_b32 v79, 0
    v_mov_b32 v80, 0
    v_mov_b32 v81, 0
    v_mov_b32 v82, 0
    v_mov_b32 v83, 0
    v_mov_b32 v84, 0
    v_mov_b32 v85, 0
    v_mov_b32 v86, 0
    v_mov_b32 v87, 0
    v_mov_b32 v88, 0
    v_mov_b32 v89, 0
    v_mov_b32 v90, 0
    v_mov_b32 v91, 0
    v_mov_b32 v92, 0
    v_mov_b32 v93, 0
    v_mov_b32 v94, 0
    v_mov_b32 v95, 0
    v_mov_b32 v96, 0
    v_mov_b32 v97, 0
    v_mov_b32 v98, 0
    v_mov_b32 v99, 0
    v_mov_b32 v100, 0
    v_mov_b32 v101, 0
    v_mov_b32 v102, 0
    v_mov_b32 v103, 0
    s_cmp_ge_u32 s29, 4
    s_cbranch_scc1 L_gqa_attn_kernel_par1
    s_waitcnt lgkmcnt(0)
    s_waitcnt vmcnt(7)
    s_barrier
    s_lshl_b32 s37, s29, 10
    s_add_u32 s37, s37, 98304
    s_mov_b32 m0, s37
    s_add_u32 s38, s26, 16384
    buffer_load_dwordx4 v244, s[8:11], s38 offen nt lds
    s_lshl_b32 s37, s29, 10
    s_add_u32 s37, s37, 106496
    s_mov_b32 m0, s37
    s_add_u32 s38, s26, 24576
    buffer_load_dwordx4 v244, s[8:11], s38 offen nt lds
    s_lshl_b32 s37, s29, 10
    s_add_u32 s37, s37, 114688
    s_mov_b32 m0, s37
    s_add_u32 s38, s26, 0
    buffer_load_dwordx4 v245, s[12:15], s38 offen nt lds
    s_lshl_b32 s37, s29, 10
    s_add_u32 s37, s37, 122880
    s_mov_b32 m0, s37
    s_sub_u32 s38, s26, 8192
    buffer_load_dwordx4 v245, s[12:15], s38 offen nt lds
    s_add_u32 s26, s26, 16384
    ds_read_b128 v[168:171], v232 offset:0
    ds_read_b128 v[172:175], v233 offset:0
    ds_read_b128 v[176:179], v234 offset:0
    ds_read_b128 v[180:183], v235 offset:0
    ds_read_b128 v[184:187], v236 offset:0
    ds_read_b128 v[188:191], v237 offset:0
    ds_read_b128 v[192:195], v238 offset:0
    ds_read_b128 v[196:199], v239 offset:0
    s_waitcnt lgkmcnt(0)
    v_mfma_f32_32x32x16_bf16 v[104:119], v[168:171], v[8:11], 0
    v_mfma_f32_32x32x16_bf16 v[104:119], v[172:175], v[12:15], v[104:119]
    v_mfma_f32_32x32x16_bf16 v[104:119], v[176:179], v[16:19], v[104:119]
    v_mfma_f32_32x32x16_bf16 v[104:119], v[180:183], v[20:23], v[104:119]
    v_mfma_f32_32x32x16_bf16 v[104:119], v[184:187], v[24:27], v[104:119]
    v_mfma_f32_32x32x16_bf16 v[104:119], v[188:191], v[28:31], v[104:119]
    v_mfma_f32_32x32x16_bf16 v[104:119], v[192:195], v[32:35], v[104:119]
    v_mfma_f32_32x32x16_bf16 v[104:119], v[196:199], v[36:39], v[104:119]
    s_waitcnt lgkmcnt(0)
    s_waitcnt vmcnt(8)
    s_barrier
    s_nop 7
    s_nop 7
    s_lshl_b32 s37, s29, 10
    s_add_u32 s37, s37, 0
    s_mov_b32 m0, s37
    s_add_u32 s38, s26, 16384
    buffer_load_dwordx4 v244, s[8:11], s38 offen nt lds
    s_lshl_b32 s37, s29, 10
    s_add_u32 s37, s37, 8192
    s_mov_b32 m0, s37
    s_add_u32 s38, s26, 24576
    buffer_load_dwordx4 v244, s[8:11], s38 offen nt lds
    s_lshl_b32 s37, s29, 10
    s_add_u32 s37, s37, 16384
    s_mov_b32 m0, s37
    s_add_u32 s38, s26, 0
    buffer_load_dwordx4 v245, s[12:15], s38 offen nt lds
    s_lshl_b32 s37, s29, 10
    s_add_u32 s37, s37, 24576
    s_mov_b32 m0, s37
    s_sub_u32 s38, s26, 8192
    buffer_load_dwordx4 v245, s[12:15], s38 offen nt lds
    s_add_u32 s26, s26, 16384
    ds_read_b128 v[168:171], v232 offset:32768
    ds_read_b128 v[172:175], v233 offset:32768
    ds_read_b128 v[176:179], v234 offset:32768
    ds_read_b128 v[180:183], v235 offset:32768
    ds_read_b128 v[184:187], v236 offset:32768
    ds_read_b128 v[188:191], v237 offset:32768
    ds_read_b128 v[192:195], v238 offset:32768
    ds_read_b128 v[196:199], v239 offset:32768
    v_fma_f32 v136, v104, s24, -v247
    v_fma_f32 v137, v105, s24, -v247
    v_fma_f32 v138, v106, s24, -v247
    v_fma_f32 v139, v107, s24, -v247
    v_fma_f32 v140, v108, s24, -v247
    v_fma_f32 v141, v109, s24, -v247
    v_exp_f32 v136, v136
    v_fma_f32 v142, v110, s24, -v247
    v_exp_f32 v137, v137
    v_fma_f32 v143, v111, s24, -v247
    v_exp_f32 v138, v138
    v_fma_f32 v144, v112, s24, -v247
    v_exp_f32 v139, v139
    v_fma_f32 v145, v113, s24, -v247
    v_add_f32 v0, v136, v137
    v_exp_f32 v140, v140
    v_fma_f32 v146, v114, s24, -v247
    v_exp_f32 v141, v141
    v_fma_f32 v147, v115, s24, -v247
    v_add_f32 v1, v138, v139
    v_exp_f32 v142, v142
    v_fma_f32 v148, v116, s24, -v247
    v_exp_f32 v143, v143
    v_fma_f32 v149, v117, s24, -v247
    s_waitcnt lgkmcnt(0)
    v_mfma_f32_32x32x16_bf16 v[120:135], v[168:171], v[8:11], 0
    ds_read_b64_tr_b16 v[200:201], v240 offset:32768
    ds_read_b64_tr_b16 v[202:203], v240 offset:34816
    v_add_f32 v2, v140, v141
    v_exp_f32 v144, v144
    v_fma_f32 v150, v118, s24, -v247
    v_mfma_f32_32x32x16_bf16 v[120:135], v[172:175], v[12:15], v[120:135]
    ds_read_b64_tr_b16 v[208:209], v241 offset:32768
    ds_read_b64_tr_b16 v[210:211], v241 offset:34816
    v_exp_f32 v145, v145
    v_fma_f32 v151, v119, s24, -v247
    v_add_f32 v3, v142, v143
    v_mfma_f32_32x32x16_bf16 v[120:135], v[176:179], v[16:19], v[120:135]
    ds_read_b64_tr_b16 v[216:217], v242 offset:32768
    ds_read_b64_tr_b16 v[218:219], v242 offset:34816
    v_exp_f32 v146, v146
    v_exp_f32 v147, v147
    v_add_f32 v4, v144, v145
    v_mfma_f32_32x32x16_bf16 v[120:135], v[180:183], v[20:23], v[120:135]
    ds_read_b64_tr_b16 v[224:225], v243 offset:32768
    ds_read_b64_tr_b16 v[226:227], v243 offset:34816
    v_exp_f32 v148, v148
    v_exp_f32 v149, v149
    v_add_f32 v5, v146, v147
    v_mfma_f32_32x32x16_bf16 v[120:135], v[184:187], v[24:27], v[120:135]
    ds_read_b64_tr_b16 v[204:205], v240 offset:36864
    ds_read_b64_tr_b16 v[206:207], v240 offset:38912
    v_exp_f32 v150, v150
    v_exp_f32 v151, v151
    v_add_f32 v6, v148, v149
    v_mfma_f32_32x32x16_bf16 v[120:135], v[188:191], v[28:31], v[120:135]
    ds_read_b64_tr_b16 v[212:213], v241 offset:36864
    ds_read_b64_tr_b16 v[214:215], v241 offset:38912
    v_add_f32 v7, v150, v151
    v_add_f32 v0, v0, v1
    v_add_f32 v1, v2, v3
    v_mfma_f32_32x32x16_bf16 v[120:135], v[192:195], v[32:35], v[120:135]
    ds_read_b64_tr_b16 v[220:221], v242 offset:36864
    ds_read_b64_tr_b16 v[222:223], v242 offset:38912
    v_add_f32 v2, v4, v5
    v_add_f32 v3, v6, v7
    v_mfma_f32_32x32x16_bf16 v[120:135], v[196:199], v[36:39], v[120:135]
    ds_read_b64_tr_b16 v[228:229], v243 offset:36864
    ds_read_b64_tr_b16 v[230:231], v243 offset:38912
    v_add_f32 v0, v0, v1
    v_add_f32 v2, v2, v3
    v_add_f32 v249, v0, v2
    v_cmp_lt_f32 vcc, s25, v249
    s_cbranch_vccnz L_gqa_attn_kernel_slow1
L_gqa_attn_kernel_res1:
    v_add_f32 v248, v248, v249
    v_cvt_pk_bf16_f32 v152, v136, v137
    v_cvt_pk_bf16_f32 v153, v138, v139
    v_cvt_pk_bf16_f32 v154, v140, v141
    v_cvt_pk_bf16_f32 v155, v142, v143
    v_cvt_pk_bf16_f32 v156, v144, v145
    v_cvt_pk_bf16_f32 v157, v146, v147
    v_cvt_pk_bf16_f32 v158, v148, v149
    v_cvt_pk_bf16_f32 v159, v150, v151
    s_mov_b32 s28, 6
L_gqa_attn_kernel_loop0:
    s_waitcnt lgkmcnt(0)
    s_waitcnt vmcnt(8)
    s_barrier
    v_add_u32 v232, 0x10000, v232
    v_add_u32 v233, 0x10000, v233
    v_add_u32 v234, 0x10000, v234
    v_add_u32 v235, 0x10000, v235
    v_add_u32 v236, 0x10000, v236
    v_add_u32 v237, 0x10000, v237
    v_add_u32 v238, 0x10000, v238
    v_add_u32 v239, 0x10000, v239
    v_add_u32 v240, 0x10000, v240
    v_add_u32 v241, 0x10000, v241
    v_add_u32 v242, 0x10000, v242
    v_add_u32 v243, 0x10000, v243
    v_mfma_f32_32x32x16_bf16 v[40:55], v[200:203], v[152:155], v[40:55]
    ds_read_b128 v[168:171], v232 offset:0
    ds_read_b128 v[172:175], v233 offset:0
    s_lshl_b32 s37, s29, 10
    s_add_u32 s37, s37, 32768
    s_mov_b32 m0, s37
    s_add_u32 s38, s26, 16384
    buffer_load_dwordx4 v244, s[8:11], s38 offen nt lds
    v_fma_f32 v136, v120, s24, -v247
    v_fma_f32 v137, v121, s24, -v247
    v_fma_f32 v138, v122, s24, -v247
    v_mfma_f32_32x32x16_bf16 v[56:71], v[208:211], v[152:155], v[56:71]
    ds_read_b128 v[176:179], v234 offset:0
    ds_read_b128 v[180:183], v235 offset:0
    s_lshl_b32 s37, s29, 10
    s_add_u32 s37, s37, 40960
    s_mov_b32 m0, s37
    s_add_u32 s38, s26, 24576
    buffer_load_dwordx4 v244, s[8:11], s38 offen nt lds
    v_fma_f32 v139, v123, s24, -v247
    v_fma_f32 v140, v124, s24, -v247
    v_fma_f32 v141, v125, s24, -v247
    v_mfma_f32_32x32x16_bf16 v[72:87], v[216:219], v[152:155], v[72:87]
    ds_read_b128 v[184:187], v236 offset:0
    ds_read_b128 v[188:191], v237 offset:0
    s_lshl_b32 s37, s29, 10
    s_add_u32 s37, s37, 49152
    s_mov_b32 m0, s37
    s_add_u32 s38, s26, 0
    buffer_load_dwordx4 v245, s[12:15], s38 offen nt lds
    v_exp_f32 v136, v136
    v_fma_f32 v142, v126, s24, -v247
    v_exp_f32 v137, v137
    v_mfma_f32_32x32x16_bf16 v[88:103], v[224:227], v[152:155], v[88:103]
    ds_read_b128 v[192:195], v238 offset:0
    ds_read_b128 v[196:199], v239 offset:0
    s_lshl_b32 s37, s29, 10
    s_add_u32 s37, s37, 57344
    s_mov_b32 m0, s37
    s_sub_u32 s38, s26, 8192
    buffer_load_dwordx4 v245, s[12:15], s38 offen nt lds
    v_fma_f32 v143, v127, s24, -v247
    v_exp_f32 v138, v138
    v_fma_f32 v144, v128, s24, -v247
    v_mfma_f32_32x32x16_bf16 v[40:55], v[204:207], v[156:159], v[40:55]
    s_add_u32 s26, s26, 16384
    v_exp_f32 v139, v139
    v_fma_f32 v145, v129, s24, -v247
    v_add_f32 v0, v136, v137
    v_mfma_f32_32x32x16_bf16 v[56:71], v[212:215], v[156:159], v[56:71]
    v_exp_f32 v140, v140
    v_fma_f32 v146, v130, s24, -v247
    v_exp_f32 v141, v141
    v_mfma_f32_32x32x16_bf16 v[72:87], v[220:223], v[156:159], v[72:87]
    v_fma_f32 v147, v131, s24, -v247
    v_add_f32 v1, v138, v139
    v_exp_f32 v142, v142
    v_mfma_f32_32x32x16_bf16 v[88:103], v[228:231], v[156:159], v[88:103]
    v_fma_f32 v148, v132, s24, -v247
    v_exp_f32 v143, v143
    v_fma_f32 v149, v133, s24, -v247
    s_waitcnt lgkmcnt(0)
    v_mfma_f32_32x32x16_bf16 v[104:119], v[168:171], v[8:11], 0
    ds_read_b64_tr_b16 v[200:201], v240 offset:0
    ds_read_b64_tr_b16 v[202:203], v240 offset:2048
    v_add_f32 v2, v140, v141
    v_exp_f32 v144, v144
    v_fma_f32 v150, v134, s24, -v247
    v_mfma_f32_32x32x16_bf16 v[104:119], v[172:175], v[12:15], v[104:119]
    ds_read_b64_tr_b16 v[208:209], v241 offset:0
    ds_read_b64_tr_b16 v[210:211], v241 offset:2048
    v_exp_f32 v145, v145
    v_fma_f32 v151, v135, s24, -v247
    v_add_f32 v3, v142, v143
    v_mfma_f32_32x32x16_bf16 v[104:119], v[176:179], v[16:19], v[104:119]
    ds_read_b64_tr_b16 v[216:217], v242 offset:0
    ds_read_b64_tr_b16 v[218:219], v242 offset:2048
    v_exp_f32 v146, v146
    v_exp_f32 v147, v147
    v_add_f32 v4, v144, v145
    v_mfma_f32_32x32x16_bf16 v[104:119], v[180:183], v[20:23], v[104:119]
    ds_read_b64_tr_b16 v[224:225], v243 offset:0
    ds_read_b64_tr_b16 v[226:227], v243 offset:2048
    v_exp_f32 v148, v148
    v_exp_f32 v149, v149
    v_add_f32 v5, v146, v147
    v_mfma_f32_32x32x16_bf16 v[104:119], v[184:187], v[24:27], v[104:119]
    ds_read_b64_tr_b16 v[204:205], v240 offset:4096
    ds_read_b64_tr_b16 v[206:207], v240 offset:6144
    v_exp_f32 v150, v150
    v_exp_f32 v151, v151
    v_add_f32 v6, v148, v149
    v_mfma_f32_32x32x16_bf16 v[104:119], v[188:191], v[28:31], v[104:119]
    ds_read_b64_tr_b16 v[212:213], v241 offset:4096
    ds_read_b64_tr_b16 v[214:215], v241 offset:6144
    v_add_f32 v7, v150, v151
    v_add_f32 v0, v0, v1
    v_add_f32 v1, v2, v3
    v_mfma_f32_32x32x16_bf16 v[104:119], v[192:195], v[32:35], v[104:119]
    ds_read_b64_tr_b16 v[220:221], v242 offset:4096
    ds_read_b64_tr_b16 v[222:223], v242 offset:6144
    v_add_f32 v2, v4, v5
    v_add_f32 v3, v6, v7
    v_mfma_f32_32x32x16_bf16 v[104:119], v[196:199], v[36:39], v[104:119]
    ds_read_b64_tr_b16 v[228:229], v243 offset:4096
    ds_read_b64_tr_b16 v[230:231], v243 offset:6144
    v_add_f32 v0, v0, v1
    v_add_f32 v2, v2, v3
    v_add_f32 v249, v0, v2
    v_cmp_lt_f32 vcc, s25, v249
    s_cbranch_vccnz L_gqa_attn_kernel_slow2
L_gqa_attn_kernel_res2:
    v_add_f32 v248, v248, v249
    v_cvt_pk_bf16_f32 v160, v136, v137
    v_cvt_pk_bf16_f32 v161, v138, v139
    v_cvt_pk_bf16_f32 v162, v140, v141
    v_cvt_pk_bf16_f32 v163, v142, v143
    v_cvt_pk_bf16_f32 v164, v144, v145
    v_cvt_pk_bf16_f32 v165, v146, v147
    v_cvt_pk_bf16_f32 v166, v148, v149
    v_cvt_pk_bf16_f32 v167, v150, v151
    s_waitcnt lgkmcnt(0)
    s_waitcnt vmcnt(8)
    s_barrier
    v_mfma_f32_32x32x16_bf16 v[40:55], v[200:203], v[160:163], v[40:55]
    ds_read_b128 v[168:171], v232 offset:32768
    ds_read_b128 v[172:175], v233 offset:32768
    s_lshl_b32 s37, s29, 10
    s_add_u32 s37, s37, 65536
    s_mov_b32 m0, s37
    s_add_u32 s38, s26, 16384
    buffer_load_dwordx4 v244, s[8:11], s38 offen nt lds
    v_fma_f32 v136, v104, s24, -v247
    v_fma_f32 v137, v105, s24, -v247
    v_fma_f32 v138, v106, s24, -v247
    v_mfma_f32_32x32x16_bf16 v[56:71], v[208:211], v[160:163], v[56:71]
    ds_read_b128 v[176:179], v234 offset:32768
    ds_read_b128 v[180:183], v235 offset:32768
    s_lshl_b32 s37, s29, 10
    s_add_u32 s37, s37, 73728
    s_mov_b32 m0, s37
    s_add_u32 s38, s26, 24576
    buffer_load_dwordx4 v244, s[8:11], s38 offen nt lds
    v_fma_f32 v139, v107, s24, -v247
    v_fma_f32 v140, v108, s24, -v247
    v_fma_f32 v141, v109, s24, -v247
    v_mfma_f32_32x32x16_bf16 v[72:87], v[216:219], v[160:163], v[72:87]
    ds_read_b128 v[184:187], v236 offset:32768
    ds_read_b128 v[188:191], v237 offset:32768
    s_lshl_b32 s37, s29, 10
    s_add_u32 s37, s37, 81920
    s_mov_b32 m0, s37
    s_add_u32 s38, s26, 0
    buffer_load_dwordx4 v245, s[12:15], s38 offen nt lds
    v_exp_f32 v136, v136
    v_fma_f32 v142, v110, s24, -v247
    v_exp_f32 v137, v137
    v_mfma_f32_32x32x16_bf16 v[88:103], v[224:227], v[160:163], v[88:103]
    ds_read_b128 v[192:195], v238 offset:32768
    ds_read_b128 v[196:199], v239 offset:32768
    s_lshl_b32 s37, s29, 10
    s_add_u32 s37, s37, 90112
    s_mov_b32 m0, s37
    s_sub_u32 s38, s26, 8192
    buffer_load_dwordx4 v245, s[12:15], s38 offen nt lds
    v_fma_f32 v143, v111, s24, -v247
    v_exp_f32 v138, v138
    v_fma_f32 v144, v112, s24, -v247
    v_mfma_f32_32x32x16_bf16 v[40:55], v[204:207], v[164:167], v[40:55]
    s_add_u32 s26, s26, 16384
    v_exp_f32 v139, v139
    v_fma_f32 v145, v113, s24, -v247
    v_add_f32 v0, v136, v137
    v_mfma_f32_32x32x16_bf16 v[56:71], v[212:215], v[164:167], v[56:71]
    v_exp_f32 v140, v140
    v_fma_f32 v146, v114, s24, -v247
    v_exp_f32 v141, v141
    v_mfma_f32_32x32x16_bf16 v[72:87], v[220:223], v[164:167], v[72:87]
    v_fma_f32 v147, v115, s24, -v247
    v_add_f32 v1, v138, v139
    v_exp_f32 v142, v142
    v_mfma_f32_32x32x16_bf16 v[88:103], v[228:231], v[164:167], v[88:103]
    v_fma_f32 v148, v116, s24, -v247
    v_exp_f32 v143, v143
    v_fma_f32 v149, v117, s24, -v247
    s_waitcnt lgkmcnt(0)
    v_mfma_f32_32x32x16_bf16 v[120:135], v[168:171], v[8:11], 0
    ds_read_b64_tr_b16 v[200:201], v240 offset:32768
    ds_read_b64_tr_b16 v[202:203], v240 offset:34816
    v_add_f32 v2, v140, v141
    v_exp_f32 v144, v144
    v_fma_f32 v150, v118, s24, -v247
    v_mfma_f32_32x32x16_bf16 v[120:135], v[172:175], v[12:15], v[120:135]
    ds_read_b64_tr_b16 v[208:209], v241 offset:32768
    ds_read_b64_tr_b16 v[210:211], v241 offset:34816
    v_exp_f32 v145, v145
    v_fma_f32 v151, v119, s24, -v247
    v_add_f32 v3, v142, v143
    v_mfma_f32_32x32x16_bf16 v[120:135], v[176:179], v[16:19], v[120:135]
    ds_read_b64_tr_b16 v[216:217], v242 offset:32768
    ds_read_b64_tr_b16 v[218:219], v242 offset:34816
    v_exp_f32 v146, v146
    v_exp_f32 v147, v147
    v_add_f32 v4, v144, v145
    v_mfma_f32_32x32x16_bf16 v[120:135], v[180:183], v[20:23], v[120:135]
    ds_read_b64_tr_b16 v[224:225], v243 offset:32768
    ds_read_b64_tr_b16 v[226:227], v243 offset:34816
    v_exp_f32 v148, v148
    v_exp_f32 v149, v149
    v_add_f32 v5, v146, v147
    v_mfma_f32_32x32x16_bf16 v[120:135], v[184:187], v[24:27], v[120:135]
    ds_read_b64_tr_b16 v[204:205], v240 offset:36864
    ds_read_b64_tr_b16 v[206:207], v240 offset:38912
    v_exp_f32 v150, v150
    v_exp_f32 v151, v151
    v_add_f32 v6, v148, v149
    v_mfma_f32_32x32x16_bf16 v[120:135], v[188:191], v[28:31], v[120:135]
    ds_read_b64_tr_b16 v[212:213], v241 offset:36864
    ds_read_b64_tr_b16 v[214:215], v241 offset:38912
    v_add_f32 v7, v150, v151
    v_add_f32 v0, v0, v1
    v_add_f32 v1, v2, v3
    v_mfma_f32_32x32x16_bf16 v[120:135], v[192:195], v[32:35], v[120:135]
    ds_read_b64_tr_b16 v[220:221], v242 offset:36864
    ds_read_b64_tr_b16 v[222:223], v242 offset:38912
    v_add_f32 v2, v4, v5
    v_add_f32 v3, v6, v7
    v_mfma_f32_32x32x16_bf16 v[120:135], v[196:199], v[36:39], v[120:135]
    ds_read_b64_tr_b16 v[228:229], v243 offset:36864
    ds_read_b64_tr_b16 v[230:231], v243 offset:38912
    v_add_f32 v0, v0, v1
    v_add_f32 v2, v2, v3
    v_add_f32 v249, v0, v2
    v_cmp_lt_f32 vcc, s25, v249
    s_cbranch_vccnz L_gqa_attn_kernel_slow3
L_gqa_attn_kernel_res3:
    v_add_f32 v248, v248, v249
    v_cvt_pk_bf16_f32 v152, v136, v137
    v_cvt_pk_bf16_f32 v153, v138, v139
    v_cvt_pk_bf16_f32 v154, v140, v141
    v_cvt_pk_bf16_f32 v155, v142, v143
    v_cvt_pk_bf16_f32 v156, v144, v145
    v_cvt_pk_bf16_f32 v157, v146, v147
    v_cvt_pk_bf16_f32 v158, v148, v149
    v_cvt_pk_bf16_f32 v159, v150, v151
    s_waitcnt lgkmcnt(0)
    s_waitcnt vmcnt(8)
    s_barrier
    v_subrev_u32 v232, 0x10000, v232
    v_subrev_u32 v233, 0x10000, v233
    v_subrev_u32 v234, 0x10000, v234
    v_subrev_u32 v235, 0x10000, v235
    v_subrev_u32 v236, 0x10000, v236
    v_subrev_u32 v237, 0x10000, v237
    v_subrev_u32 v238, 0x10000, v238
    v_subrev_u32 v239, 0x10000, v239
    v_subrev_u32 v240, 0x10000, v240
    v_subrev_u32 v241, 0x10000, v241
    v_subrev_u32 v242, 0x10000, v242
    v_subrev_u32 v243, 0x10000, v243
    v_mfma_f32_32x32x16_bf16 v[40:55], v[200:203], v[152:155], v[40:55]
    ds_read_b128 v[168:171], v232 offset:0
    ds_read_b128 v[172:175], v233 offset:0
    s_lshl_b32 s37, s29, 10
    s_add_u32 s37, s37, 98304
    s_mov_b32 m0, s37
    s_add_u32 s38, s26, 16384
    buffer_load_dwordx4 v244, s[8:11], s38 offen nt lds
    v_fma_f32 v136, v120, s24, -v247
    v_fma_f32 v137, v121, s24, -v247
    v_fma_f32 v138, v122, s24, -v247
    v_mfma_f32_32x32x16_bf16 v[56:71], v[208:211], v[152:155], v[56:71]
    ds_read_b128 v[176:179], v234 offset:0
    ds_read_b128 v[180:183], v235 offset:0
    s_lshl_b32 s37, s29, 10
    s_add_u32 s37, s37, 106496
    s_mov_b32 m0, s37
    s_add_u32 s38, s26, 24576
    buffer_load_dwordx4 v244, s[8:11], s38 offen nt lds
    v_fma_f32 v139, v123, s24, -v247
    v_fma_f32 v140, v124, s24, -v247
    v_fma_f32 v141, v125, s24, -v247
    v_mfma_f32_32x32x16_bf16 v[72:87], v[216:219], v[152:155], v[72:87]
    ds_read_b128 v[184:187], v236 offset:0
    ds_read_b128 v[188:191], v237 offset:0
    s_lshl_b32 s37, s29, 10
    s_add_u32 s37, s37, 114688
    s_mov_b32 m0, s37
    s_add_u32 s38, s26, 0
    buffer_load_dwordx4 v245, s[12:15], s38 offen nt lds
    v_exp_f32 v136, v136
    v_fma_f32 v142, v126, s24, -v247
    v_exp_f32 v137, v137
    v_mfma_f32_32x32x16_bf16 v[88:103], v[224:227], v[152:155], v[88:103]
    ds_read_b128 v[192:195], v238 offset:0
    ds_read_b128 v[196:199], v239 offset:0
    s_lshl_b32 s37, s29, 10
    s_add_u32 s37, s37, 122880
    s_mov_b32 m0, s37
    s_sub_u32 s38, s26, 8192
    buffer_load_dwordx4 v245, s[12:15], s38 offen nt lds
    v_fma_f32 v143, v127, s24, -v247
    v_exp_f32 v138, v138
    v_fma_f32 v144, v128, s24, -v247
    v_mfma_f32_32x32x16_bf16 v[40:55], v[204:207], v[156:159], v[40:55]
    s_add_u32 s26, s26, 16384
    v_exp_f32 v139, v139
    v_fma_f32 v145, v129, s24, -v247
    v_add_f32 v0, v136, v137
    v_mfma_f32_32x32x16_bf16 v[56:71], v[212:215], v[156:159], v[56:71]
    v_exp_f32 v140, v140
    v_fma_f32 v146, v130, s24, -v247
    v_exp_f32 v141, v141
    v_mfma_f32_32x32x16_bf16 v[72:87], v[220:223], v[156:159], v[72:87]
    v_fma_f32 v147, v131, s24, -v247
    v_add_f32 v1, v138, v139
    v_exp_f32 v142, v142
    v_mfma_f32_32x32x16_bf16 v[88:103], v[228:231], v[156:159], v[88:103]
    v_fma_f32 v148, v132, s24, -v247
    v_exp_f32 v143, v143
    v_fma_f32 v149, v133, s24, -v247
    s_waitcnt lgkmcnt(0)
    v_mfma_f32_32x32x16_bf16 v[104:119], v[168:171], v[8:11], 0
    ds_read_b64_tr_b16 v[200:201], v240 offset:0
    ds_read_b64_tr_b16 v[202:203], v240 offset:2048
    v_add_f32 v2, v140, v141
    v_exp_f32 v144, v144
    v_fma_f32 v150, v134, s24, -v247
    v_mfma_f32_32x32x16_bf16 v[104:119], v[172:175], v[12:15], v[104:119]
    ds_read_b64_tr_b16 v[208:209], v241 offset:0
    ds_read_b64_tr_b16 v[210:211], v241 offset:2048
    v_exp_f32 v145, v145
    v_fma_f32 v151, v135, s24, -v247
    v_add_f32 v3, v142, v143
    v_mfma_f32_32x32x16_bf16 v[104:119], v[176:179], v[16:19], v[104:119]
    ds_read_b64_tr_b16 v[216:217], v242 offset:0
    ds_read_b64_tr_b16 v[218:219], v242 offset:2048
    v_exp_f32 v146, v146
    v_exp_f32 v147, v147
    v_add_f32 v4, v144, v145
    v_mfma_f32_32x32x16_bf16 v[104:119], v[180:183], v[20:23], v[104:119]
    ds_read_b64_tr_b16 v[224:225], v243 offset:0
    ds_read_b64_tr_b16 v[226:227], v243 offset:2048
    v_exp_f32 v148, v148
    v_exp_f32 v149, v149
    v_add_f32 v5, v146, v147
    v_mfma_f32_32x32x16_bf16 v[104:119], v[184:187], v[24:27], v[104:119]
    ds_read_b64_tr_b16 v[204:205], v240 offset:4096
    ds_read_b64_tr_b16 v[206:207], v240 offset:6144
    v_exp_f32 v150, v150
    v_exp_f32 v151, v151
    v_add_f32 v6, v148, v149
    v_mfma_f32_32x32x16_bf16 v[104:119], v[188:191], v[28:31], v[104:119]
    ds_read_b64_tr_b16 v[212:213], v241 offset:4096
    ds_read_b64_tr_b16 v[214:215], v241 offset:6144
    v_add_f32 v7, v150, v151
    v_add_f32 v0, v0, v1
    v_add_f32 v1, v2, v3
    v_mfma_f32_32x32x16_bf16 v[104:119], v[192:195], v[32:35], v[104:119]
    ds_read_b64_tr_b16 v[220:221], v242 offset:4096
    ds_read_b64_tr_b16 v[222:223], v242 offset:6144
    v_add_f32 v2, v4, v5
    v_add_f32 v3, v6, v7
    v_mfma_f32_32x32x16_bf16 v[104:119], v[196:199], v[36:39], v[104:119]
    ds_read_b64_tr_b16 v[228:229], v243 offset:4096
    ds_read_b64_tr_b16 v[230:231], v243 offset:6144
    v_add_f32 v0, v0, v1
    v_add_f32 v2, v2, v3
    v_add_f32 v249, v0, v2
    v_cmp_lt_f32 vcc, s25, v249
    s_cbranch_vccnz L_gqa_attn_kernel_slow4
L_gqa_attn_kernel_res4:
    v_add_f32 v248, v248, v249
    v_cvt_pk_bf16_f32 v160, v136, v137
    v_cvt_pk_bf16_f32 v161, v138, v139
    v_cvt_pk_bf16_f32 v162, v140, v141
    v_cvt_pk_bf16_f32 v163, v142, v143
    v_cvt_pk_bf16_f32 v164, v144, v145
    v_cvt_pk_bf16_f32 v165, v146, v147
    v_cvt_pk_bf16_f32 v166, v148, v149
    v_cvt_pk_bf16_f32 v167, v150, v151
    s_waitcnt lgkmcnt(0)
    s_waitcnt vmcnt(8)
    s_barrier
    v_mfma_f32_32x32x16_bf16 v[40:55], v[200:203], v[160:163], v[40:55]
    ds_read_b128 v[168:171], v232 offset:32768
    ds_read_b128 v[172:175], v233 offset:32768
    s_lshl_b32 s37, s29, 10
    s_add_u32 s37, s37, 0
    s_mov_b32 m0, s37
    s_add_u32 s38, s26, 16384
    buffer_load_dwordx4 v244, s[8:11], s38 offen nt lds
    v_fma_f32 v136, v104, s24, -v247
    v_fma_f32 v137, v105, s24, -v247
    v_fma_f32 v138, v106, s24, -v247
    v_mfma_f32_32x32x16_bf16 v[56:71], v[208:211], v[160:163], v[56:71]
    ds_read_b128 v[176:179], v234 offset:32768
    ds_read_b128 v[180:183], v235 offset:32768
    s_lshl_b32 s37, s29, 10
    s_add_u32 s37, s37, 8192
    s_mov_b32 m0, s37
    s_add_u32 s38, s26, 24576
    buffer_load_dwordx4 v244, s[8:11], s38 offen nt lds
    v_fma_f32 v139, v107, s24, -v247
    v_fma_f32 v140, v108, s24, -v247
    v_fma_f32 v141, v109, s24, -v247
    v_mfma_f32_32x32x16_bf16 v[72:87], v[216:219], v[160:163], v[72:87]
    ds_read_b128 v[184:187], v236 offset:32768
    ds_read_b128 v[188:191], v237 offset:32768
    s_lshl_b32 s37, s29, 10
    s_add_u32 s37, s37, 16384
    s_mov_b32 m0, s37
    s_add_u32 s38, s26, 0
    buffer_load_dwordx4 v245, s[12:15], s38 offen nt lds
    v_exp_f32 v136, v136
    v_fma_f32 v142, v110, s24, -v247
    v_exp_f32 v137, v137
    v_mfma_f32_32x32x16_bf16 v[88:103], v[224:227], v[160:163], v[88:103]
    ds_read_b128 v[192:195], v238 offset:32768
    ds_read_b128 v[196:199], v239 offset:32768
    s_lshl_b32 s37, s29, 10
    s_add_u32 s37, s37, 24576
    s_mov_b32 m0, s37
    s_sub_u32 s38, s26, 8192
    buffer_load_dwordx4 v245, s[12:15], s38 offen nt lds
    v_fma_f32 v143, v111, s24, -v247
    v_exp_f32 v138, v138
    v_fma_f32 v144, v112, s24, -v247
    v_mfma_f32_32x32x16_bf16 v[40:55], v[204:207], v[164:167], v[40:55]
    s_add_u32 s26, s26, 16384
    v_exp_f32 v139, v139
    v_fma_f32 v145, v113, s24, -v247
    v_add_f32 v0, v136, v137
    v_mfma_f32_32x32x16_bf16 v[56:71], v[212:215], v[164:167], v[56:71]
    v_exp_f32 v140, v140
    v_fma_f32 v146, v114, s24, -v247
    v_exp_f32 v141, v141
    v_mfma_f32_32x32x16_bf16 v[72:87], v[220:223], v[164:167], v[72:87]
    v_fma_f32 v147, v115, s24, -v247
    v_add_f32 v1, v138, v139
    v_exp_f32 v142, v142
    v_mfma_f32_32x32x16_bf16 v[88:103], v[228:231], v[164:167], v[88:103]
    v_fma_f32 v148, v116, s24, -v247
    v_exp_f32 v143, v143
    v_fma_f32 v149, v117, s24, -v247
    s_waitcnt lgkmcnt(0)
    v_mfma_f32_32x32x16_bf16 v[120:135], v[168:171], v[8:11], 0
    ds_read_b64_tr_b16 v[200:201], v240 offset:32768
    ds_read_b64_tr_b16 v[202:203], v240 offset:34816
    v_add_f32 v2, v140, v141
    v_exp_f32 v144, v144
    v_fma_f32 v150, v118, s24, -v247
    v_mfma_f32_32x32x16_bf16 v[120:135], v[172:175], v[12:15], v[120:135]
    ds_read_b64_tr_b16 v[208:209], v241 offset:32768
    ds_read_b64_tr_b16 v[210:211], v241 offset:34816
    v_exp_f32 v145, v145
    v_fma_f32 v151, v119, s24, -v247
    v_add_f32 v3, v142, v143
    v_mfma_f32_32x32x16_bf16 v[120:135], v[176:179], v[16:19], v[120:135]
    ds_read_b64_tr_b16 v[216:217], v242 offset:32768
    ds_read_b64_tr_b16 v[218:219], v242 offset:34816
    v_exp_f32 v146, v146
    v_exp_f32 v147, v147
    v_add_f32 v4, v144, v145
    v_mfma_f32_32x32x16_bf16 v[120:135], v[180:183], v[20:23], v[120:135]
    ds_read_b64_tr_b16 v[224:225], v243 offset:32768
    ds_read_b64_tr_b16 v[226:227], v243 offset:34816
    v_exp_f32 v148, v148
    v_exp_f32 v149, v149
    v_add_f32 v5, v146, v147
    v_mfma_f32_32x32x16_bf16 v[120:135], v[184:187], v[24:27], v[120:135]
    ds_read_b64_tr_b16 v[204:205], v240 offset:36864
    ds_read_b64_tr_b16 v[206:207], v240 offset:38912
    v_exp_f32 v150, v150
    v_exp_f32 v151, v151
    v_add_f32 v6, v148, v149
    v_mfma_f32_32x32x16_bf16 v[120:135], v[188:191], v[28:31], v[120:135]
    ds_read_b64_tr_b16 v[212:213], v241 offset:36864
    ds_read_b64_tr_b16 v[214:215], v241 offset:38912
    v_add_f32 v7, v150, v151
    v_add_f32 v0, v0, v1
    v_add_f32 v1, v2, v3
    v_mfma_f32_32x32x16_bf16 v[120:135], v[192:195], v[32:35], v[120:135]
    ds_read_b64_tr_b16 v[220:221], v242 offset:36864
    ds_read_b64_tr_b16 v[222:223], v242 offset:38912
    v_add_f32 v2, v4, v5
    v_add_f32 v3, v6, v7
    v_mfma_f32_32x32x16_bf16 v[120:135], v[196:199], v[36:39], v[120:135]
    ds_read_b64_tr_b16 v[228:229], v243 offset:36864
    ds_read_b64_tr_b16 v[230:231], v243 offset:38912
    v_add_f32 v0, v0, v1
    v_add_f32 v2, v2, v3
    v_add_f32 v249, v0, v2
    v_cmp_lt_f32 vcc, s25, v249
    s_cbranch_vccnz L_gqa_attn_kernel_slow5
L_gqa_attn_kernel_res5:
    v_add_f32 v248, v248, v249
    v_cvt_pk_bf16_f32 v152, v136, v137
    v_cvt_pk_bf16_f32 v153, v138, v139
    v_cvt_pk_bf16_f32 v154, v140, v141
    v_cvt_pk_bf16_f32 v155, v142, v143
    v_cvt_pk_bf16_f32 v156, v144, v145
    v_cvt_pk_bf16_f32 v157, v146, v147
    v_cvt_pk_bf16_f32 v158, v148, v149
    v_cvt_pk_bf16_f32 v159, v150, v151
    s_sub_u32 s28, s28, 1
    s_cmp_lg_u32 s28, 0
    s_cbranch_scc1 L_gqa_attn_kernel_loop0
    s_waitcnt lgkmcnt(0)
    s_waitcnt vmcnt(8)
    s_barrier
    v_add_u32 v232, 0x10000, v232
    v_add_u32 v233, 0x10000, v233
    v_add_u32 v234, 0x10000, v234
    v_add_u32 v235, 0x10000, v235
    v_add_u32 v236, 0x10000, v236
    v_add_u32 v237, 0x10000, v237
    v_add_u32 v238, 0x10000, v238
    v_add_u32 v239, 0x10000, v239
    v_add_u32 v240, 0x10000, v240
    v_add_u32 v241, 0x10000, v241
    v_add_u32 v242, 0x10000, v242
    v_add_u32 v243, 0x10000, v243
    v_mfma_f32_32x32x16_bf16 v[40:55], v[200:203], v[152:155], v[40:55]
    ds_read_b128 v[168:171], v232 offset:0
    ds_read_b128 v[172:175], v233 offset:0
    s_lshl_b32 s37, s29, 10
    s_add_u32 s37, s37, 32768
    s_mov_b32 m0, s37
    s_add_u32 s38, s26, 16384
    buffer_load_dwordx4 v244, s[8:11], s38 offen nt lds
    v_fma_f32 v136, v120, s24, -v247
    v_fma_f32 v137, v121, s24, -v247
    v_fma_f32 v138, v122, s24, -v247
    v_mfma_f32_32x32x16_bf16 v[56:71], v[208:211], v[152:155], v[56:71]
    ds_read_b128 v[176:179], v234 offset:0
    ds_read_b128 v[180:183], v235 offset:0
    s_lshl_b32 s37, s29, 10
    s_add_u32 s37, s37, 40960
    s_mov_b32 m0, s37
    s_add_u32 s38, s26, 24576
    buffer_load_dwordx4 v244, s[8:11], s38 offen nt lds
    v_fma_f32 v139, v123, s24, -v247
    v_fma_f32 v140, v124, s24, -v247
    v_fma_f32 v141, v125, s24, -v247
    v_mfma_f32_32x32x16_bf16 v[72:87], v[216:219], v[152:155], v[72:87]
    ds_read_b128 v[184:187], v236 offset:0
    ds_read_b128 v[188:191], v237 offset:0
    s_lshl_b32 s37, s29, 10
    s_add_u32 s37, s37, 49152
    s_mov_b32 m0, s37
    s_add_u32 s38, s26, 0
    buffer_load_dwordx4 v245, s[12:15], s38 offen nt lds
    v_exp_f32 v136, v136
    v_fma_f32 v142, v126, s24, -v247
    v_exp_f32 v137, v137
    v_mfma_f32_32x32x16_bf16 v[88:103], v[224:227], v[152:155], v[88:103]
    ds_read_b128 v[192:195], v238 offset:0
    ds_read_b128 v[196:199], v239 offset:0
    s_lshl_b32 s37, s29, 10
    s_add_u32 s37, s37, 57344
    s_mov_b32 m0, s37
    s_sub_u32 s38, s26, 8192
    buffer_load_dwordx4 v245, s[12:15], s38 offen nt lds
    v_fma_f32 v143, v127, s24, -v247
    v_exp_f32 v138, v138
    v_fma_f32 v144, v128, s24, -v247
    v_mfma_f32_32x32x16_bf16 v[40:55], v[204:207], v[156:159], v[40:55]
    s_add_u32 s26, s26, 16384
    v_exp_f32 v139, v139
    v_fma_f32 v145, v129, s24, -v247
    v_add_f32 v0, v136, v137
    v_mfma_f32_32x32x16_bf16 v[56:71], v[212:215], v[156:159], v[56:71]
    v_exp_f32 v140, v140
    v_fma_f32 v146, v130, s24, -v247
    v_exp_f32 v141, v141
    v_mfma_f32_32x32x16_bf16 v[72:87], v[220:223], v[156:159], v[72:87]
    v_fma_f32 v147, v131, s24, -v247
    v_add_f32 v1, v138, v139
    v_exp_f32 v142, v142
    v_mfma_f32_32x32x16_bf16 v[88:103], v[228:231], v[156:159], v[88:103]
    v_fma_f32 v148, v132, s24, -v247
    v_exp_f32 v143, v143
    v_fma_f32 v149, v133, s24, -v247
    s_waitcnt lgkmcnt(0)
    v_mfma_f32_32x32x16_bf16 v[104:119], v[168:171], v[8:11], 0
    ds_read_b64_tr_b16 v[200:201], v240 offset:0
    ds_read_b64_tr_b16 v[202:203], v240 offset:2048
    v_add_f32 v2, v140, v141
    v_exp_f32 v144, v144
    v_fma_f32 v150, v134, s24, -v247
    v_mfma_f32_32x32x16_bf16 v[104:119], v[172:175], v[12:15], v[104:119]
    ds_read_b64_tr_b16 v[208:209], v241 offset:0
    ds_read_b64_tr_b16 v[210:211], v241 offset:2048
    v_exp_f32 v145, v145
    v_fma_f32 v151, v135, s24, -v247
    v_add_f32 v3, v142, v143
    v_mfma_f32_32x32x16_bf16 v[104:119], v[176:179], v[16:19], v[104:119]
    ds_read_b64_tr_b16 v[216:217], v242 offset:0
    ds_read_b64_tr_b16 v[218:219], v242 offset:2048
    v_exp_f32 v146, v146
    v_exp_f32 v147, v147
    v_add_f32 v4, v144, v145
    v_mfma_f32_32x32x16_bf16 v[104:119], v[180:183], v[20:23], v[104:119]
    ds_read_b64_tr_b16 v[224:225], v243 offset:0
    ds_read_b64_tr_b16 v[226:227], v243 offset:2048
    v_exp_f32 v148, v148
    v_exp_f32 v149, v149
    v_add_f32 v5, v146, v147
    v_mfma_f32_32x32x16_bf16 v[104:119], v[184:187], v[24:27], v[104:119]
    ds_read_b64_tr_b16 v[204:205], v240 offset:4096
    ds_read_b64_tr_b16 v[206:207], v240 offset:6144
    v_exp_f32 v150, v150
    v_exp_f32 v151, v151
    v_add_f32 v6, v148, v149
    v_mfma_f32_32x32x16_bf16 v[104:119], v[188:191], v[28:31], v[104:119]
    ds_read_b64_tr_b16 v[212:213], v241 offset:4096
    ds_read_b64_tr_b16 v[214:215], v241 offset:6144
    v_add_f32 v7, v150, v151
    v_add_f32 v0, v0, v1
    v_add_f32 v1, v2, v3
    v_mfma_f32_32x32x16_bf16 v[104:119], v[192:195], v[32:35], v[104:119]
    ds_read_b64_tr_b16 v[220:221], v242 offset:4096
    ds_read_b64_tr_b16 v[222:223], v242 offset:6144
    v_add_f32 v2, v4, v5
    v_add_f32 v3, v6, v7
    v_mfma_f32_32x32x16_bf16 v[104:119], v[196:199], v[36:39], v[104:119]
    ds_read_b64_tr_b16 v[228:229], v243 offset:4096
    ds_read_b64_tr_b16 v[230:231], v243 offset:6144
    v_add_f32 v0, v0, v1
    v_add_f32 v2, v2, v3
    v_add_f32 v249, v0, v2
    v_cmp_lt_f32 vcc, s25, v249
    s_cbranch_vccnz L_gqa_attn_kernel_slow6
L_gqa_attn_kernel_res6:
    v_add_f32 v248, v248, v249
    v_cvt_pk_bf16_f32 v160, v136, v137
    v_cvt_pk_bf16_f32 v161, v138, v139
    v_cvt_pk_bf16_f32 v162, v140, v141
    v_cvt_pk_bf16_f32 v163, v142, v143
    v_cvt_pk_bf16_f32 v164, v144, v145
    v_cvt_pk_bf16_f32 v165, v146, v147
    v_cvt_pk_bf16_f32 v166, v148, v149
    v_cvt_pk_bf16_f32 v167, v150, v151
    s_waitcnt lgkmcnt(0)
    s_waitcnt vmcnt(8)
    s_barrier
    v_mfma_f32_32x32x16_bf16 v[40:55], v[200:203], v[160:163], v[40:55]
    ds_read_b128 v[168:171], v232 offset:32768
    ds_read_b128 v[172:175], v233 offset:32768
    s_lshl_b32 s37, s29, 10
    s_add_u32 s37, s37, 65536
    s_mov_b32 m0, s37
    s_add_u32 s38, s26, 16384
    buffer_load_dwordx4 v244, s[8:11], s38 offen nt lds
    v_fma_f32 v136, v104, s24, -v247
    v_fma_f32 v137, v105, s24, -v247
    v_fma_f32 v138, v106, s24, -v247
    v_mfma_f32_32x32x16_bf16 v[56:71], v[208:211], v[160:163], v[56:71]
    ds_read_b128 v[176:179], v234 offset:32768
    ds_read_b128 v[180:183], v235 offset:32768
    s_lshl_b32 s37, s29, 10
    s_add_u32 s37, s37, 73728
    s_mov_b32 m0, s37
    s_add_u32 s38, s26, 24576
    buffer_load_dwordx4 v244, s[8:11], s38 offen nt lds
    v_fma_f32 v139, v107, s24, -v247
    v_fma_f32 v140, v108, s24, -v247
    v_fma_f32 v141, v109, s24, -v247
    v_mfma_f32_32x32x16_bf16 v[72:87], v[216:219], v[160:163], v[72:87]
    ds_read_b128 v[184:187], v236 offset:32768
    ds_read_b128 v[188:191], v237 offset:32768
    s_lshl_b32 s37, s29, 10
    s_add_u32 s37, s37, 81920
    s_mov_b32 m0, s37
    s_add_u32 s38, s26, 0
    buffer_load_dwordx4 v245, s[12:15], s38 offen nt lds
    v_exp_f32 v136, v136
    v_fma_f32 v142, v110, s24, -v247
    v_exp_f32 v137, v137
    v_mfma_f32_32x32x16_bf16 v[88:103], v[224:227], v[160:163], v[88:103]
    ds_read_b128 v[192:195], v238 offset:32768
    ds_read_b128 v[196:199], v239 offset:32768
    s_lshl_b32 s37, s29, 10
    s_add_u32 s37, s37, 90112
    s_mov_b32 m0, s37
    s_sub_u32 s38, s26, 8192
    buffer_load_dwordx4 v245, s[12:15], s38 offen nt lds
    v_fma_f32 v143, v111, s24, -v247
    v_exp_f32 v138, v138
    v_fma_f32 v144, v112, s24, -v247
    v_mfma_f32_32x32x16_bf16 v[40:55], v[204:207], v[164:167], v[40:55]
    s_add_u32 s26, s26, 16384
    v_exp_f32 v139, v139
    v_fma_f32 v145, v113, s24, -v247
    v_add_f32 v0, v136, v137
    v_mfma_f32_32x32x16_bf16 v[56:71], v[212:215], v[164:167], v[56:71]
    v_exp_f32 v140, v140
    v_fma_f32 v146, v114, s24, -v247
    v_exp_f32 v141, v141
    v_mfma_f32_32x32x16_bf16 v[72:87], v[220:223], v[164:167], v[72:87]
    v_fma_f32 v147, v115, s24, -v247
    v_add_f32 v1, v138, v139
    v_exp_f32 v142, v142
    v_mfma_f32_32x32x16_bf16 v[88:103], v[228:231], v[164:167], v[88:103]
    v_fma_f32 v148, v116, s24, -v247
    v_exp_f32 v143, v143
    v_fma_f32 v149, v117, s24, -v247
    s_waitcnt lgkmcnt(0)
    v_mfma_f32_32x32x16_bf16 v[120:135], v[168:171], v[8:11], 0
    ds_read_b64_tr_b16 v[200:201], v240 offset:32768
    ds_read_b64_tr_b16 v[202:203], v240 offset:34816
    v_add_f32 v2, v140, v141
    v_exp_f32 v144, v144
    v_fma_f32 v150, v118, s24, -v247
    v_mfma_f32_32x32x16_bf16 v[120:135], v[172:175], v[12:15], v[120:135]
    ds_read_b64_tr_b16 v[208:209], v241 offset:32768
    ds_read_b64_tr_b16 v[210:211], v241 offset:34816
    v_exp_f32 v145, v145
    v_fma_f32 v151, v119, s24, -v247
    v_add_f32 v3, v142, v143
    v_mfma_f32_32x32x16_bf16 v[120:135], v[176:179], v[16:19], v[120:135]
    ds_read_b64_tr_b16 v[216:217], v242 offset:32768
    ds_read_b64_tr_b16 v[218:219], v242 offset:34816
    v_exp_f32 v146, v146
    v_exp_f32 v147, v147
    v_add_f32 v4, v144, v145
    v_mfma_f32_32x32x16_bf16 v[120:135], v[180:183], v[20:23], v[120:135]
    ds_read_b64_tr_b16 v[224:225], v243 offset:32768
    ds_read_b64_tr_b16 v[226:227], v243 offset:34816
    v_exp_f32 v148, v148
    v_exp_f32 v149, v149
    v_add_f32 v5, v146, v147
    v_mfma_f32_32x32x16_bf16 v[120:135], v[184:187], v[24:27], v[120:135]
    ds_read_b64_tr_b16 v[204:205], v240 offset:36864
    ds_read_b64_tr_b16 v[206:207], v240 offset:38912
    v_exp_f32 v150, v150
    v_exp_f32 v151, v151
    v_add_f32 v6, v148, v149
    v_mfma_f32_32x32x16_bf16 v[120:135], v[188:191], v[28:31], v[120:135]
    ds_read_b64_tr_b16 v[212:213], v241 offset:36864
    ds_read_b64_tr_b16 v[214:215], v241 offset:38912
    v_add_f32 v7, v150, v151
    v_add_f32 v0, v0, v1
    v_add_f32 v1, v2, v3
    v_mfma_f32_32x32x16_bf16 v[120:135], v[192:195], v[32:35], v[120:135]
    ds_read_b64_tr_b16 v[220:221], v242 offset:36864
    ds_read_b64_tr_b16 v[222:223], v242 offset:38912
    v_add_f32 v2, v4, v5
    v_add_f32 v3, v6, v7
    v_mfma_f32_32x32x16_bf16 v[120:135], v[196:199], v[36:39], v[120:135]
    ds_read_b64_tr_b16 v[228:229], v243 offset:36864
    ds_read_b64_tr_b16 v[230:231], v243 offset:38912
    v_add_f32 v0, v0, v1
    v_add_f32 v2, v2, v3
    v_add_f32 v249, v0, v2
    v_cmp_lt_f32 vcc, s25, v249
    s_cbranch_vccnz L_gqa_attn_kernel_slow7
L_gqa_attn_kernel_res7:
    v_add_f32 v248, v248, v249
    v_cvt_pk_bf16_f32 v152, v136, v137
    v_cvt_pk_bf16_f32 v153, v138, v139
    v_cvt_pk_bf16_f32 v154, v140, v141
    v_cvt_pk_bf16_f32 v155, v142, v143
    v_cvt_pk_bf16_f32 v156, v144, v145
    v_cvt_pk_bf16_f32 v157, v146, v147
    v_cvt_pk_bf16_f32 v158, v148, v149
    v_cvt_pk_bf16_f32 v159, v150, v151
    s_waitcnt lgkmcnt(0)
    s_waitcnt vmcnt(8)
    s_barrier
    v_subrev_u32 v232, 0x10000, v232
    v_subrev_u32 v233, 0x10000, v233
    v_subrev_u32 v234, 0x10000, v234
    v_subrev_u32 v235, 0x10000, v235
    v_subrev_u32 v236, 0x10000, v236
    v_subrev_u32 v237, 0x10000, v237
    v_subrev_u32 v238, 0x10000, v238
    v_subrev_u32 v239, 0x10000, v239
    v_subrev_u32 v240, 0x10000, v240
    v_subrev_u32 v241, 0x10000, v241
    v_subrev_u32 v242, 0x10000, v242
    v_subrev_u32 v243, 0x10000, v243
    v_mfma_f32_32x32x16_bf16 v[40:55], v[200:203], v[152:155], v[40:55]
    ds_read_b128 v[168:171], v232 offset:0
    ds_read_b128 v[172:175], v233 offset:0
    s_lshl_b32 s37, s29, 10
    s_add_u32 s37, s37, 98304
    s_mov_b32 m0, s37
    s_add_u32 s38, s26, 16384
    buffer_load_dwordx4 v244, s[8:11], s38 offen nt lds
    v_fma_f32 v136, v120, s24, -v247
    v_fma_f32 v137, v121, s24, -v247
    v_fma_f32 v138, v122, s24, -v247
    v_mfma_f32_32x32x16_bf16 v[56:71], v[208:211], v[152:155], v[56:71]
    ds_read_b128 v[176:179], v234 offset:0
    ds_read_b128 v[180:183], v235 offset:0
    s_lshl_b32 s37, s29, 10
    s_add_u32 s37, s37, 106496
    s_mov_b32 m0, s37
    s_add_u32 s38, s26, 24576
    buffer_load_dwordx4 v244, s[8:11], s38 offen nt lds
    v_fma_f32 v139, v123, s24, -v247
    v_fma_f32 v140, v124, s24, -v247
    v_fma_f32 v141, v125, s24, -v247
    v_mfma_f32_32x32x16_bf16 v[72:87], v[216:219], v[152:155], v[72:87]
    ds_read_b128 v[184:187], v236 offset:0
    ds_read_b128 v[188:191], v237 offset:0
    s_lshl_b32 s37, s29, 10
    s_add_u32 s37, s37, 114688
    s_mov_b32 m0, s37
    s_add_u32 s38, s26, 0
    buffer_load_dwordx4 v245, s[12:15], s38 offen nt lds
    v_exp_f32 v136, v136
    v_fma_f32 v142, v126, s24, -v247
    v_exp_f32 v137, v137
    v_mfma_f32_32x32x16_bf16 v[88:103], v[224:227], v[152:155], v[88:103]
    ds_read_b128 v[192:195], v238 offset:0
    ds_read_b128 v[196:199], v239 offset:0
    s_lshl_b32 s37, s29, 10
    s_add_u32 s37, s37, 122880
    s_mov_b32 m0, s37
    s_sub_u32 s38, s26, 8192
    buffer_load_dwordx4 v245, s[12:15], s38 offen nt lds
    v_fma_f32 v143, v127, s24, -v247
    v_exp_f32 v138, v138
    v_fma_f32 v144, v128, s24, -v247
    v_mfma_f32_32x32x16_bf16 v[40:55], v[204:207], v[156:159], v[40:55]
    s_add_u32 s26, s26, 16384
    v_exp_f32 v139, v139
    v_fma_f32 v145, v129, s24, -v247
    v_add_f32 v0, v136, v137
    v_mfma_f32_32x32x16_bf16 v[56:71], v[212:215], v[156:159], v[56:71]
    v_exp_f32 v140, v140
    v_fma_f32 v146, v130, s24, -v247
    v_exp_f32 v141, v141
    v_mfma_f32_32x32x16_bf16 v[72:87], v[220:223], v[156:159], v[72:87]
    v_fma_f32 v147, v131, s24, -v247
    v_add_f32 v1, v138, v139
    v_exp_f32 v142, v142
    v_mfma_f32_32x32x16_bf16 v[88:103], v[228:231], v[156:159], v[88:103]
    v_fma_f32 v148, v132, s24, -v247
    v_exp_f32 v143, v143
    v_fma_f32 v149, v133, s24, -v247
    s_waitcnt lgkmcnt(0)
    v_mfma_f32_32x32x16_bf16 v[104:119], v[168:171], v[8:11], 0
    ds_read_b64_tr_b16 v[200:201], v240 offset:0
    ds_read_b64_tr_b16 v[202:203], v240 offset:2048
    v_add_f32 v2, v140, v141
    v_exp_f32 v144, v144
    v_fma_f32 v150, v134, s24, -v247
    v_mfma_f32_32x32x16_bf16 v[104:119], v[172:175], v[12:15], v[104:119]
    ds_read_b64_tr_b16 v[208:209], v241 offset:0
    ds_read_b64_tr_b16 v[210:211], v241 offset:2048
    v_exp_f32 v145, v145
    v_fma_f32 v151, v135, s24, -v247
    v_add_f32 v3, v142, v143
    v_mfma_f32_32x32x16_bf16 v[104:119], v[176:179], v[16:19], v[104:119]
    ds_read_b64_tr_b16 v[216:217], v242 offset:0
    ds_read_b64_tr_b16 v[218:219], v242 offset:2048
    v_exp_f32 v146, v146
    v_exp_f32 v147, v147
    v_add_f32 v4, v144, v145
    v_mfma_f32_32x32x16_bf16 v[104:119], v[180:183], v[20:23], v[104:119]
    ds_read_b64_tr_b16 v[224:225], v243 offset:0
    ds_read_b64_tr_b16 v[226:227], v243 offset:2048
    v_exp_f32 v148, v148
    v_exp_f32 v149, v149
    v_add_f32 v5, v146, v147
    v_mfma_f32_32x32x16_bf16 v[104:119], v[184:187], v[24:27], v[104:119]
    ds_read_b64_tr_b16 v[204:205], v240 offset:4096
    ds_read_b64_tr_b16 v[206:207], v240 offset:6144
    v_exp_f32 v150, v150
    v_exp_f32 v151, v151
    v_add_f32 v6, v148, v149
    v_mfma_f32_32x32x16_bf16 v[104:119], v[188:191], v[28:31], v[104:119]
    ds_read_b64_tr_b16 v[212:213], v241 offset:4096
    ds_read_b64_tr_b16 v[214:215], v241 offset:6144
    v_add_f32 v7, v150, v151
    v_add_f32 v0, v0, v1
    v_add_f32 v1, v2, v3
    v_mfma_f32_32x32x16_bf16 v[104:119], v[192:195], v[32:35], v[104:119]
    ds_read_b64_tr_b16 v[220:221], v242 offset:4096
    ds_read_b64_tr_b16 v[222:223], v242 offset:6144
    v_add_f32 v2, v4, v5
    v_add_f32 v3, v6, v7
    v_mfma_f32_32x32x16_bf16 v[104:119], v[196:199], v[36:39], v[104:119]
    ds_read_b64_tr_b16 v[228:229], v243 offset:4096
    ds_read_b64_tr_b16 v[230:231], v243 offset:6144
    v_add_f32 v0, v0, v1
    v_add_f32 v2, v2, v3
    v_add_f32 v249, v0, v2
    v_cmp_lt_f32 vcc, s25, v249
    s_cbranch_vccnz L_gqa_attn_kernel_slow8
L_gqa_attn_kernel_res8:
    v_add_f32 v248, v248, v249
    v_cvt_pk_bf16_f32 v160, v136, v137
    v_cvt_pk_bf16_f32 v161, v138, v139
    v_cvt_pk_bf16_f32 v162, v140, v141
    v_cvt_pk_bf16_f32 v163, v142, v143
    v_cvt_pk_bf16_f32 v164, v144, v145
    v_cvt_pk_bf16_f32 v165, v146, v147
    v_cvt_pk_bf16_f32 v166, v148, v149
    v_cvt_pk_bf16_f32 v167, v150, v151
    s_waitcnt lgkmcnt(0)
    s_waitcnt vmcnt(8)
    s_barrier
    v_mfma_f32_32x32x16_bf16 v[40:55], v[200:203], v[160:163], v[40:55]
    ds_read_b128 v[168:171], v232 offset:32768
    ds_read_b128 v[172:175], v233 offset:32768
    s_lshl_b32 s37, s29, 10
    s_add_u32 s37, s37, 16384
    s_mov_b32 m0, s37
    s_add_u32 s38, s26, 0
    buffer_load_dwordx4 v245, s[12:15], s38 offen nt lds
    v_fma_f32 v136, v104, s24, -v247
    v_fma_f32 v137, v105, s24, -v247
    v_fma_f32 v138, v106, s24, -v247
    v_mfma_f32_32x32x16_bf16 v[56:71], v[208:211], v[160:163], v[56:71]
    ds_read_b128 v[176:179], v234 offset:32768
    ds_read_b128 v[180:183], v235 offset:32768
    s_lshl_b32 s37, s29, 10
    s_add_u32 s37, s37, 24576
    s_mov_b32 m0, s37
    s_sub_u32 s38, s26, 8192
    buffer_load_dwordx4 v245, s[12:15], s38 offen nt lds
    v_fma_f32 v139, v107, s24, -v247
    v_fma_f32 v140, v108, s24, -v247
    v_fma_f32 v141, v109, s24, -v247
    v_mfma_f32_32x32x16_bf16 v[72:87], v[216:219], v[160:163], v[72:87]
    ds_read_b128 v[184:187], v236 offset:32768
    ds_read_b128 v[188:191], v237 offset:32768
    s_add_u32 s26, s26, 16384
    v_exp_f32 v136, v136
    v_fma_f32 v142, v110, s24, -v247
    v_exp_f32 v137, v137
    v_mfma_f32_32x32x16_bf16 v[88:103], v[224:227], v[160:163], v[88:103]
    ds_read_b128 v[192:195], v238 offset:32768
    ds_read_b128 v[196:199], v239 offset:32768
    v_fma_f32 v143, v111, s24, -v247
    v_exp_f32 v138, v138
    v_fma_f32 v144, v112, s24, -v247
    v_mfma_f32_32x32x16_bf16 v[40:55], v[204:207], v[164:167], v[40:55]
    v_exp_f32 v139, v139
    v_fma_f32 v145, v113, s24, -v247
    v_add_f32 v0, v136, v137
    v_mfma_f32_32x32x16_bf16 v[56:71], v[212:215], v[164:167], v[56:71]
    v_exp_f32 v140, v140
    v_fma_f32 v146, v114, s24, -v247
    v_exp_f32 v141, v141
    v_mfma_f32_32x32x16_bf16 v[72:87], v[220:223], v[164:167], v[72:87]
    v_fma_f32 v147, v115, s24, -v247
    v_add_f32 v1, v138, v139
    v_exp_f32 v142, v142
    v_mfma_f32_32x32x16_bf16 v[88:103], v[228:231], v[164:167], v[88:103]
    v_fma_f32 v148, v116, s24, -v247
    v_exp_f32 v143, v143
    v_fma_f32 v149, v117, s24, -v247
    s_waitcnt lgkmcnt(0)
    v_mfma_f32_32x32x16_bf16 v[120:135], v[168:171], v[8:11], 0
    ds_read_b64_tr_b16 v[200:201], v240 offset:32768
    ds_read_b64_tr_b16 v[202:203], v240 offset:34816
    v_add_f32 v2, v140, v141
    v_exp_f32 v144, v144
    v_fma_f32 v150, v118, s24, -v247
    v_mfma_f32_32x32x16_bf16 v[120:135], v[172:175], v[12:15], v[120:135]
    ds_read_b64_tr_b16 v[208:209], v241 offset:32768
    ds_read_b64_tr_b16 v[210:211], v241 offset:34816
    v_exp_f32 v145, v145
    v_fma_f32 v151, v119, s24, -v247
    v_add_f32 v3, v142, v143
    v_mfma_f32_32x32x16_bf16 v[120:135], v[176:179], v[16:19], v[120:135]
    ds_read_b64_tr_b16 v[216:217], v242 offset:32768
    ds_read_b64_tr_b16 v[218:219], v242 offset:34816
    v_exp_f32 v146, v146
    v_exp_f32 v147, v147
    v_add_f32 v4, v144, v145
    v_mfma_f32_32x32x16_bf16 v[120:135], v[180:183], v[20:23], v[120:135]
    ds_read_b64_tr_b16 v[224:225], v243 offset:32768
    ds_read_b64_tr_b16 v[226:227], v243 offset:34816
    v_exp_f32 v148, v148
    v_exp_f32 v149, v149
    v_add_f32 v5, v146, v147
    v_mfma_f32_32x32x16_bf16 v[120:135], v[184:187], v[24:27], v[120:135]
    ds_read_b64_tr_b16 v[204:205], v240 offset:36864
    ds_read_b64_tr_b16 v[206:207], v240 offset:38912
    v_exp_f32 v150, v150
    v_exp_f32 v151, v151
    v_add_f32 v6, v148, v149
    v_mfma_f32_32x32x16_bf16 v[120:135], v[188:191], v[28:31], v[120:135]
    ds_read_b64_tr_b16 v[212:213], v241 offset:36864
    ds_read_b64_tr_b16 v[214:215], v241 offset:38912
    v_add_f32 v7, v150, v151
    v_add_f32 v0, v0, v1
    v_add_f32 v1, v2, v3
    v_mfma_f32_32x32x16_bf16 v[120:135], v[192:195], v[32:35], v[120:135]
    ds_read_b64_tr_b16 v[220:221], v242 offset:36864
    ds_read_b64_tr_b16 v[222:223], v242 offset:38912
    v_add_f32 v2, v4, v5
    v_add_f32 v3, v6, v7
    v_mfma_f32_32x32x16_bf16 v[120:135], v[196:199], v[36:39], v[120:135]
    ds_read_b64_tr_b16 v[228:229], v243 offset:36864
    ds_read_b64_tr_b16 v[230:231], v243 offset:38912
    v_add_f32 v0, v0, v1
    v_add_f32 v2, v2, v3
    v_add_f32 v249, v0, v2
    v_cmp_lt_f32 vcc, s25, v249
    s_cbranch_vccnz L_gqa_attn_kernel_slow9
L_gqa_attn_kernel_res9:
    v_add_f32 v248, v248, v249
    v_cvt_pk_bf16_f32 v152, v136, v137
    v_cvt_pk_bf16_f32 v153, v138, v139
    v_cvt_pk_bf16_f32 v154, v140, v141
    v_cvt_pk_bf16_f32 v155, v142, v143
    v_cvt_pk_bf16_f32 v156, v144, v145
    v_cvt_pk_bf16_f32 v157, v146, v147
    v_cvt_pk_bf16_f32 v158, v148, v149
    v_cvt_pk_bf16_f32 v159, v150, v151
    s_waitcnt lgkmcnt(0)
    s_waitcnt vmcnt(6)
    s_barrier
    v_add_u32 v232, 0x10000, v232
    v_add_u32 v233, 0x10000, v233
    v_add_u32 v234, 0x10000, v234
    v_add_u32 v235, 0x10000, v235
    v_add_u32 v236, 0x10000, v236
    v_add_u32 v237, 0x10000, v237
    v_add_u32 v238, 0x10000, v238
    v_add_u32 v239, 0x10000, v239
    v_add_u32 v240, 0x10000, v240
    v_add_u32 v241, 0x10000, v241
    v_add_u32 v242, 0x10000, v242
    v_add_u32 v243, 0x10000, v243
    v_mfma_f32_32x32x16_bf16 v[40:55], v[200:203], v[152:155], v[40:55]
    ds_read_b128 v[168:171], v232 offset:0
    ds_read_b128 v[172:175], v233 offset:0
    s_lshl_b32 s37, s29, 10
    s_add_u32 s37, s37, 57344
    s_mov_b32 m0, s37
    s_sub_u32 s38, s26, 8192
    buffer_load_dwordx4 v245, s[12:15], s38 offen nt lds
    v_fma_f32 v136, v120, s24, -v247
    v_fma_f32 v137, v121, s24, -v247
    v_fma_f32 v138, v122, s24, -v247
    v_mfma_f32_32x32x16_bf16 v[56:71], v[208:211], v[152:155], v[56:71]
    ds_read_b128 v[176:179], v234 offset:0
    ds_read_b128 v[180:183], v235 offset:0
    s_add_u32 s26, s26, 16384
    v_fma_f32 v139, v123, s24, -v247
    v_fma_f32 v140, v124, s24, -v247
    v_fma_f32 v141, v125, s24, -v247
    v_mfma_f32_32x32x16_bf16 v[72:87], v[216:219], v[152:155], v[72:87]
    ds_read_b128 v[184:187], v236 offset:0
    ds_read_b128 v[188:191], v237 offset:0
    v_exp_f32 v136, v136
    v_fma_f32 v142, v126, s24, -v247
    v_exp_f32 v137, v137
    v_mfma_f32_32x32x16_bf16 v[88:103], v[224:227], v[152:155], v[88:103]
    ds_read_b128 v[192:195], v238 offset:0
    ds_read_b128 v[196:199], v239 offset:0
    v_fma_f32 v143, v127, s24, -v247
    v_exp_f32 v138, v138
    v_fma_f32 v144, v128, s24, -v247
    v_mfma_f32_32x32x16_bf16 v[40:55], v[204:207], v[156:159], v[40:55]
    v_exp_f32 v139, v139
    v_fma_f32 v145, v129, s24, -v247
    v_add_f32 v0, v136, v137
    v_mfma_f32_32x32x16_bf16 v[56:71], v[212:215], v[156:159], v[56:71]
    v_exp_f32 v140, v140
    v_fma_f32 v146, v130, s24, -v247
    v_exp_f32 v141, v141
    v_mfma_f32_32x32x16_bf16 v[72:87], v[220:223], v[156:159], v[72:87]
    v_fma_f32 v147, v131, s24, -v247
    v_add_f32 v1, v138, v139
    v_exp_f32 v142, v142
    v_mfma_f32_32x32x16_bf16 v[88:103], v[228:231], v[156:159], v[88:103]
    v_fma_f32 v148, v132, s24, -v247
    v_exp_f32 v143, v143
    v_fma_f32 v149, v133, s24, -v247
    s_waitcnt lgkmcnt(0)
    v_mfma_f32_32x32x16_bf16 v[104:119], v[168:171], v[8:11], 0
    ds_read_b64_tr_b16 v[200:201], v240 offset:0
    ds_read_b64_tr_b16 v[202:203], v240 offset:2048
    v_add_f32 v2, v140, v141
    v_exp_f32 v144, v144
    v_fma_f32 v150, v134, s24, -v247
    v_mfma_f32_32x32x16_bf16 v[104:119], v[172:175], v[12:15], v[104:119]
    ds_read_b64_tr_b16 v[208:209], v241 offset:0
    ds_read_b64_tr_b16 v[210:211], v241 offset:2048
    v_exp_f32 v145, v145
    v_fma_f32 v151, v135, s24, -v247
    v_add_f32 v3, v142, v143
    v_mfma_f32_32x32x16_bf16 v[104:119], v[176:179], v[16:19], v[104:119]
    ds_read_b64_tr_b16 v[216:217], v242 offset:0
    ds_read_b64_tr_b16 v[218:219], v242 offset:2048
    v_exp_f32 v146, v146
    v_exp_f32 v147, v147
    v_add_f32 v4, v144, v145
    v_mfma_f32_32x32x16_bf16 v[104:119], v[180:183], v[20:23], v[104:119]
    ds_read_b64_tr_b16 v[224:225], v243 offset:0
    ds_read_b64_tr_b16 v[226:227], v243 offset:2048
    v_exp_f32 v148, v148
    v_exp_f32 v149, v149
    v_add_f32 v5, v146, v147
    v_mfma_f32_32x32x16_bf16 v[104:119], v[184:187], v[24:27], v[104:119]
    ds_read_b64_tr_b16 v[204:205], v240 offset:4096
    ds_read_b64_tr_b16 v[206:207], v240 offset:6144
    v_exp_f32 v150, v150
    v_exp_f32 v151, v151
    v_add_f32 v6, v148, v149
    v_mfma_f32_32x32x16_bf16 v[104:119], v[188:191], v[28:31], v[104:119]
    ds_read_b64_tr_b16 v[212:213], v241 offset:4096
    ds_read_b64_tr_b16 v[214:215], v241 offset:6144
    v_add_f32 v7, v150, v151
    v_add_f32 v0, v0, v1
    v_add_f32 v1, v2, v3
    v_mfma_f32_32x32x16_bf16 v[104:119], v[192:195], v[32:35], v[104:119]
    ds_read_b64_tr_b16 v[220:221], v242 offset:4096
    ds_read_b64_tr_b16 v[222:223], v242 offset:6144
    v_add_f32 v2, v4, v5
    v_add_f32 v3, v6, v7
    v_mfma_f32_32x32x16_bf16 v[104:119], v[196:199], v[36:39], v[104:119]
    ds_read_b64_tr_b16 v[228:229], v243 offset:4096
    ds_read_b64_tr_b16 v[230:231], v243 offset:6144
    v_add_f32 v0, v0, v1
    v_add_f32 v2, v2, v3
    v_add_f32 v249, v0, v2
    v_cmp_lt_f32 vcc, s25, v249
    s_cbranch_vccnz L_gqa_attn_kernel_slow10
L_gqa_attn_kernel_res10:
    v_add_f32 v248, v248, v249
    v_cvt_pk_bf16_f32 v160, v136, v137
    v_cvt_pk_bf16_f32 v161, v138, v139
    v_cvt_pk_bf16_f32 v162, v140, v141
    v_cvt_pk_bf16_f32 v163, v142, v143
    v_cvt_pk_bf16_f32 v164, v144, v145
    v_cvt_pk_bf16_f32 v165, v146, v147
    v_cvt_pk_bf16_f32 v166, v148, v149
    v_cvt_pk_bf16_f32 v167, v150, v151
    s_waitcnt lgkmcnt(0)
    s_waitcnt vmcnt(3)
    s_barrier
    v_mfma_f32_32x32x16_bf16 v[40:55], v[200:203], v[160:163], v[40:55]
    ds_read_b128 v[168:171], v232 offset:32768
    ds_read_b128 v[172:175], v233 offset:32768
    s_add_u32 s26, s26, 16384
    v_fma_f32 v136, v104, s24, -v247
    v_fma_f32 v137, v105, s24, -v247
    v_fma_f32 v138, v106, s24, -v247
    v_mfma_f32_32x32x16_bf16 v[56:71], v[208:211], v[160:163], v[56:71]
    ds_read_b128 v[176:179], v234 offset:32768
    ds_read_b128 v[180:183], v235 offset:32768
    v_fma_f32 v139, v107, s24, -v247
    v_fma_f32 v140, v108, s24, -v247
    v_fma_f32 v141, v109, s24, -v247
    v_mfma_f32_32x32x16_bf16 v[72:87], v[216:219], v[160:163], v[72:87]
    ds_read_b128 v[184:187], v236 offset:32768
    ds_read_b128 v[188:191], v237 offset:32768
    v_exp_f32 v136, v136
    v_fma_f32 v142, v110, s24, -v247
    v_exp_f32 v137, v137
    v_mfma_f32_32x32x16_bf16 v[88:103], v[224:227], v[160:163], v[88:103]
    ds_read_b128 v[192:195], v238 offset:32768
    ds_read_b128 v[196:199], v239 offset:32768
    v_fma_f32 v143, v111, s24, -v247
    v_exp_f32 v138, v138
    v_fma_f32 v144, v112, s24, -v247
    v_mfma_f32_32x32x16_bf16 v[40:55], v[204:207], v[164:167], v[40:55]
    v_exp_f32 v139, v139
    v_fma_f32 v145, v113, s24, -v247
    v_add_f32 v0, v136, v137
    v_mfma_f32_32x32x16_bf16 v[56:71], v[212:215], v[164:167], v[56:71]
    v_exp_f32 v140, v140
    v_fma_f32 v146, v114, s24, -v247
    v_exp_f32 v141, v141
    v_mfma_f32_32x32x16_bf16 v[72:87], v[220:223], v[164:167], v[72:87]
    v_fma_f32 v147, v115, s24, -v247
    v_add_f32 v1, v138, v139
    v_exp_f32 v142, v142
    v_mfma_f32_32x32x16_bf16 v[88:103], v[228:231], v[164:167], v[88:103]
    v_fma_f32 v148, v116, s24, -v247
    v_exp_f32 v143, v143
    v_fma_f32 v149, v117, s24, -v247
    s_waitcnt lgkmcnt(0)
    v_mfma_f32_32x32x16_bf16 v[120:135], v[168:171], v[8:11], 0
    ds_read_b64_tr_b16 v[200:201], v240 offset:32768
    ds_read_b64_tr_b16 v[202:203], v240 offset:34816
    v_add_f32 v2, v140, v141
    v_exp_f32 v144, v144
    v_fma_f32 v150, v118, s24, -v247
    v_mfma_f32_32x32x16_bf16 v[120:135], v[172:175], v[12:15], v[120:135]
    ds_read_b64_tr_b16 v[208:209], v241 offset:32768
    ds_read_b64_tr_b16 v[210:211], v241 offset:34816
    v_exp_f32 v145, v145
    v_fma_f32 v151, v119, s24, -v247
    v_add_f32 v3, v142, v143
    v_mfma_f32_32x32x16_bf16 v[120:135], v[176:179], v[16:19], v[120:135]
    ds_read_b64_tr_b16 v[216:217], v242 offset:32768
    ds_read_b64_tr_b16 v[218:219], v242 offset:34816
    v_exp_f32 v146, v146
    v_exp_f32 v147, v147
    v_add_f32 v4, v144, v145
    v_mfma_f32_32x32x16_bf16 v[120:135], v[180:183], v[20:23], v[120:135]
    ds_read_b64_tr_b16 v[224:225], v243 offset:32768
    ds_read_b64_tr_b16 v[226:227], v243 offset:34816
    v_exp_f32 v148, v148
    v_exp_f32 v149, v149
    v_add_f32 v5, v146, v147
    v_mfma_f32_32x32x16_bf16 v[120:135], v[184:187], v[24:27], v[120:135]
    ds_read_b64_tr_b16 v[204:205], v240 offset:36864
    ds_read_b64_tr_b16 v[206:207], v240 offset:38912
    v_exp_f32 v150, v150
    v_exp_f32 v151, v151
    v_add_f32 v6, v148, v149
    v_mfma_f32_32x32x16_bf16 v[120:135], v[188:191], v[28:31], v[120:135]
    ds_read_b64_tr_b16 v[212:213], v241 offset:36864
    ds_read_b64_tr_b16 v[214:215], v241 offset:38912
    v_add_f32 v7, v150, v151
    v_add_f32 v0, v0, v1
    v_add_f32 v1, v2, v3
    v_mfma_f32_32x32x16_bf16 v[120:135], v[192:195], v[32:35], v[120:135]
    ds_read_b64_tr_b16 v[220:221], v242 offset:36864
    ds_read_b64_tr_b16 v[222:223], v242 offset:38912
    v_add_f32 v2, v4, v5
    v_add_f32 v3, v6, v7
    v_mfma_f32_32x32x16_bf16 v[120:135], v[196:199], v[36:39], v[120:135]
    ds_read_b64_tr_b16 v[228:229], v243 offset:36864
    ds_read_b64_tr_b16 v[230:231], v243 offset:38912
    v_add_f32 v0, v0, v1
    v_add_f32 v2, v2, v3
    v_add_f32 v249, v0, v2
    v_cmp_lt_f32 vcc, s25, v249
    s_cbranch_vccnz L_gqa_attn_kernel_slow11
L_gqa_attn_kernel_res11:
    v_add_f32 v248, v248, v249
    v_cvt_pk_bf16_f32 v152, v136, v137
    v_cvt_pk_bf16_f32 v153, v138, v139
    v_cvt_pk_bf16_f32 v154, v140, v141
    v_cvt_pk_bf16_f32 v155, v142, v143
    v_cvt_pk_bf16_f32 v156, v144, v145
    v_cvt_pk_bf16_f32 v157, v146, v147
    v_cvt_pk_bf16_f32 v158, v148, v149
    v_cvt_pk_bf16_f32 v159, v150, v151
    s_waitcnt lgkmcnt(0)
    s_waitcnt vmcnt(1)
    s_barrier
    v_subrev_u32 v232, 0x10000, v232
    v_subrev_u32 v233, 0x10000, v233
    v_subrev_u32 v234, 0x10000, v234
    v_subrev_u32 v235, 0x10000, v235
    v_subrev_u32 v236, 0x10000, v236
    v_subrev_u32 v237, 0x10000, v237
    v_subrev_u32 v238, 0x10000, v238
    v_subrev_u32 v239, 0x10000, v239
    v_subrev_u32 v240, 0x10000, v240
    v_subrev_u32 v241, 0x10000, v241
    v_subrev_u32 v242, 0x10000, v242
    v_subrev_u32 v243, 0x10000, v243
    v_mfma_f32_32x32x16_bf16 v[40:55], v[200:203], v[152:155], v[40:55]
    s_add_u32 s26, s26, 16384
    v_fma_f32 v136, v120, s24, -v247
    v_fma_f32 v137, v121, s24, -v247
    v_fma_f32 v138, v122, s24, -v247
    v_mfma_f32_32x32x16_bf16 v[56:71], v[208:211], v[152:155], v[56:71]
    v_fma_f32 v139, v123, s24, -v247
    v_fma_f32 v140, v124, s24, -v247
    v_fma_f32 v141, v125, s24, -v247
    v_mfma_f32_32x32x16_bf16 v[72:87], v[216:219], v[152:155], v[72:87]
    v_exp_f32 v136, v136
    v_fma_f32 v142, v126, s24, -v247
    v_exp_f32 v137, v137
    v_mfma_f32_32x32x16_bf16 v[88:103], v[224:227], v[152:155], v[88:103]
    v_fma_f32 v143, v127, s24, -v247
    v_exp_f32 v138, v138
    v_fma_f32 v144, v128, s24, -v247
    v_mfma_f32_32x32x16_bf16 v[40:55], v[204:207], v[156:159], v[40:55]
    v_exp_f32 v139, v139
    v_fma_f32 v145, v129, s24, -v247
    v_add_f32 v0, v136, v137
    v_mfma_f32_32x32x16_bf16 v[56:71], v[212:215], v[156:159], v[56:71]
    v_exp_f32 v140, v140
    v_fma_f32 v146, v130, s24, -v247
    v_exp_f32 v141, v141
    v_mfma_f32_32x32x16_bf16 v[72:87], v[220:223], v[156:159], v[72:87]
    v_fma_f32 v147, v131, s24, -v247
    v_add_f32 v1, v138, v139
    v_exp_f32 v142, v142
    v_mfma_f32_32x32x16_bf16 v[88:103], v[228:231], v[156:159], v[88:103]
    v_fma_f32 v148, v132, s24, -v247
    v_exp_f32 v143, v143
    v_fma_f32 v149, v133, s24, -v247
    ds_read_b64_tr_b16 v[200:201], v240 offset:0
    ds_read_b64_tr_b16 v[202:203], v240 offset:2048
    ds_read_b64_tr_b16 v[208:209], v241 offset:0
    ds_read_b64_tr_b16 v[210:211], v241 offset:2048
    ds_read_b64_tr_b16 v[216:217], v242 offset:0
    ds_read_b64_tr_b16 v[218:219], v242 offset:2048
    ds_read_b64_tr_b16 v[224:225], v243 offset:0
    ds_read_b64_tr_b16 v[226:227], v243 offset:2048
    ds_read_b64_tr_b16 v[204:205], v240 offset:4096
    ds_read_b64_tr_b16 v[206:207], v240 offset:6144
    ds_read_b64_tr_b16 v[212:213], v241 offset:4096
    ds_read_b64_tr_b16 v[214:215], v241 offset:6144
    ds_read_b64_tr_b16 v[220:221], v242 offset:4096
    ds_read_b64_tr_b16 v[222:223], v242 offset:6144
    ds_read_b64_tr_b16 v[228:229], v243 offset:4096
    ds_read_b64_tr_b16 v[230:231], v243 offset:6144
    v_add_f32 v2, v140, v141
    v_exp_f32 v144, v144
    v_fma_f32 v150, v134, s24, -v247
    v_exp_f32 v145, v145
    v_fma_f32 v151, v135, s24, -v247
    v_add_f32 v3, v142, v143
    v_exp_f32 v146, v146
    v_exp_f32 v147, v147
    v_add_f32 v4, v144, v145
    v_exp_f32 v148, v148
    v_exp_f32 v149, v149
    v_add_f32 v5, v146, v147
    v_exp_f32 v150, v150
    v_exp_f32 v151, v151
    v_add_f32 v6, v148, v149
    v_add_f32 v7, v150, v151
    v_add_f32 v0, v0, v1
    v_add_f32 v1, v2, v3
    v_add_f32 v2, v4, v5
    v_add_f32 v3, v6, v7
    v_add_f32 v0, v0, v1
    v_add_f32 v2, v2, v3
    v_add_f32 v249, v0, v2
    v_cmp_lt_f32 vcc, s25, v249
    s_cbranch_vccnz L_gqa_attn_kernel_slow12
L_gqa_attn_kernel_res12:
    v_add_f32 v248, v248, v249
    v_cvt_pk_bf16_f32 v160, v136, v137
    v_cvt_pk_bf16_f32 v161, v138, v139
    v_cvt_pk_bf16_f32 v162, v140, v141
    v_cvt_pk_bf16_f32 v163, v142, v143
    v_cvt_pk_bf16_f32 v164, v144, v145
    v_cvt_pk_bf16_f32 v165, v146, v147
    v_cvt_pk_bf16_f32 v166, v148, v149
    v_cvt_pk_bf16_f32 v167, v150, v151
    s_waitcnt lgkmcnt(0)
    s_waitcnt vmcnt(0)
    s_barrier
    v_mfma_f32_32x32x16_bf16 v[40:55], v[200:203], v[160:163], v[40:55]
    s_add_u32 s26, s26, 16384
    v_mfma_f32_32x32x16_bf16 v[56:71], v[208:211], v[160:163], v[56:71]
    v_mfma_f32_32x32x16_bf16 v[72:87], v[216:219], v[160:163], v[72:87]
    v_mfma_f32_32x32x16_bf16 v[88:103], v[224:227], v[160:163], v[88:103]
    v_mfma_f32_32x32x16_bf16 v[40:55], v[204:207], v[164:167], v[40:55]
    v_mfma_f32_32x32x16_bf16 v[56:71], v[212:215], v[164:167], v[56:71]
    v_mfma_f32_32x32x16_bf16 v[72:87], v[220:223], v[164:167], v[72:87]
    v_mfma_f32_32x32x16_bf16 v[88:103], v[228:231], v[164:167], v[88:103]
    s_branch L_gqa_attn_kernel_epi
L_gqa_attn_kernel_par1:
    s_waitcnt lgkmcnt(0)
    s_waitcnt vmcnt(7)
    s_barrier
    s_lshl_b32 s37, s29, 10
    s_add_u32 s37, s37, 98304
    s_mov_b32 m0, s37
    s_add_u32 s38, s26, 16384
    buffer_load_dwordx4 v244, s[8:11], s38 offen nt lds
    s_lshl_b32 s37, s29, 10
    s_add_u32 s37, s37, 106496
    s_mov_b32 m0, s37
    s_add_u32 s38, s26, 24576
    buffer_load_dwordx4 v244, s[8:11], s38 offen nt lds
    s_lshl_b32 s37, s29, 10
    s_add_u32 s37, s37, 114688
    s_mov_b32 m0, s37
    s_add_u32 s38, s26, 0
    buffer_load_dwordx4 v245, s[12:15], s38 offen nt lds
    s_lshl_b32 s37, s29, 10
    s_add_u32 s37, s37, 122880
    s_mov_b32 m0, s37
    s_sub_u32 s38, s26, 8192
    buffer_load_dwordx4 v245, s[12:15], s38 offen nt lds
    s_add_u32 s26, s26, 16384
    ds_read_b128 v[168:171], v232 offset:0
    ds_read_b128 v[172:175], v233 offset:0
    ds_read_b128 v[176:179], v234 offset:0
    ds_read_b128 v[180:183], v235 offset:0
    ds_read_b128 v[184:187], v236 offset:0
    ds_read_b128 v[188:191], v237 offset:0
    ds_read_b128 v[192:195], v238 offset:0
    ds_read_b128 v[196:199], v239 offset:0
    s_waitcnt lgkmcnt(0)
    s_waitcnt vmcnt(8)
    s_barrier
    v_mfma_f32_32x32x16_bf16 v[104:119], v[168:171], v[8:11], 0
    s_lshl_b32 s37, s29, 10
    s_add_u32 s37, s37, 0
    s_mov_b32 m0, s37
    s_add_u32 s38, s26, 16384
    buffer_load_dwordx4 v244, s[8:11], s38 offen nt lds
    v_mfma_f32_32x32x16_bf16 v[104:119], v[172:175], v[12:15], v[104:119]
    s_lshl_b32 s37, s29, 10
    s_add_u32 s37, s37, 8192
    s_mov_b32 m0, s37
    s_add_u32 s38, s26, 24576
    buffer_load_dwordx4 v244, s[8:11], s38 offen nt lds
    v_mfma_f32_32x32x16_bf16 v[104:119], v[176:179], v[16:19], v[104:119]
    s_lshl_b32 s37, s29, 10
    s_add_u32 s37, s37, 16384
    s_mov_b32 m0, s37
    s_add_u32 s38, s26, 0
    buffer_load_dwordx4 v245, s[12:15], s38 offen nt lds
    v_mfma_f32_32x32x16_bf16 v[104:119], v[180:183], v[20:23], v[104:119]
    s_lshl_b32 s37, s29, 10
    s_add_u32 s37, s37, 24576
    s_mov_b32 m0, s37
    s_sub_u32 s38, s26, 8192
    buffer_load_dwordx4 v245, s[12:15], s38 offen nt lds
    v_mfma_f32_32x32x16_bf16 v[104:119], v[184:187], v[24:27], v[104:119]
    s_add_u32 s26, s26, 16384
    v_mfma_f32_32x32x16_bf16 v[104:119], v[188:191], v[28:31], v[104:119]
    v_mfma_f32_32x32x16_bf16 v[104:119], v[192:195], v[32:35], v[104:119]
    v_mfma_f32_32x32x16_bf16 v[104:119], v[196:199], v[36:39], v[104:119]
    s_nop 7
    s_nop 7
    ds_read_b128 v[168:171], v232 offset:32768
    ds_read_b128 v[172:175], v233 offset:32768
    ds_read_b128 v[176:179], v234 offset:32768
    ds_read_b128 v[180:183], v235 offset:32768
    ds_read_b128 v[184:187], v236 offset:32768
    ds_read_b128 v[188:191], v237 offset:32768
    ds_read_b128 v[192:195], v238 offset:32768
    ds_read_b128 v[196:199], v239 offset:32768
    v_fma_f32 v136, v104, s24, -v247
    v_fma_f32 v137, v105, s24, -v247
    v_fma_f32 v138, v106, s24, -v247
    v_fma_f32 v139, v107, s24, -v247
    v_fma_f32 v140, v108, s24, -v247
    v_fma_f32 v141, v109, s24, -v247
    v_exp_f32 v136, v136
    v_fma_f32 v142, v110, s24, -v247
    v_exp_f32 v137, v137
    v_fma_f32 v143, v111, s24, -v247
    v_exp_f32 v138, v138
    v_fma_f32 v144, v112, s24, -v247
    v_exp_f32 v139, v139
    v_fma_f32 v145, v113, s24, -v247
    v_add_f32 v0, v136, v137
    v_exp_f32 v140, v140
    v_fma_f32 v146, v114, s24, -v247
    v_exp_f32 v141, v141
    v_fma_f32 v147, v115, s24, -v247
    v_add_f32 v1, v138, v139
    v_exp_f32 v142, v142
    v_fma_f32 v148, v116, s24, -v247
    v_exp_f32 v143, v143
    v_fma_f32 v149, v117, s24, -v247
    s_mov_b32 s28, 6
L_gqa_attn_kernel_loop1:
    s_waitcnt lgkmcnt(0)
    s_waitcnt vmcnt(8)
    s_barrier
    v_add_u32 v232, 0x10000, v232
    v_add_u32 v233, 0x10000, v233
    v_add_u32 v234, 0x10000, v234
    v_add_u32 v235, 0x10000, v235
    v_add_u32 v236, 0x10000, v236
    v_add_u32 v237, 0x10000, v237
    v_add_u32 v238, 0x10000, v238
    v_add_u32 v239, 0x10000, v239
    v_add_u32 v240, 0x10000, v240
    v_add_u32 v241, 0x10000, v241
    v_add_u32 v242, 0x10000, v242
    v_add_u32 v243, 0x10000, v243
    v_mfma_f32_32x32x16_bf16 v[120:135], v[168:171], v[8:11], 0
    s_lshl_b32 s37, s29, 10
    s_add_u32 s37, s37, 32768
    s_mov_b32 m0, s37
    s_add_u32 s38, s26, 16384
    buffer_load_dwordx4 v244, s[8:11], s38 offen nt lds
    ds_read_b64_tr_b16 v[200:201], v240 offset:0
    ds_read_b64_tr_b16 v[202:203], v240 offset:2048
    v_add_f32 v2, v140, v141
    v_exp_f32 v144, v144
    v_fma_f32 v150, v118, s24, -v247
    v_mfma_f32_32x32x16_bf16 v[120:135], v[172:175], v[12:15], v[120:135]
    s_lshl_b32 s37, s29, 10
    s_add_u32 s37, s37, 40960
    s_mov_b32 m0, s37
    s_add_u32 s38, s26, 24576
    buffer_load_dwordx4 v244, s[8:11], s38 offen nt lds
    ds_read_b64_tr_b16 v[208:209], v241 offset:0
    ds_read_b64_tr_b16 v[210:211], v241 offset:2048
    v_exp_f32 v145, v145
    v_fma_f32 v151, v119, s24, -v247
    v_add_f32 v3, v142, v143
    v_mfma_f32_32x32x16_bf16 v[120:135], v[176:179], v[16:19], v[120:135]
    s_lshl_b32 s37, s29, 10
    s_add_u32 s37, s37, 49152
    s_mov_b32 m0, s37
    s_add_u32 s38, s26, 0
    buffer_load_dwordx4 v245, s[12:15], s38 offen nt lds
    ds_read_b64_tr_b16 v[216:217], v242 offset:0
    ds_read_b64_tr_b16 v[218:219], v242 offset:2048
    v_exp_f32 v146, v146
    v_exp_f32 v147, v147
    v_add_f32 v4, v144, v145
    v_mfma_f32_32x32x16_bf16 v[120:135], v[180:183], v[20:23], v[120:135]
    s_lshl_b32 s37, s29, 10
    s_add_u32 s37, s37, 57344
    s_mov_b32 m0, s37
    s_sub_u32 s38, s26, 8192
    buffer_load_dwordx4 v245, s[12:15], s38 offen nt lds
    ds_read_b64_tr_b16 v[224:225], v243 offset:0
    ds_read_b64_tr_b16 v[226:227], v243 offset:2048
    v_exp_f32 v148, v148
    v_exp_f32 v149, v149
    v_add_f32 v5, v146, v147
    v_mfma_f32_32x32x16_bf16 v[120:135], v[184:187], v[24:27], v[120:135]
    s_add_u32 s26, s26, 16384
    ds_read_b64_tr_b16 v[204:205], v240 offset:4096
    ds_read_b64_tr_b16 v[206:207], v240 offset:6144
    v_exp_f32 v150, v150
    v_exp_f32 v151, v151
    v_add_f32 v6, v148, v149
    v_mfma_f32_32x32x16_bf16 v[120:135], v[188:191], v[28:31], v[120:135]
    ds_read_b64_tr_b16 v[212:213], v241 offset:4096
    ds_read_b64_tr_b16 v[214:215], v241 offset:6144
    v_add_f32 v7, v150, v151
    v_add_f32 v0, v0, v1
    v_add_f32 v1, v2, v3
    v_mfma_f32_32x32x16_bf16 v[120:135], v[192:195], v[32:35], v[120:135]
    ds_read_b64_tr_b16 v[220:221], v242 offset:4096
    ds_read_b64_tr_b16 v[222:223], v242 offset:6144
    v_add_f32 v2, v4, v5
    v_add_f32 v3, v6, v7
    v_mfma_f32_32x32x16_bf16 v[120:135], v[196:199], v[36:39], v[120:135]
    ds_read_b64_tr_b16 v[228:229], v243 offset:4096
    ds_read_b64_tr_b16 v[230:231], v243 offset:6144
    v_add_f32 v0, v0, v1
    v_add_f32 v2, v2, v3
    v_add_f32 v249, v0, v2
    v_cmp_lt_f32 vcc, s25, v249
    s_cbranch_vccnz L_gqa_attn_kernel_slow13
L_gqa_attn_kernel_res13:
    v_add_f32 v248, v248, v249
    v_cvt_pk_bf16_f32 v152, v136, v137
    v_cvt_pk_bf16_f32 v153, v138, v139
    v_cvt_pk_bf16_f32 v154, v140, v141
    v_cvt_pk_bf16_f32 v155, v142, v143
    v_cvt_pk_bf16_f32 v156, v144, v145
    v_cvt_pk_bf16_f32 v157, v146, v147
    v_cvt_pk_bf16_f32 v158, v148, v149
    v_cvt_pk_bf16_f32 v159, v150, v151
    s_waitcnt lgkmcnt(0)
    v_mfma_f32_32x32x16_bf16 v[40:55], v[200:203], v[152:155], v[40:55]
    ds_read_b128 v[168:171], v232 offset:0
    ds_read_b128 v[172:175], v233 offset:0
    v_fma_f32 v136, v120, s24, -v247
    v_fma_f32 v137, v121, s24, -v247
    v_fma_f32 v138, v122, s24, -v247
    v_mfma_f32_32x32x16_bf16 v[56:71], v[208:211], v[152:155], v[56:71]
    ds_read_b128 v[176:179], v234 offset:0
    ds_read_b128 v[180:183], v235 offset:0
    v_fma_f32 v139, v123, s24, -v247
    v_fma_f32 v140, v124, s24, -v247
    v_fma_f32 v141, v125, s24, -v247
    v_mfma_f32_32x32x16_bf16 v[72:87], v[216:219], v[152:155], v[72:87]
    ds_read_b128 v[184:187], v236 offset:0
    ds_read_b128 v[188:191], v237 offset:0
    v_exp_f32 v136, v136
    v_fma_f32 v142, v126, s24, -v247
    v_exp_f32 v137, v137
    v_mfma_f32_32x32x16_bf16 v[88:103], v[224:227], v[152:155], v[88:103]
    ds_read_b128 v[192:195], v238 offset:0
    ds_read_b128 v[196:199], v239 offset:0
    v_fma_f32 v143, v127, s24, -v247
    v_exp_f32 v138, v138
    v_fma_f32 v144, v128, s24, -v247
    v_mfma_f32_32x32x16_bf16 v[40:55], v[204:207], v[156:159], v[40:55]
    v_exp_f32 v139, v139
    v_fma_f32 v145, v129, s24, -v247
    v_add_f32 v0, v136, v137
    v_mfma_f32_32x32x16_bf16 v[56:71], v[212:215], v[156:159], v[56:71]
    v_exp_f32 v140, v140
    v_fma_f32 v146, v130, s24, -v247
    v_exp_f32 v141, v141
    v_mfma_f32_32x32x16_bf16 v[72:87], v[220:223], v[156:159], v[72:87]
    v_fma_f32 v147, v131, s24, -v247
    v_add_f32 v1, v138, v139
    v_exp_f32 v142, v142
    v_mfma_f32_32x32x16_bf16 v[88:103], v[228:231], v[156:159], v[88:103]
    v_fma_f32 v148, v132, s24, -v247
    v_exp_f32 v143, v143
    v_fma_f32 v149, v133, s24, -v247
    s_waitcnt lgkmcnt(0)
    s_waitcnt vmcnt(8)
    s_barrier
    v_mfma_f32_32x32x16_bf16 v[104:119], v[168:171], v[8:11], 0
    s_lshl_b32 s37, s29, 10
    s_add_u32 s37, s37, 65536
    s_mov_b32 m0, s37
    s_add_u32 s38, s26, 16384
    buffer_load_dwordx4 v244, s[8:11], s38 offen nt lds
    ds_read_b64_tr_b16 v[200:201], v240 offset:32768
    ds_read_b64_tr_b16 v[202:203], v240 offset:34816
    v_add_f32 v2, v140, v141
    v_exp_f32 v144, v144
    v_fma_f32 v150, v134, s24, -v247
    v_mfma_f32_32x32x16_bf16 v[104:119], v[172:175], v[12:15], v[104:119]
    s_lshl_b32 s37, s29, 10
    s_add_u32 s37, s37, 73728
    s_mov_b32 m0, s37
    s_add_u32 s38, s26, 24576
    buffer_load_dwordx4 v244, s[8:11], s38 offen nt lds
    ds_read_b64_tr_b16 v[208:209], v241 offset:32768
    ds_read_b64_tr_b16 v[210:211], v241 offset:34816
    v_exp_f32 v145, v145
    v_fma_f32 v151, v135, s24, -v247
    v_add_f32 v3, v142, v143
    v_mfma_f32_32x32x16_bf16 v[104:119], v[176:179], v[16:19], v[104:119]
    s_lshl_b32 s37, s29, 10
    s_add_u32 s37, s37, 81920
    s_mov_b32 m0, s37
    s_add_u32 s38, s26, 0
    buffer_load_dwordx4 v245, s[12:15], s38 offen nt lds
    ds_read_b64_tr_b16 v[216:217], v242 offset:32768
    ds_read_b64_tr_b16 v[218:219], v242 offset:34816
    v_exp_f32 v146, v146
    v_exp_f32 v147, v147
    v_add_f32 v4, v144, v145
    v_mfma_f32_32x32x16_bf16 v[104:119], v[180:183], v[20:23], v[104:119]
    s_lshl_b32 s37, s29, 10
    s_add_u32 s37, s37, 90112
    s_mov_b32 m0, s37
    s_sub_u32 s38, s26, 8192
    buffer_load_dwordx4 v245, s[12:15], s38 offen nt lds
    ds_read_b64_tr_b16 v[224:225], v243 offset:32768
    ds_read_b64_tr_b16 v[226:227], v243 offset:34816
    v_exp_f32 v148, v148
    v_exp_f32 v149, v149
    v_add_f32 v5, v146, v147
    v_mfma_f32_32x32x16_bf16 v[104:119], v[184:187], v[24:27], v[104:119]
    s_add_u32 s26, s26, 16384
    ds_read_b64_tr_b16 v[204:205], v240 offset:36864
    ds_read_b64_tr_b16 v[206:207], v240 offset:38912
    v_exp_f32 v150, v150
    v_exp_f32 v151, v151
    v_add_f32 v6, v148, v149
    v_mfma_f32_32x32x16_bf16 v[104:119], v[188:191], v[28:31], v[104:119]
    ds_read_b64_tr_b16 v[212:213], v241 offset:36864
    ds_read_b64_tr_b16 v[214:215], v241 offset:38912
    v_add_f32 v7, v150, v151
    v_add_f32 v0, v0, v1
    v_add_f32 v1, v2, v3
    v_mfma_f32_32x32x16_bf16 v[104:119], v[192:195], v[32:35], v[104:119]
    ds_read_b64_tr_b16 v[220:221], v242 offset:36864
    ds_read_b64_tr_b16 v[222:223], v242 offset:38912
    v_add_f32 v2, v4, v5
    v_add_f32 v3, v6, v7
    v_mfma_f32_32x32x16_bf16 v[104:119], v[196:199], v[36:39], v[104:119]
    ds_read_b64_tr_b16 v[228:229], v243 offset:36864
    ds_read_b64_tr_b16 v[230:231], v243 offset:38912
    v_add_f32 v0, v0, v1
    v_add_f32 v2, v2, v3
    v_add_f32 v249, v0, v2
    v_cmp_lt_f32 vcc, s25, v249
    s_cbranch_vccnz L_gqa_attn_kernel_slow14
L_gqa_attn_kernel_res14:
    v_add_f32 v248, v248, v249
    v_cvt_pk_bf16_f32 v160, v136, v137
    v_cvt_pk_bf16_f32 v161, v138, v139
    v_cvt_pk_bf16_f32 v162, v140, v141
    v_cvt_pk_bf16_f32 v163, v142, v143
    v_cvt_pk_bf16_f32 v164, v144, v145
    v_cvt_pk_bf16_f32 v165, v146, v147
    v_cvt_pk_bf16_f32 v166, v148, v149
    v_cvt_pk_bf16_f32 v167, v150, v151
    s_waitcnt lgkmcnt(0)
    v_mfma_f32_32x32x16_bf16 v[40:55], v[200:203], v[160:163], v[40:55]
    ds_read_b128 v[168:171], v232 offset:32768
    ds_read_b128 v[172:175], v233 offset:32768
    v_fma_f32 v136, v104, s24, -v247
    v_fma_f32 v137, v105, s24, -v247
    v_fma_f32 v138, v106, s24, -v247
    v_mfma_f32_32x32x16_bf16 v[56:71], v[208:211], v[160:163], v[56:71]
    ds_read_b128 v[176:179], v234 offset:32768
    ds_read_b128 v[180:183], v235 offset:32768
    v_fma_f32 v139, v107, s24, -v247
    v_fma_f32 v140, v108, s24, -v247
    v_fma_f32 v141, v109, s24, -v247
    v_mfma_f32_32x32x16_bf16 v[72:87], v[216:219], v[160:163], v[72:87]
    ds_read_b128 v[184:187], v236 offset:32768
    ds_read_b128 v[188:191], v237 offset:32768
    v_exp_f32 v136, v136
    v_fma_f32 v142, v110, s24, -v247
    v_exp_f32 v137, v137
    v_mfma_f32_32x32x16_bf16 v[88:103], v[224:227], v[160:163], v[88:103]
    ds_read_b128 v[192:195], v238 offset:32768
    ds_read_b128 v[196:199], v239 offset:32768
    v_fma_f32 v143, v111, s24, -v247
    v_exp_f32 v138, v138
    v_fma_f32 v144, v112, s24, -v247
    v_mfma_f32_32x32x16_bf16 v[40:55], v[204:207], v[164:167], v[40:55]
    v_exp_f32 v139, v139
    v_fma_f32 v145, v113, s24, -v247
    v_add_f32 v0, v136, v137
    v_mfma_f32_32x32x16_bf16 v[56:71], v[212:215], v[164:167], v[56:71]
    v_exp_f32 v140, v140
    v_fma_f32 v146, v114, s24, -v247
    v_exp_f32 v141, v141
    v_mfma_f32_32x32x16_bf16 v[72:87], v[220:223], v[164:167], v[72:87]
    v_fma_f32 v147, v115, s24, -v247
    v_add_f32 v1, v138, v139
    v_exp_f32 v142, v142
    v_mfma_f32_32x32x16_bf16 v[88:103], v[228:231], v[164:167], v[88:103]
    v_fma_f32 v148, v116, s24, -v247
    v_exp_f32 v143, v143
    v_fma_f32 v149, v117, s24, -v247
    s_waitcnt lgkmcnt(0)
    s_waitcnt vmcnt(8)
    s_barrier
    v_subrev_u32 v232, 0x10000, v232
    v_subrev_u32 v233, 0x10000, v233
    v_subrev_u32 v234, 0x10000, v234
    v_subrev_u32 v235, 0x10000, v235
    v_subrev_u32 v236, 0x10000, v236
    v_subrev_u32 v237, 0x10000, v237
    v_subrev_u32 v238, 0x10000, v238
    v_subrev_u32 v239, 0x10000, v239
    v_subrev_u32 v240, 0x10000, v240
    v_subrev_u32 v241, 0x10000, v241
    v_subrev_u32 v242, 0x10000, v242
    v_subrev_u32 v243, 0x10000, v243
    v_mfma_f32_32x32x16_bf16 v[120:135], v[168:171], v[8:11], 0
    s_lshl_b32 s37, s29, 10
    s_add_u32 s37, s37, 98304
    s_mov_b32 m0, s37
    s_add_u32 s38, s26, 16384
    buffer_load_dwordx4 v244, s[8:11], s38 offen nt lds
    ds_read_b64_tr_b16 v[200:201], v240 offset:0
    ds_read_b64_tr_b16 v[202:203], v240 offset:2048
    v_add_f32 v2, v140, v141
    v_exp_f32 v144, v144
    v_fma_f32 v150, v118, s24, -v247
    v_mfma_f32_32x32x16_bf16 v[120:135], v[172:175], v[12:15], v[120:135]
    s_lshl_b32 s37, s29, 10
    s_add_u32 s37, s37, 106496
    s_mov_b32 m0, s37
    s_add_u32 s38, s26, 24576
    buffer_load_dwordx4 v244, s[8:11], s38 offen nt lds
    ds_read_b64_tr_b16 v[208:209], v241 offset:0
    ds_read_b64_tr_b16 v[210:211], v241 offset:2048
    v_exp_f32 v145, v145
    v_fma_f32 v151, v119, s24, -v247
    v_add_f32 v3, v142, v143
    v_mfma_f32_32x32x16_bf16 v[120:135], v[176:179], v[16:19], v[120:135]
    s_lshl_b32 s37, s29, 10
    s_add_u32 s37, s37, 114688
    s_mov_b32 m0, s37
    s_add_u32 s38, s26, 0
    buffer_load_dwordx4 v245, s[12:15], s38 offen nt lds
    ds_read_b64_tr_b16 v[216:217], v242 offset:0
    ds_read_b64_tr_b16 v[218:219], v242 offset:2048
    v_exp_f32 v146, v146
    v_exp_f32 v147, v147
    v_add_f32 v4, v144, v145
    v_mfma_f32_32x32x16_bf16 v[120:135], v[180:183], v[20:23], v[120:135]
    s_lshl_b32 s37, s29, 10
    s_add_u32 s37, s37, 122880
    s_mov_b32 m0, s37
    s_sub_u32 s38, s26, 8192
    buffer_load_dwordx4 v245, s[12:15], s38 offen nt lds
    ds_read_b64_tr_b16 v[224:225], v243 offset:0
    ds_read_b64_tr_b16 v[226:227], v243 offset:2048
    v_exp_f32 v148, v148
    v_exp_f32 v149, v149
    v_add_f32 v5, v146, v147
    v_mfma_f32_32x32x16_bf16 v[120:135], v[184:187], v[24:27], v[120:135]
    s_add_u32 s26, s26, 16384
    ds_read_b64_tr_b16 v[204:205], v240 offset:4096
    ds_read_b64_tr_b16 v[206:207], v240 offset:6144
    v_exp_f32 v150, v150
    v_exp_f32 v151, v151
    v_add_f32 v6, v148, v149
    v_mfma_f32_32x32x16_bf16 v[120:135], v[188:191], v[28:31], v[120:135]
    ds_read_b64_tr_b16 v[212:213], v241 offset:4096
    ds_read_b64_tr_b16 v[214:215], v241 offset:6144
    v_add_f32 v7, v150, v151
    v_add_f32 v0, v0, v1
    v_add_f32 v1, v2, v3
    v_mfma_f32_32x32x16_bf16 v[120:135], v[192:195], v[32:35], v[120:135]
    ds_read_b64_tr_b16 v[220:221], v242 offset:4096
    ds_read_b64_tr_b16 v[222:223], v242 offset:6144
    v_add_f32 v2, v4, v5
    v_add_f32 v3, v6, v7
    v_mfma_f32_32x32x16_bf16 v[120:135], v[196:199], v[36:39], v[120:135]
    ds_read_b64_tr_b16 v[228:229], v243 offset:4096
    ds_read_b64_tr_b16 v[230:231], v243 offset:6144
    v_add_f32 v0, v0, v1
    v_add_f32 v2, v2, v3
    v_add_f32 v249, v0, v2
    v_cmp_lt_f32 vcc, s25, v249
    s_cbranch_vccnz L_gqa_attn_kernel_slow15
L_gqa_attn_kernel_res15:
    v_add_f32 v248, v248, v249
    v_cvt_pk_bf16_f32 v152, v136, v137
    v_cvt_pk_bf16_f32 v153, v138, v139
    v_cvt_pk_bf16_f32 v154, v140, v141
    v_cvt_pk_bf16_f32 v155, v142, v143
    v_cvt_pk_bf16_f32 v156, v144, v145
    v_cvt_pk_bf16_f32 v157, v146, v147
    v_cvt_pk_bf16_f32 v158, v148, v149
    v_cvt_pk_bf16_f32 v159, v150, v151
    s_waitcnt lgkmcnt(0)
    v_mfma_f32_32x32x16_bf16 v[40:55], v[200:203], v[152:155], v[40:55]
    ds_read_b128 v[168:171], v232 offset:0
    ds_read_b128 v[172:175], v233 offset:0
    v_fma_f32 v136, v120, s24, -v247
    v_fma_f32 v137, v121, s24, -v247
    v_fma_f32 v138, v122, s24, -v247
    v_mfma_f32_32x32x16_bf16 v[56:71], v[208:211], v[152:155], v[56:71]
    ds_read_b128 v[176:179], v234 offset:0
    ds_read_b128 v[180:183], v235 offset:0
    v_fma_f32 v139, v123, s24, -v247
    v_fma_f32 v140, v124, s24, -v247
    v_fma_f32 v141, v125, s24, -v247
    v_mfma_f32_32x32x16_bf16 v[72:87], v[216:219], v[152:155], v[72:87]
    ds_read_b128 v[184:187], v236 offset:0
    ds_read_b128 v[188:191], v237 offset:0
    v_exp_f32 v136, v136
    v_fma_f32 v142, v126, s24, -v247
    v_exp_f32 v137, v137
    v_mfma_f32_32x32x16_bf16 v[88:103], v[224:227], v[152:155], v[88:103]
    ds_read_b128 v[192:195], v238 offset:0
    ds_read_b128 v[196:199], v239 offset:0
    v_fma_f32 v143, v127, s24, -v247
    v_exp_f32 v138, v138
    v_fma_f32 v144, v128, s24, -v247
    v_mfma_f32_32x32x16_bf16 v[40:55], v[204:207], v[156:159], v[40:55]
    v_exp_f32 v139, v139
    v_fma_f32 v145, v129, s24, -v247
    v_add_f32 v0, v136, v137
    v_mfma_f32_32x32x16_bf16 v[56:71], v[212:215], v[156:159], v[56:71]
    v_exp_f32 v140, v140
    v_fma_f32 v146, v130, s24, -v247
    v_exp_f32 v141, v141
    v_mfma_f32_32x32x16_bf16 v[72:87], v[220:223], v[156:159], v[72:87]
    v_fma_f32 v147, v131, s24, -v247
    v_add_f32 v1, v138, v139
    v_exp_f32 v142, v142
    v_mfma_f32_32x32x16_bf16 v[88:103], v[228:231], v[156:159], v[88:103]
    v_fma_f32 v148, v132, s24, -v247
    v_exp_f32 v143, v143
    v_fma_f32 v149, v133, s24, -v247
    s_waitcnt lgkmcnt(0)
    s_waitcnt vmcnt(8)
    s_barrier
    v_mfma_f32_32x32x16_bf16 v[104:119], v[168:171], v[8:11], 0
    s_lshl_b32 s37, s29, 10
    s_add_u32 s37, s37, 0
    s_mov_b32 m0, s37
    s_add_u32 s38, s26, 16384
    buffer_load_dwordx4 v244, s[8:11], s38 offen nt lds
    ds_read_b64_tr_b16 v[200:201], v240 offset:32768
    ds_read_b64_tr_b16 v[202:203], v240 offset:34816
    v_add_f32 v2, v140, v141
    v_exp_f32 v144, v144
    v_fma_f32 v150, v134, s24, -v247
    v_mfma_f32_32x32x16_bf16 v[104:119], v[172:175], v[12:15], v[104:119]
    s_lshl_b32 s37, s29, 10
    s_add_u32 s37, s37, 8192
    s_mov_b32 m0, s37
    s_add_u32 s38, s26, 24576
    buffer_load_dwordx4 v244, s[8:11], s38 offen nt lds
    ds_read_b64_tr_b16 v[208:209], v241 offset:32768
    ds_read_b64_tr_b16 v[210:211], v241 offset:34816
    v_exp_f32 v145, v145
    v_fma_f32 v151, v135, s24, -v247
    v_add_f32 v3, v142, v143
    v_mfma_f32_32x32x16_bf16 v[104:119], v[176:179], v[16:19], v[104:119]
    s_lshl_b32 s37, s29, 10
    s_add_u32 s37, s37, 16384
    s_mov_b32 m0, s37
    s_add_u32 s38, s26, 0
    buffer_load_dwordx4 v245, s[12:15], s38 offen nt lds
    ds_read_b64_tr_b16 v[216:217], v242 offset:32768
    ds_read_b64_tr_b16 v[218:219], v242 offset:34816
    v_exp_f32 v146, v146
    v_exp_f32 v147, v147
    v_add_f32 v4, v144, v145
    v_mfma_f32_32x32x16_bf16 v[104:119], v[180:183], v[20:23], v[104:119]
    s_lshl_b32 s37, s29, 10
    s_add_u32 s37, s37, 24576
    s_mov_b32 m0, s37
    s_sub_u32 s38, s26, 8192
    buffer_load_dwordx4 v245, s[12:15], s38 offen nt lds
    ds_read_b64_tr_b16 v[224:225], v243 offset:32768
    ds_read_b64_tr_b16 v[226:227], v243 offset:34816
    v_exp_f32 v148, v148
    v_exp_f32 v149, v149
    v_add_f32 v5, v146, v147
    v_mfma_f32_32x32x16_bf16 v[104:119], v[184:187], v[24:27], v[104:119]
    s_add_u32 s26, s26, 16384
    ds_read_b64_tr_b16 v[204:205], v240 offset:36864
    ds_read_b64_tr_b16 v[206:207], v240 offset:38912
    v_exp_f32 v150, v150
    v_exp_f32 v151, v151
    v_add_f32 v6, v148, v149
    v_mfma_f32_32x32x16_bf16 v[104:119], v[188:191], v[28:31], v[104:119]
    ds_read_b64_tr_b16 v[212:213], v241 offset:36864
    ds_read_b64_tr_b16 v[214:215], v241 offset:38912
    v_add_f32 v7, v150, v151
    v_add_f32 v0, v0, v1
    v_add_f32 v1, v2, v3
    v_mfma_f32_32x32x16_bf16 v[104:119], v[192:195], v[32:35], v[104:119]
    ds_read_b64_tr_b16 v[220:221], v242 offset:36864
    ds_read_b64_tr_b16 v[222:223], v242 offset:38912
    v_add_f32 v2, v4, v5
    v_add_f32 v3, v6, v7
    v_mfma_f32_32x32x16_bf16 v[104:119], v[196:199], v[36:39], v[104:119]
    ds_read_b64_tr_b16 v[228:229], v243 offset:36864
    ds_read_b64_tr_b16 v[230:231], v243 offset:38912
    v_add_f32 v0, v0, v1
    v_add_f32 v2, v2, v3
    v_add_f32 v249, v0, v2
    v_cmp_lt_f32 vcc, s25, v249
    s_cbranch_vccnz L_gqa_attn_kernel_slow16
L_gqa_attn_kernel_res16:
    v_add_f32 v248, v248, v249
    v_cvt_pk_bf16_f32 v160, v136, v137
    v_cvt_pk_bf16_f32 v161, v138, v139
    v_cvt_pk_bf16_f32 v162, v140, v141
    v_cvt_pk_bf16_f32 v163, v142, v143
    v_cvt_pk_bf16_f32 v164, v144, v145
    v_cvt_pk_bf16_f32 v165, v146, v147
    v_cvt_pk_bf16_f32 v166, v148, v149
    v_cvt_pk_bf16_f32 v167, v150, v151
    s_waitcnt lgkmcnt(0)
    v_mfma_f32_32x32x16_bf16 v[40:55], v[200:203], v[160:163], v[40:55]
    ds_read_b128 v[168:171], v232 offset:32768
    ds_read_b128 v[172:175], v233 offset:32768
    v_fma_f32 v136, v104, s24, -v247
    v_fma_f32 v137, v105, s24, -v247
    v_fma_f32 v138, v106, s24, -v247
    v_mfma_f32_32x32x16_bf16 v[56:71], v[208:211], v[160:163], v[56:71]
    ds_read_b128 v[176:179], v234 offset:32768
    ds_read_b128 v[180:183], v235 offset:32768
    v_fma_f32 v139, v107, s24, -v247
    v_fma_f32 v140, v108, s24, -v247
    v_fma_f32 v141, v109, s24, -v247
    v_mfma_f32_32x32x16_bf16 v[72:87], v[216:219], v[160:163], v[72:87]
    ds_read_b128 v[184:187], v236 offset:32768
    ds_read_b128 v[188:191], v237 offset:32768
    v_exp_f32 v136, v136
    v_fma_f32 v142, v110, s24, -v247
    v_exp_f32 v137, v137
    v_mfma_f32_32x32x16_bf16 v[88:103], v[224:227], v[160:163], v[88:103]
    ds_read_b128 v[192:195], v238 offset:32768
    ds_read_b128 v[196:199], v239 offset:32768
    v_fma_f32 v143, v111, s24, -v247
    v_exp_f32 v138, v138
    v_fma_f32 v144, v112, s24, -v247
    v_mfma_f32_32x32x16_bf16 v[40:55], v[204:207], v[164:167], v[40:55]
    v_exp_f32 v139, v139
    v_fma_f32 v145, v113, s24, -v247
    v_add_f32 v0, v136, v137
    v_mfma_f32_32x32x16_bf16 v[56:71], v[212:215], v[164:167], v[56:71]
    v_exp_f32 v140, v140
    v_fma_f32 v146, v114, s24, -v247
    v_exp_f32 v141, v141
    v_mfma_f32_32x32x16_bf16 v[72:87], v[220:223], v[164:167], v[72:87]
    v_fma_f32 v147, v115, s24, -v247
    v_add_f32 v1, v138, v139
    v_exp_f32 v142, v142
    v_mfma_f32_32x32x16_bf16 v[88:103], v[228:231], v[164:167], v[88:103]
    v_fma_f32 v148, v116, s24, -v247
    v_exp_f32 v143, v143
    v_fma_f32 v149, v117, s24, -v247
    s_sub_u32 s28, s28, 1
    s_cmp_lg_u32 s28, 0
    s_cbranch_scc1 L_gqa_attn_kernel_loop1
    s_waitcnt lgkmcnt(0)
    s_waitcnt vmcnt(8)
    s_barrier
    v_add_u32 v232, 0x10000, v232
    v_add_u32 v233, 0x10000, v233
    v_add_u32 v234, 0x10000, v234
    v_add_u32 v235, 0x10000, v235
    v_add_u32 v236, 0x10000, v236
    v_add_u32 v237, 0x10000, v237
    v_add_u32 v238, 0x10000, v238
    v_add_u32 v239, 0x10000, v239
    v_add_u32 v240, 0x10000, v240
    v_add_u32 v241, 0x10000, v241
    v_add_u32 v242, 0x10000, v242
    v_add_u32 v243, 0x10000, v243
    v_mfma_f32_32x32x16_bf16 v[120:135], v[168:171], v[8:11], 0
    s_lshl_b32 s37, s29, 10
    s_add_u32 s37, s37, 32768
    s_mov_b32 m0, s37
    s_add_u32 s38, s26, 16384
    buffer_load_dwordx4 v244, s[8:11], s38 offen nt lds
    ds_read_b64_tr_b16 v[200:201], v240 offset:0
    ds_read_b64_tr_b16 v[202:203], v240 offset:2048
    v_add_f32 v2, v140, v141
    v_exp_f32 v144, v144
    v_fma_f32 v150, v118, s24, -v247
    v_mfma_f32_32x32x16_bf16 v[120:135], v[172:175], v[12:15], v[120:135]
    s_lshl_b32 s37, s29, 10
    s_add_u32 s37, s37, 40960
    s_mov_b32 m0, s37
    s_add_u32 s38, s26, 24576
    buffer_load_dwordx4 v244, s[8:11], s38 offen nt lds
    ds_read_b64_tr_b16 v[208:209], v241 offset:0
    ds_read_b64_tr_b16 v[210:211], v241 offset:2048
    v_exp_f32 v145, v145
    v_fma_f32 v151, v119, s24, -v247
    v_add_f32 v3, v142, v143
    v_mfma_f32_32x32x16_bf16 v[120:135], v[176:179], v[16:19], v[120:135]
    s_lshl_b32 s37, s29, 10
    s_add_u32 s37, s37, 49152
    s_mov_b32 m0, s37
    s_add_u32 s38, s26, 0
    buffer_load_dwordx4 v245, s[12:15], s38 offen nt lds
    ds_read_b64_tr_b16 v[216:217], v242 offset:0
    ds_read_b64_tr_b16 v[218:219], v242 offset:2048
    v_exp_f32 v146, v146
    v_exp_f32 v147, v147
    v_add_f32 v4, v144, v145
    v_mfma_f32_32x32x16_bf16 v[120:135], v[180:183], v[20:23], v[120:135]
    s_lshl_b32 s37, s29, 10
    s_add_u32 s37, s37, 57344
    s_mov_b32 m0, s37
    s_sub_u32 s38, s26, 8192
    buffer_load_dwordx4 v245, s[12:15], s38 offen nt lds
    ds_read_b64_tr_b16 v[224:225], v243 offset:0
    ds_read_b64_tr_b16 v[226:227], v243 offset:2048
    v_exp_f32 v148, v148
    v_exp_f32 v149, v149
    v_add_f32 v5, v146, v147
    v_mfma_f32_32x32x16_bf16 v[120:135], v[184:187], v[24:27], v[120:135]
    s_add_u32 s26, s26, 16384
    ds_read_b64_tr_b16 v[204:205], v240 offset:4096
    ds_read_b64_tr_b16 v[206:207], v240 offset:6144
    v_exp_f32 v150, v150
    v_exp_f32 v151, v151
    v_add_f32 v6, v148, v149
    v_mfma_f32_32x32x16_bf16 v[120:135], v[188:191], v[28:31], v[120:135]
    ds_read_b64_tr_b16 v[212:213], v241 offset:4096
    ds_read_b64_tr_b16 v[214:215], v241 offset:6144
    v_add_f32 v7, v150, v151
    v_add_f32 v0, v0, v1
    v_add_f32 v1, v2, v3
    v_mfma_f32_32x32x16_bf16 v[120:135], v[192:195], v[32:35], v[120:135]
    ds_read_b64_tr_b16 v[220:221], v242 offset:4096
    ds_read_b64_tr_b16 v[222:223], v242 offset:6144
    v_add_f32 v2, v4, v5
    v_add_f32 v3, v6, v7
    v_mfma_f32_32x32x16_bf16 v[120:135], v[196:199], v[36:39], v[120:135]
    ds_read_b64_tr_b16 v[228:229], v243 offset:4096
    ds_read_b64_tr_b16 v[230:231], v243 offset:6144
    v_add_f32 v0, v0, v1
    v_add_f32 v2, v2, v3
    v_add_f32 v249, v0, v2
    v_cmp_lt_f32 vcc, s25, v249
    s_cbranch_vccnz L_gqa_attn_kernel_slow17
L_gqa_attn_kernel_res17:
    v_add_f32 v248, v248, v249
    v_cvt_pk_bf16_f32 v152, v136, v137
    v_cvt_pk_bf16_f32 v153, v138, v139
    v_cvt_pk_bf16_f32 v154, v140, v141
    v_cvt_pk_bf16_f32 v155, v142, v143
    v_cvt_pk_bf16_f32 v156, v144, v145
    v_cvt_pk_bf16_f32 v157, v146, v147
    v_cvt_pk_bf16_f32 v158, v148, v149
    v_cvt_pk_bf16_f32 v159, v150, v151
    s_waitcnt lgkmcnt(0)
    v_mfma_f32_32x32x16_bf16 v[40:55], v[200:203], v[152:155], v[40:55]
    ds_read_b128 v[168:171], v232 offset:0
    ds_read_b128 v[172:175], v233 offset:0
    v_fma_f32 v136, v120, s24, -v247
    v_fma_f32 v137, v121, s24, -v247
    v_fma_f32 v138, v122, s24, -v247
    v_mfma_f32_32x32x16_bf16 v[56:71], v[208:211], v[152:155], v[56:71]
    ds_read_b128 v[176:179], v234 offset:0
    ds_read_b128 v[180:183], v235 offset:0
    v_fma_f32 v139, v123, s24, -v247
    v_fma_f32 v140, v124, s24, -v247
    v_fma_f32 v141, v125, s24, -v247
    v_mfma_f32_32x32x16_bf16 v[72:87], v[216:219], v[152:155], v[72:87]
    ds_read_b128 v[184:187], v236 offset:0
    ds_read_b128 v[188:191], v237 offset:0
    v_exp_f32 v136, v136
    v_fma_f32 v142, v126, s24, -v247
    v_exp_f32 v137, v137
    v_mfma_f32_32x32x16_bf16 v[88:103], v[224:227], v[152:155], v[88:103]
    ds_read_b128 v[192:195], v238 offset:0
    ds_read_b128 v[196:199], v239 offset:0
    v_fma_f32 v143, v127, s24, -v247
    v_exp_f32 v138, v138
    v_fma_f32 v144, v128, s24, -v247
    v_mfma_f32_32x32x16_bf16 v[40:55], v[204:207], v[156:159], v[40:55]
    v_exp_f32 v139, v139
    v_fma_f32 v145, v129, s24, -v247
    v_add_f32 v0, v136, v137
    v_mfma_f32_32x32x16_bf16 v[56:71], v[212:215], v[156:159], v[56:71]
    v_exp_f32 v140, v140
    v_fma_f32 v146, v130, s24, -v247
    v_exp_f32 v141, v141
    v_mfma_f32_32x32x16_bf16 v[72:87], v[220:223], v[156:159], v[72:87]
    v_fma_f32 v147, v131, s24, -v247
    v_add_f32 v1, v138, v139
    v_exp_f32 v142, v142
    v_mfma_f32_32x32x16_bf16 v[88:103], v[228:231], v[156:159], v[88:103]
    v_fma_f32 v148, v132, s24, -v247
    v_exp_f32 v143, v143
    v_fma_f32 v149, v133, s24, -v247
    s_waitcnt lgkmcnt(0)
    s_waitcnt vmcnt(8)
    s_barrier
    v_mfma_f32_32x32x16_bf16 v[104:119], v[168:171], v[8:11], 0
    s_lshl_b32 s37, s29, 10
    s_add_u32 s37, s37, 65536
    s_mov_b32 m0, s37
    s_add_u32 s38, s26, 16384
    buffer_load_dwordx4 v244, s[8:11], s38 offen nt lds
    ds_read_b64_tr_b16 v[200:201], v240 offset:32768
    ds_read_b64_tr_b16 v[202:203], v240 offset:34816
    v_add_f32 v2, v140, v141
    v_exp_f32 v144, v144
    v_fma_f32 v150, v134, s24, -v247
    v_mfma_f32_32x32x16_bf16 v[104:119], v[172:175], v[12:15], v[104:119]
    s_lshl_b32 s37, s29, 10
    s_add_u32 s37, s37, 73728
    s_mov_b32 m0, s37
    s_add_u32 s38, s26, 24576
    buffer_load_dwordx4 v244, s[8:11], s38 offen nt lds
    ds_read_b64_tr_b16 v[208:209], v241 offset:32768
    ds_read_b64_tr_b16 v[210:211], v241 offset:34816
    v_exp_f32 v145, v145
    v_fma_f32 v151, v135, s24, -v247
    v_add_f32 v3, v142, v143
    v_mfma_f32_32x32x16_bf16 v[104:119], v[176:179], v[16:19], v[104:119]
    s_lshl_b32 s37, s29, 10
    s_add_u32 s37, s37, 81920
    s_mov_b32 m0, s37
    s_add_u32 s38, s26, 0
    buffer_load_dwordx4 v245, s[12:15], s38 offen nt lds
    ds_read_b64_tr_b16 v[216:217], v242 offset:32768
    ds_read_b64_tr_b16 v[218:219], v242 offset:34816
    v_exp_f32 v146, v146
    v_exp_f32 v147, v147
    v_add_f32 v4, v144, v145
    v_mfma_f32_32x32x16_bf16 v[104:119], v[180:183], v[20:23], v[104:119]
    s_lshl_b32 s37, s29, 10
    s_add_u32 s37, s37, 90112
    s_mov_b32 m0, s37
    s_sub_u32 s38, s26, 8192
    buffer_load_dwordx4 v245, s[12:15], s38 offen nt lds
    ds_read_b64_tr_b16 v[224:225], v243 offset:32768
    ds_read_b64_tr_b16 v[226:227], v243 offset:34816
    v_exp_f32 v148, v148
    v_exp_f32 v149, v149
    v_add_f32 v5, v146, v147
    v_mfma_f32_32x32x16_bf16 v[104:119], v[184:187], v[24:27], v[104:119]
    s_add_u32 s26, s26, 16384
    ds_read_b64_tr_b16 v[204:205], v240 offset:36864
    ds_read_b64_tr_b16 v[206:207], v240 offset:38912
    v_exp_f32 v150, v150
    v_exp_f32 v151, v151
    v_add_f32 v6, v148, v149
    v_mfma_f32_32x32x16_bf16 v[104:119], v[188:191], v[28:31], v[104:119]
    ds_read_b64_tr_b16 v[212:213], v241 offset:36864
    ds_read_b64_tr_b16 v[214:215], v241 offset:38912
    v_add_f32 v7, v150, v151
    v_add_f32 v0, v0, v1
    v_add_f32 v1, v2, v3
    v_mfma_f32_32x32x16_bf16 v[104:119], v[192:195], v[32:35], v[104:119]
    ds_read_b64_tr_b16 v[220:221], v242 offset:36864
    ds_read_b64_tr_b16 v[222:223], v242 offset:38912
    v_add_f32 v2, v4, v5
    v_add_f32 v3, v6, v7
    v_mfma_f32_32x32x16_bf16 v[104:119], v[196:199], v[36:39], v[104:119]
    ds_read_b64_tr_b16 v[228:229], v243 offset:36864
    ds_read_b64_tr_b16 v[230:231], v243 offset:38912
    v_add_f32 v0, v0, v1
    v_add_f32 v2, v2, v3
    v_add_f32 v249, v0, v2
    v_cmp_lt_f32 vcc, s25, v249
    s_cbranch_vccnz L_gqa_attn_kernel_slow18
L_gqa_attn_kernel_res18:
    v_add_f32 v248, v248, v249
    v_cvt_pk_bf16_f32 v160, v136, v137
    v_cvt_pk_bf16_f32 v161, v138, v139
    v_cvt_pk_bf16_f32 v162, v140, v141
    v_cvt_pk_bf16_f32 v163, v142, v143
    v_cvt_pk_bf16_f32 v164, v144, v145
    v_cvt_pk_bf16_f32 v165, v146, v147
    v_cvt_pk_bf16_f32 v166, v148, v149
    v_cvt_pk_bf16_f32 v167, v150, v151
    s_waitcnt lgkmcnt(0)
    v_mfma_f32_32x32x16_bf16 v[40:55], v[200:203], v[160:163], v[40:55]
    ds_read_b128 v[168:171], v232 offset:32768
    ds_read_b128 v[172:175], v233 offset:32768
    v_fma_f32 v136, v104, s24, -v247
    v_fma_f32 v137, v105, s24, -v247
    v_fma_f32 v138, v106, s24, -v247
    v_mfma_f32_32x32x16_bf16 v[56:71], v[208:211], v[160:163], v[56:71]
    ds_read_b128 v[176:179], v234 offset:32768
    ds_read_b128 v[180:183], v235 offset:32768
    v_fma_f32 v139, v107, s24, -v247
    v_fma_f32 v140, v108, s24, -v247
    v_fma_f32 v141, v109, s24, -v247
    v_mfma_f32_32x32x16_bf16 v[72:87], v[216:219], v[160:163], v[72:87]
    ds_read_b128 v[184:187], v236 offset:32768
    ds_read_b128 v[188:191], v237 offset:32768
    v_exp_f32 v136, v136
    v_fma_f32 v142, v110, s24, -v247
    v_exp_f32 v137, v137
    v_mfma_f32_32x32x16_bf16 v[88:103], v[224:227], v[160:163], v[88:103]
    ds_read_b128 v[192:195], v238 offset:32768
    ds_read_b128 v[196:199], v239 offset:32768
    v_fma_f32 v143, v111, s24, -v247
    v_exp_f32 v138, v138
    v_fma_f32 v144, v112, s24, -v247
    v_mfma_f32_32x32x16_bf16 v[40:55], v[204:207], v[164:167], v[40:55]
    v_exp_f32 v139, v139
    v_fma_f32 v145, v113, s24, -v247
    v_add_f32 v0, v136, v137
    v_mfma_f32_32x32x16_bf16 v[56:71], v[212:215], v[164:167], v[56:71]
    v_exp_f32 v140, v140
    v_fma_f32 v146, v114, s24, -v247
    v_exp_f32 v141, v141
    v_mfma_f32_32x32x16_bf16 v[72:87], v[220:223], v[164:167], v[72:87]
    v_fma_f32 v147, v115, s24, -v247
    v_add_f32 v1, v138, v139
    v_exp_f32 v142, v142
    v_mfma_f32_32x32x16_bf16 v[88:103], v[228:231], v[164:167], v[88:103]
    v_fma_f32 v148, v116, s24, -v247
    v_exp_f32 v143, v143
    v_fma_f32 v149, v117, s24, -v247
    s_waitcnt lgkmcnt(0)
    s_waitcnt vmcnt(8)
    s_barrier
    v_subrev_u32 v232, 0x10000, v232
    v_subrev_u32 v233, 0x10000, v233
    v_subrev_u32 v234, 0x10000, v234
    v_subrev_u32 v235, 0x10000, v235
    v_subrev_u32 v236, 0x10000, v236
    v_subrev_u32 v237, 0x10000, v237
    v_subrev_u32 v238, 0x10000, v238
    v_subrev_u32 v239, 0x10000, v239
    v_subrev_u32 v240, 0x10000, v240
    v_subrev_u32 v241, 0x10000, v241
    v_subrev_u32 v242, 0x10000, v242
    v_subrev_u32 v243, 0x10000, v243
    v_mfma_f32_32x32x16_bf16 v[120:135], v[168:171], v[8:11], 0
    s_lshl_b32 s37, s29, 10
    s_add_u32 s37, s37, 98304
    s_mov_b32 m0, s37
    s_add_u32 s38, s26, 16384
    buffer_load_dwordx4 v244, s[8:11], s38 offen nt lds
    ds_read_b64_tr_b16 v[200:201], v240 offset:0
    ds_read_b64_tr_b16 v[202:203], v240 offset:2048
    v_add_f32 v2, v140, v141
    v_exp_f32 v144, v144
    v_fma_f32 v150, v118, s24, -v247
    v_mfma_f32_32x32x16_bf16 v[120:135], v[172:175], v[12:15], v[120:135]
    s_lshl_b32 s37, s29, 10
    s_add_u32 s37, s37, 106496
    s_mov_b32 m0, s37
    s_add_u32 s38, s26, 24576
    buffer_load_dwordx4 v244, s[8:11], s38 offen nt lds
    ds_read_b64_tr_b16 v[208:209], v241 offset:0
    ds_read_b64_tr_b16 v[210:211], v241 offset:2048
    v_exp_f32 v145, v145
    v_fma_f32 v151, v119, s24, -v247
    v_add_f32 v3, v142, v143
    v_mfma_f32_32x32x16_bf16 v[120:135], v[176:179], v[16:19], v[120:135]
    s_lshl_b32 s37, s29, 10
    s_add_u32 s37, s37, 114688
    s_mov_b32 m0, s37
    s_add_u32 s38, s26, 0
    buffer_load_dwordx4 v245, s[12:15], s38 offen nt lds
    ds_read_b64_tr_b16 v[216:217], v242 offset:0
    ds_read_b64_tr_b16 v[218:219], v242 offset:2048
    v_exp_f32 v146, v146
    v_exp_f32 v147, v147
    v_add_f32 v4, v144, v145
    v_mfma_f32_32x32x16_bf16 v[120:135], v[180:183], v[20:23], v[120:135]
    s_lshl_b32 s37, s29, 10
    s_add_u32 s37, s37, 122880
    s_mov_b32 m0, s37
    s_sub_u32 s38, s26, 8192
    buffer_load_dwordx4 v245, s[12:15], s38 offen nt lds
    ds_read_b64_tr_b16 v[224:225], v243 offset:0
    ds_read_b64_tr_b16 v[226:227], v243 offset:2048
    v_exp_f32 v148, v148
    v_exp_f32 v149, v149
    v_add_f32 v5, v146, v147
    v_mfma_f32_32x32x16_bf16 v[120:135], v[184:187], v[24:27], v[120:135]
    s_add_u32 s26, s26, 16384
    ds_read_b64_tr_b16 v[204:205], v240 offset:4096
    ds_read_b64_tr_b16 v[206:207], v240 offset:6144
    v_exp_f32 v150, v150
    v_exp_f32 v151, v151
    v_add_f32 v6, v148, v149
    v_mfma_f32_32x32x16_bf16 v[120:135], v[188:191], v[28:31], v[120:135]
    ds_read_b64_tr_b16 v[212:213], v241 offset:4096
    ds_read_b64_tr_b16 v[214:215], v241 offset:6144
    v_add_f32 v7, v150, v151
    v_add_f32 v0, v0, v1
    v_add_f32 v1, v2, v3
    v_mfma_f32_32x32x16_bf16 v[120:135], v[192:195], v[32:35], v[120:135]
    ds_read_b64_tr_b16 v[220:221], v242 offset:4096
    ds_read_b64_tr_b16 v[222:223], v242 offset:6144
    v_add_f32 v2, v4, v5
    v_add_f32 v3, v6, v7
    v_mfma_f32_32x32x16_bf16 v[120:135], v[196:199], v[36:39], v[120:135]
    ds_read_b64_tr_b16 v[228:229], v243 offset:4096
    ds_read_b64_tr_b16 v[230:231], v243 offset:6144
    v_add_f32 v0, v0, v1
    v_add_f32 v2, v2, v3
    v_add_f32 v249, v0, v2
    v_cmp_lt_f32 vcc, s25, v249
    s_cbranch_vccnz L_gqa_attn_kernel_slow19
L_gqa_attn_kernel_res19:
    v_add_f32 v248, v248, v249
    v_cvt_pk_bf16_f32 v152, v136, v137
    v_cvt_pk_bf16_f32 v153, v138, v139
    v_cvt_pk_bf16_f32 v154, v140, v141
    v_cvt_pk_bf16_f32 v155, v142, v143
    v_cvt_pk_bf16_f32 v156, v144, v145
    v_cvt_pk_bf16_f32 v157, v146, v147
    v_cvt_pk_bf16_f32 v158, v148, v149
    v_cvt_pk_bf16_f32 v159, v150, v151
    s_waitcnt lgkmcnt(0)
    v_mfma_f32_32x32x16_bf16 v[40:55], v[200:203], v[152:155], v[40:55]
    ds_read_b128 v[168:171], v232 offset:0
    ds_read_b128 v[172:175], v233 offset:0
    v_fma_f32 v136, v120, s24, -v247
    v_fma_f32 v137, v121, s24, -v247
    v_fma_f32 v138, v122, s24, -v247
    v_mfma_f32_32x32x16_bf16 v[56:71], v[208:211], v[152:155], v[56:71]
    ds_read_b128 v[176:179], v234 offset:0
    ds_read_b128 v[180:183], v235 offset:0
    v_fma_f32 v139, v123, s24, -v247
    v_fma_f32 v140, v124, s24, -v247
    v_fma_f32 v141, v125, s24, -v247
    v_mfma_f32_32x32x16_bf16 v[72:87], v[216:219], v[152:155], v[72:87]
    ds_read_b128 v[184:187], v236 offset:0
    ds_read_b128 v[188:191], v237 offset:0
    v_exp_f32 v136, v136
    v_fma_f32 v142, v126, s24, -v247
    v_exp_f32 v137, v137
    v_mfma_f32_32x32x16_bf16 v[88:103], v[224:227], v[152:155], v[88:103]
    ds_read_b128 v[192:195], v238 offset:0
    ds_read_b128 v[196:199], v239 offset:0
    v_fma_f32 v143, v127, s24, -v247
    v_exp_f32 v138, v138
    v_fma_f32 v144, v128, s24, -v247
    v_mfma_f32_32x32x16_bf16 v[40:55], v[204:207], v[156:159], v[40:55]
    v_exp_f32 v139, v139
    v_fma_f32 v145, v129, s24, -v247
    v_add_f32 v0, v136, v137
    v_mfma_f32_32x32x16_bf16 v[56:71], v[212:215], v[156:159], v[56:71]
    v_exp_f32 v140, v140
    v_fma_f32 v146, v130, s24, -v247
    v_exp_f32 v141, v141
    v_mfma_f32_32x32x16_bf16 v[72:87], v[220:223], v[156:159], v[72:87]
    v_fma_f32 v147, v131, s24, -v247
    v_add_f32 v1, v138, v139
    v_exp_f32 v142, v142
    v_mfma_f32_32x32x16_bf16 v[88:103], v[228:231], v[156:159], v[88:103]
    v_fma_f32 v148, v132, s24, -v247
    v_exp_f32 v143, v143
    v_fma_f32 v149, v133, s24, -v247
    s_waitcnt lgkmcnt(0)
    s_waitcnt vmcnt(8)
    s_barrier
    v_mfma_f32_32x32x16_bf16 v[104:119], v[168:171], v[8:11], 0
    s_lshl_b32 s37, s29, 10
    s_add_u32 s37, s37, 16384
    s_mov_b32 m0, s37
    s_add_u32 s38, s26, 0
    buffer_load_dwordx4 v245, s[12:15], s38 offen nt lds
    ds_read_b64_tr_b16 v[200:201], v240 offset:32768
    ds_read_b64_tr_b16 v[202:203], v240 offset:34816
    v_add_f32 v2, v140, v141
    v_exp_f32 v144, v144
    v_fma_f32 v150, v134, s24, -v247
    v_mfma_f32_32x32x16_bf16 v[104:119], v[172:175], v[12:15], v[104:119]
    s_lshl_b32 s37, s29, 10
    s_add_u32 s37, s37, 24576
    s_mov_b32 m0, s37
    s_sub_u32 s38, s26, 8192
    buffer_load_dwordx4 v245, s[12:15], s38 offen nt lds
    ds_read_b64_tr_b16 v[208:209], v241 offset:32768
    ds_read_b64_tr_b16 v[210:211], v241 offset:34816
    v_exp_f32 v145, v145
    v_fma_f32 v151, v135, s24, -v247
    v_add_f32 v3, v142, v143
    v_mfma_f32_32x32x16_bf16 v[104:119], v[176:179], v[16:19], v[104:119]
    s_add_u32 s26, s26, 16384
    ds_read_b64_tr_b16 v[216:217], v242 offset:32768
    ds_read_b64_tr_b16 v[218:219], v242 offset:34816
    v_exp_f32 v146, v146
    v_exp_f32 v147, v147
    v_add_f32 v4, v144, v145
    v_mfma_f32_32x32x16_bf16 v[104:119], v[180:183], v[20:23], v[104:119]
    ds_read_b64_tr_b16 v[224:225], v243 offset:32768
    ds_read_b64_tr_b16 v[226:227], v243 offset:34816
    v_exp_f32 v148, v148
    v_exp_f32 v149, v149
    v_add_f32 v5, v146, v147
    v_mfma_f32_32x32x16_bf16 v[104:119], v[184:187], v[24:27], v[104:119]
    ds_read_b64_tr_b16 v[204:205], v240 offset:36864
    ds_read_b64_tr_b16 v[206:207], v240 offset:38912
    v_exp_f32 v150, v150
    v_exp_f32 v151, v151
    v_add_f32 v6, v148, v149
    v_mfma_f32_32x32x16_bf16 v[104:119], v[188:191], v[28:31], v[104:119]
    ds_read_b64_tr_b16 v[212:213], v241 offset:36864
    ds_read_b64_tr_b16 v[214:215], v241 offset:38912
    v_add_f32 v7, v150, v151
    v_add_f32 v0, v0, v1
    v_add_f32 v1, v2, v3
    v_mfma_f32_32x32x16_bf16 v[104:119], v[192:195], v[32:35], v[104:119]
    ds_read_b64_tr_b16 v[220:221], v242 offset:36864
    ds_read_b64_tr_b16 v[222:223], v242 offset:38912
    v_add_f32 v2, v4, v5
    v_add_f32 v3, v6, v7
    v_mfma_f32_32x32x16_bf16 v[104:119], v[196:199], v[36:39], v[104:119]
    ds_read_b64_tr_b16 v[228:229], v243 offset:36864
    ds_read_b64_tr_b16 v[230:231], v243 offset:38912
    v_add_f32 v0, v0, v1
    v_add_f32 v2, v2, v3
    v_add_f32 v249, v0, v2
    v_cmp_lt_f32 vcc, s25, v249
    s_cbranch_vccnz L_gqa_attn_kernel_slow20
L_gqa_attn_kernel_res20:
    v_add_f32 v248, v248, v249
    v_cvt_pk_bf16_f32 v160, v136, v137
    v_cvt_pk_bf16_f32 v161, v138, v139
    v_cvt_pk_bf16_f32 v162, v140, v141
    v_cvt_pk_bf16_f32 v163, v142, v143
    v_cvt_pk_bf16_f32 v164, v144, v145
    v_cvt_pk_bf16_f32 v165, v146, v147
    v_cvt_pk_bf16_f32 v166, v148, v149
    v_cvt_pk_bf16_f32 v167, v150, v151
    s_waitcnt lgkmcnt(0)
    v_mfma_f32_32x32x16_bf16 v[40:55], v[200:203], v[160:163], v[40:55]
    ds_read_b128 v[168:171], v232 offset:32768
    ds_read_b128 v[172:175], v233 offset:32768
    v_fma_f32 v136, v104, s24, -v247
    v_fma_f32 v137, v105, s24, -v247
    v_fma_f32 v138, v106, s24, -v247
    v_mfma_f32_32x32x16_bf16 v[56:71], v[208:211], v[160:163], v[56:71]
    ds_read_b128 v[176:179], v234 offset:32768
    ds_read_b128 v[180:183], v235 offset:32768
    v_fma_f32 v139, v107, s24, -v247
    v_fma_f32 v140, v108, s24, -v247
    v_fma_f32 v141, v109, s24, -v247
    v_mfma_f32_32x32x16_bf16 v[72:87], v[216:219], v[160:163], v[72:87]
    ds_read_b128 v[184:187], v236 offset:32768
    ds_read_b128 v[188:191], v237 offset:32768
    v_exp_f32 v136, v136
    v_fma_f32 v142, v110, s24, -v247
    v_exp_f32 v137, v137
    v_mfma_f32_32x32x16_bf16 v[88:103], v[224:227], v[160:163], v[88:103]
    ds_read_b128 v[192:195], v238 offset:32768
    ds_read_b128 v[196:199], v239 offset:32768
    v_fma_f32 v143, v111, s24, -v247
    v_exp_f32 v138, v138
    v_fma_f32 v144, v112, s24, -v247
    v_mfma_f32_32x32x16_bf16 v[40:55], v[204:207], v[164:167], v[40:55]
    v_exp_f32 v139, v139
    v_fma_f32 v145, v113, s24, -v247
    v_add_f32 v0, v136, v137
    v_mfma_f32_32x32x16_bf16 v[56:71], v[212:215], v[164:167], v[56:71]
    v_exp_f32 v140, v140
    v_fma_f32 v146, v114, s24, -v247
    v_exp_f32 v141, v141
    v_mfma_f32_32x32x16_bf16 v[72:87], v[220:223], v[164:167], v[72:87]
    v_fma_f32 v147, v115, s24, -v247
    v_add_f32 v1, v138, v139
    v_exp_f32 v142, v142
    v_mfma_f32_32x32x16_bf16 v[88:103], v[228:231], v[164:167], v[88:103]
    v_fma_f32 v148, v116, s24, -v247
    v_exp_f32 v143, v143
    v_fma_f32 v149, v117, s24, -v247
    s_waitcnt lgkmcnt(0)
    s_waitcnt vmcnt(6)
    s_barrier
    v_add_u32 v232, 0x10000, v232
    v_add_u32 v233, 0x10000, v233
    v_add_u32 v234, 0x10000, v234
    v_add_u32 v235, 0x10000, v235
    v_add_u32 v236, 0x10000, v236
    v_add_u32 v237, 0x10000, v237
    v_add_u32 v238, 0x10000, v238
    v_add_u32 v239, 0x10000, v239
    v_add_u32 v240, 0x10000, v240
    v_add_u32 v241, 0x10000, v241
    v_add_u32 v242, 0x10000, v242
    v_add_u32 v243, 0x10000, v243
    v_mfma_f32_32x32x16_bf16 v[120:135], v[168:171], v[8:11], 0
    s_lshl_b32 s37, s29, 10
    s_add_u32 s37, s37, 57344
    s_mov_b32 m0, s37
    s_sub_u32 s38, s26, 8192
    buffer_load_dwordx4 v245, s[12:15], s38 offen nt lds
    ds_read_b64_tr_b16 v[200:201], v240 offset:0
    ds_read_b64_tr_b16 v[202:203], v240 offset:2048
    v_add_f32 v2, v140, v141
    v_exp_f32 v144, v144
    v_fma_f32 v150, v118, s24, -v247
    v_mfma_f32_32x32x16_bf16 v[120:135], v[172:175], v[12:15], v[120:135]
    s_add_u32 s26, s26, 16384
    ds_read_b64_tr_b16 v[208:209], v241 offset:0
    ds_read_b64_tr_b16 v[210:211], v241 offset:2048
    v_exp_f32 v145, v145
    v_fma_f32 v151, v119, s24, -v247
    v_add_f32 v3, v142, v143
    v_mfma_f32_32x32x16_bf16 v[120:135], v[176:179], v[16:19], v[120:135]
    ds_read_b64_tr_b16 v[216:217], v242 offset:0
    ds_read_b64_tr_b16 v[218:219], v242 offset:2048
    v_exp_f32 v146, v146
    v_exp_f32 v147, v147
    v_add_f32 v4, v144, v145
    v_mfma_f32_32x32x16_bf16 v[120:135], v[180:183], v[20:23], v[120:135]
    ds_read_b64_tr_b16 v[224:225], v243 offset:0
    ds_read_b64_tr_b16 v[226:227], v243 offset:2048
    v_exp_f32 v148, v148
    v_exp_f32 v149, v149
    v_add_f32 v5, v146, v147
    v_mfma_f32_32x32x16_bf16 v[120:135], v[184:187], v[24:27], v[120:135]
    ds_read_b64_tr_b16 v[204:205], v240 offset:4096
    ds_read_b64_tr_b16 v[206:207], v240 offset:6144
    v_exp_f32 v150, v150
    v_exp_f32 v151, v151
    v_add_f32 v6, v148, v149
    v_mfma_f32_32x32x16_bf16 v[120:135], v[188:191], v[28:31], v[120:135]
    ds_read_b64_tr_b16 v[212:213], v241 offset:4096
    ds_read_b64_tr_b16 v[214:215], v241 offset:6144
    v_add_f32 v7, v150, v151
    v_add_f32 v0, v0, v1
    v_add_f32 v1, v2, v3
    v_mfma_f32_32x32x16_bf16 v[120:135], v[192:195], v[32:35], v[120:135]
    ds_read_b64_tr_b16 v[220:221], v242 offset:4096
    ds_read_b64_tr_b16 v[222:223], v242 offset:6144
    v_add_f32 v2, v4, v5
    v_add_f32 v3, v6, v7
    v_mfma_f32_32x32x16_bf16 v[120:135], v[196:199], v[36:39], v[120:135]
    ds_read_b64_tr_b16 v[228:229], v243 offset:4096
    ds_read_b64_tr_b16 v[230:231], v243 offset:6144
    v_add_f32 v0, v0, v1
    v_add_f32 v2, v2, v3
    v_add_f32 v249, v0, v2
    v_cmp_lt_f32 vcc, s25, v249
    s_cbranch_vccnz L_gqa_attn_kernel_slow21
L_gqa_attn_kernel_res21:
    v_add_f32 v248, v248, v249
    v_cvt_pk_bf16_f32 v152, v136, v137
    v_cvt_pk_bf16_f32 v153, v138, v139
    v_cvt_pk_bf16_f32 v154, v140, v141
    v_cvt_pk_bf16_f32 v155, v142, v143
    v_cvt_pk_bf16_f32 v156, v144, v145
    v_cvt_pk_bf16_f32 v157, v146, v147
    v_cvt_pk_bf16_f32 v158, v148, v149
    v_cvt_pk_bf16_f32 v159, v150, v151
    s_waitcnt lgkmcnt(0)
    v_mfma_f32_32x32x16_bf16 v[40:55], v[200:203], v[152:155], v[40:55]
    ds_read_b128 v[168:171], v232 offset:0
    ds_read_b128 v[172:175], v233 offset:0
    v_fma_f32 v136, v120, s24, -v247
    v_fma_f32 v137, v121, s24, -v247
    v_fma_f32 v138, v122, s24, -v247
    v_mfma_f32_32x32x16_bf16 v[56:71], v[208:211], v[152:155], v[56:71]
    ds_read_b128 v[176:179], v234 offset:0
    ds_read_b128 v[180:183], v235 offset:0
    v_fma_f32 v139, v123, s24, -v247
    v_fma_f32 v140, v124, s24, -v247
    v_fma_f32 v141, v125, s24, -v247
    v_mfma_f32_32x32x16_bf16 v[72:87], v[216:219], v[152:155], v[72:87]
    ds_read_b128 v[184:187], v236 offset:0
    ds_read_b128 v[188:191], v237 offset:0
    v_exp_f32 v136, v136
    v_fma_f32 v142, v126, s24, -v247
    v_exp_f32 v137, v137
    v_mfma_f32_32x32x16_bf16 v[88:103], v[224:227], v[152:155], v[88:103]
    ds_read_b128 v[192:195], v238 offset:0
    ds_read_b128 v[196:199], v239 offset:0
    v_fma_f32 v143, v127, s24, -v247
    v_exp_f32 v138, v138
    v_fma_f32 v144, v128, s24, -v247
    v_mfma_f32_32x32x16_bf16 v[40:55], v[204:207], v[156:159], v[40:55]
    v_exp_f32 v139, v139
    v_fma_f32 v145, v129, s24, -v247
    v_add_f32 v0, v136, v137
    v_mfma_f32_32x32x16_bf16 v[56:71], v[212:215], v[156:159], v[56:71]
    v_exp_f32 v140, v140
    v_fma_f32 v146, v130, s24, -v247
    v_exp_f32 v141, v141
    v_mfma_f32_32x32x16_bf16 v[72:87], v[220:223], v[156:159], v[72:87]
    v_fma_f32 v147, v131, s24, -v247
    v_add_f32 v1, v138, v139
    v_exp_f32 v142, v142
    v_mfma_f32_32x32x16_bf16 v[88:103], v[228:231], v[156:159], v[88:103]
    v_fma_f32 v148, v132, s24, -v247
    v_exp_f32 v143, v143
    v_fma_f32 v149, v133, s24, -v247
    s_waitcnt lgkmcnt(0)
    s_waitcnt vmcnt(3)
    s_barrier
    v_mfma_f32_32x32x16_bf16 v[104:119], v[168:171], v[8:11], 0
    s_add_u32 s26, s26, 16384
    ds_read_b64_tr_b16 v[200:201], v240 offset:32768
    ds_read_b64_tr_b16 v[202:203], v240 offset:34816
    v_add_f32 v2, v140, v141
    v_exp_f32 v144, v144
    v_fma_f32 v150, v134, s24, -v247
    v_mfma_f32_32x32x16_bf16 v[104:119], v[172:175], v[12:15], v[104:119]
    ds_read_b64_tr_b16 v[208:209], v241 offset:32768
    ds_read_b64_tr_b16 v[210:211], v241 offset:34816
    v_exp_f32 v145, v145
    v_fma_f32 v151, v135, s24, -v247
    v_add_f32 v3, v142, v143
    v_mfma_f32_32x32x16_bf16 v[104:119], v[176:179], v[16:19], v[104:119]
    ds_read_b64_tr_b16 v[216:217], v242 offset:32768
    ds_read_b64_tr_b16 v[218:219], v242 offset:34816
    v_exp_f32 v146, v146
    v_exp_f32 v147, v147
    v_add_f32 v4, v144, v145
    v_mfma_f32_32x32x16_bf16 v[104:119], v[180:183], v[20:23], v[104:119]
    ds_read_b64_tr_b16 v[224:225], v243 offset:32768
    ds_read_b64_tr_b16 v[226:227], v243 offset:34816
    v_exp_f32 v148, v148
    v_exp_f32 v149, v149
    v_add_f32 v5, v146, v147
    v_mfma_f32_32x32x16_bf16 v[104:119], v[184:187], v[24:27], v[104:119]
    ds_read_b64_tr_b16 v[204:205], v240 offset:36864
    ds_read_b64_tr_b16 v[206:207], v240 offset:38912
    v_exp_f32 v150, v150
    v_exp_f32 v151, v151
    v_add_f32 v6, v148, v149
    v_mfma_f32_32x32x16_bf16 v[104:119], v[188:191], v[28:31], v[104:119]
    ds_read_b64_tr_b16 v[212:213], v241 offset:36864
    ds_read_b64_tr_b16 v[214:215], v241 offset:38912
    v_add_f32 v7, v150, v151
    v_add_f32 v0, v0, v1
    v_add_f32 v1, v2, v3
    v_mfma_f32_32x32x16_bf16 v[104:119], v[192:195], v[32:35], v[104:119]
    ds_read_b64_tr_b16 v[220:221], v242 offset:36864
    ds_read_b64_tr_b16 v[222:223], v242 offset:38912
    v_add_f32 v2, v4, v5
    v_add_f32 v3, v6, v7
    v_mfma_f32_32x32x16_bf16 v[104:119], v[196:199], v[36:39], v[104:119]
    ds_read_b64_tr_b16 v[228:229], v243 offset:36864
    ds_read_b64_tr_b16 v[230:231], v243 offset:38912
    v_add_f32 v0, v0, v1
    v_add_f32 v2, v2, v3
    v_add_f32 v249, v0, v2
    v_cmp_lt_f32 vcc, s25, v249
    s_cbranch_vccnz L_gqa_attn_kernel_slow22
L_gqa_attn_kernel_res22:
    v_add_f32 v248, v248, v249
    v_cvt_pk_bf16_f32 v160, v136, v137
    v_cvt_pk_bf16_f32 v161, v138, v139
    v_cvt_pk_bf16_f32 v162, v140, v141
    v_cvt_pk_bf16_f32 v163, v142, v143
    v_cvt_pk_bf16_f32 v164, v144, v145
    v_cvt_pk_bf16_f32 v165, v146, v147
    v_cvt_pk_bf16_f32 v166, v148, v149
    v_cvt_pk_bf16_f32 v167, v150, v151
    s_waitcnt lgkmcnt(0)
    v_mfma_f32_32x32x16_bf16 v[40:55], v[200:203], v[160:163], v[40:55]
    ds_read_b128 v[168:171], v232 offset:32768
    ds_read_b128 v[172:175], v233 offset:32768
    v_fma_f32 v136, v104, s24, -v247
    v_fma_f32 v137, v105, s24, -v247
    v_fma_f32 v138, v106, s24, -v247
    v_mfma_f32_32x32x16_bf16 v[56:71], v[208:211], v[160:163], v[56:71]
    ds_read_b128 v[176:179], v234 offset:32768
    ds_read_b128 v[180:183], v235 offset:32768
    v_fma_f32 v139, v107, s24, -v247
    v_fma_f32 v140, v108, s24, -v247
    v_fma_f32 v141, v109, s24, -v247
    v_mfma_f32_32x32x16_bf16 v[72:87], v[216:219], v[160:163], v[72:87]
    ds_read_b128 v[184:187], v236 offset:32768
    ds_read_b128 v[188:191], v237 offset:32768
    v_exp_f32 v136, v136
    v_fma_f32 v142, v110, s24, -v247
    v_exp_f32 v137, v137
    v_mfma_f32_32x32x16_bf16 v[88:103], v[224:227], v[160:163], v[88:103]
    ds_read_b128 v[192:195], v238 offset:32768
    ds_read_b128 v[196:199], v239 offset:32768
    v_fma_f32 v143, v111, s24, -v247
    v_exp_f32 v138, v138
    v_fma_f32 v144, v112, s24, -v247
    v_mfma_f32_32x32x16_bf16 v[40:55], v[204:207], v[164:167], v[40:55]
    v_exp_f32 v139, v139
    v_fma_f32 v145, v113, s24, -v247
    v_add_f32 v0, v136, v137
    v_mfma_f32_32x32x16_bf16 v[56:71], v[212:215], v[164:167], v[56:71]
    v_exp_f32 v140, v140
    v_fma_f32 v146, v114, s24, -v247
    v_exp_f32 v141, v141
    v_mfma_f32_32x32x16_bf16 v[72:87], v[220:223], v[164:167], v[72:87]
    v_fma_f32 v147, v115, s24, -v247
    v_add_f32 v1, v138, v139
    v_exp_f32 v142, v142
    v_mfma_f32_32x32x16_bf16 v[88:103], v[228:231], v[164:167], v[88:103]
    v_fma_f32 v148, v116, s24, -v247
    v_exp_f32 v143, v143
    v_fma_f32 v149, v117, s24, -v247
    s_waitcnt lgkmcnt(0)
    s_waitcnt vmcnt(1)
    s_barrier
    v_subrev_u32 v232, 0x10000, v232
    v_subrev_u32 v233, 0x10000, v233
    v_subrev_u32 v234, 0x10000, v234
    v_subrev_u32 v235, 0x10000, v235
    v_subrev_u32 v236, 0x10000, v236
    v_subrev_u32 v237, 0x10000, v237
    v_subrev_u32 v238, 0x10000, v238
    v_subrev_u32 v239, 0x10000, v239
    v_subrev_u32 v240, 0x10000, v240
    v_subrev_u32 v241, 0x10000, v241
    v_subrev_u32 v242, 0x10000, v242
    v_subrev_u32 v243, 0x10000, v243
    v_mfma_f32_32x32x16_bf16 v[120:135], v[168:171], v[8:11], 0
    s_add_u32 s26, s26, 16384
    ds_read_b64_tr_b16 v[200:201], v240 offset:0
    ds_read_b64_tr_b16 v[202:203], v240 offset:2048
    v_add_f32 v2, v140, v141
    v_exp_f32 v144, v144
    v_fma_f32 v150, v118, s24, -v247
    v_mfma_f32_32x32x16_bf16 v[120:135], v[172:175], v[12:15], v[120:135]
    ds_read_b64_tr_b16 v[208:209], v241 offset:0
    ds_read_b64_tr_b16 v[210:211], v241 offset:2048
    v_exp_f32 v145, v145
    v_fma_f32 v151, v119, s24, -v247
    v_add_f32 v3, v142, v143
    v_mfma_f32_32x32x16_bf16 v[120:135], v[176:179], v[16:19], v[120:135]
    ds_read_b64_tr_b16 v[216:217], v242 offset:0
    ds_read_b64_tr_b16 v[218:219], v242 offset:2048
    v_exp_f32 v146, v146
    v_exp_f32 v147, v147
    v_add_f32 v4, v144, v145
    v_mfma_f32_32x32x16_bf16 v[120:135], v[180:183], v[20:23], v[120:135]
    ds_read_b64_tr_b16 v[224:225], v243 offset:0
    ds_read_b64_tr_b16 v[226:227], v243 offset:2048
    v_exp_f32 v148, v148
    v_exp_f32 v149, v149
    v_add_f32 v5, v146, v147
    v_mfma_f32_32x32x16_bf16 v[120:135], v[184:187], v[24:27], v[120:135]
    ds_read_b64_tr_b16 v[204:205], v240 offset:4096
    ds_read_b64_tr_b16 v[206:207], v240 offset:6144
    v_exp_f32 v150, v150
    v_exp_f32 v151, v151
    v_add_f32 v6, v148, v149
    v_mfma_f32_32x32x16_bf16 v[120:135], v[188:191], v[28:31], v[120:135]
    ds_read_b64_tr_b16 v[212:213], v241 offset:4096
    ds_read_b64_tr_b16 v[214:215], v241 offset:6144
    v_add_f32 v7, v150, v151
    v_add_f32 v0, v0, v1
    v_add_f32 v1, v2, v3
    v_mfma_f32_32x32x16_bf16 v[120:135], v[192:195], v[32:35], v[120:135]
    ds_read_b64_tr_b16 v[220:221], v242 offset:4096
    ds_read_b64_tr_b16 v[222:223], v242 offset:6144
    v_add_f32 v2, v4, v5
    v_add_f32 v3, v6, v7
    v_mfma_f32_32x32x16_bf16 v[120:135], v[196:199], v[36:39], v[120:135]
    ds_read_b64_tr_b16 v[228:229], v243 offset:4096
    ds_read_b64_tr_b16 v[230:231], v243 offset:6144
    v_add_f32 v0, v0, v1
    v_add_f32 v2, v2, v3
    v_add_f32 v249, v0, v2
    v_cmp_lt_f32 vcc, s25, v249
    s_cbranch_vccnz L_gqa_attn_kernel_slow23
L_gqa_attn_kernel_res23:
    v_add_f32 v248, v248, v249
    v_cvt_pk_bf16_f32 v152, v136, v137
    v_cvt_pk_bf16_f32 v153, v138, v139
    v_cvt_pk_bf16_f32 v154, v140, v141
    v_cvt_pk_bf16_f32 v155, v142, v143
    v_cvt_pk_bf16_f32 v156, v144, v145
    v_cvt_pk_bf16_f32 v157, v146, v147
    v_cvt_pk_bf16_f32 v158, v148, v149
    v_cvt_pk_bf16_f32 v159, v150, v151
    s_waitcnt lgkmcnt(0)
    v_mfma_f32_32x32x16_bf16 v[40:55], v[200:203], v[152:155], v[40:55]
    v_fma_f32 v136, v120, s24, -v247
    v_fma_f32 v137, v121, s24, -v247
    v_fma_f32 v138, v122, s24, -v247
    v_mfma_f32_32x32x16_bf16 v[56:71], v[208:211], v[152:155], v[56:71]
    v_fma_f32 v139, v123, s24, -v247
    v_fma_f32 v140, v124, s24, -v247
    v_fma_f32 v141, v125, s24, -v247
    v_mfma_f32_32x32x16_bf16 v[72:87], v[216:219], v[152:155], v[72:87]
    v_exp_f32 v136, v136
    v_fma_f32 v142, v126, s24, -v247
    v_exp_f32 v137, v137
    v_mfma_f32_32x32x16_bf16 v[88:103], v[224:227], v[152:155], v[88:103]
    v_fma_f32 v143, v127, s24, -v247
    v_exp_f32 v138, v138
    v_fma_f32 v144, v128, s24, -v247
    v_mfma_f32_32x32x16_bf16 v[40:55], v[204:207], v[156:159], v[40:55]
    v_exp_f32 v139, v139
    v_fma_f32 v145, v129, s24, -v247
    v_add_f32 v0, v136, v137
    v_mfma_f32_32x32x16_bf16 v[56:71], v[212:215], v[156:159], v[56:71]
    v_exp_f32 v140, v140
    v_fma_f32 v146, v130, s24, -v247
    v_exp_f32 v141, v141
    v_mfma_f32_32x32x16_bf16 v[72:87], v[220:223], v[156:159], v[72:87]
    v_fma_f32 v147, v131, s24, -v247
    v_add_f32 v1, v138, v139
    v_exp_f32 v142, v142
    v_mfma_f32_32x32x16_bf16 v[88:103], v[228:231], v[156:159], v[88:103]
    v_fma_f32 v148, v132, s24, -v247
    v_exp_f32 v143, v143
    v_fma_f32 v149, v133, s24, -v247
    s_waitcnt lgkmcnt(0)
    s_waitcnt vmcnt(0)
    s_barrier
    s_add_u32 s26, s26, 16384
    ds_read_b64_tr_b16 v[200:201], v240 offset:32768
    ds_read_b64_tr_b16 v[202:203], v240 offset:34816
    ds_read_b64_tr_b16 v[208:209], v241 offset:32768
    ds_read_b64_tr_b16 v[210:211], v241 offset:34816
    ds_read_b64_tr_b16 v[216:217], v242 offset:32768
    ds_read_b64_tr_b16 v[218:219], v242 offset:34816
    ds_read_b64_tr_b16 v[224:225], v243 offset:32768
    ds_read_b64_tr_b16 v[226:227], v243 offset:34816
    ds_read_b64_tr_b16 v[204:205], v240 offset:36864
    ds_read_b64_tr_b16 v[206:207], v240 offset:38912
    ds_read_b64_tr_b16 v[212:213], v241 offset:36864
    ds_read_b64_tr_b16 v[214:215], v241 offset:38912
    ds_read_b64_tr_b16 v[220:221], v242 offset:36864
    ds_read_b64_tr_b16 v[222:223], v242 offset:38912
    ds_read_b64_tr_b16 v[228:229], v243 offset:36864
    ds_read_b64_tr_b16 v[230:231], v243 offset:38912
    v_add_f32 v2, v140, v141
    v_exp_f32 v144, v144
    v_fma_f32 v150, v134, s24, -v247
    v_exp_f32 v145, v145
    v_fma_f32 v151, v135, s24, -v247
    v_add_f32 v3, v142, v143
    v_exp_f32 v146, v146
    v_exp_f32 v147, v147
    v_add_f32 v4, v144, v145
    v_exp_f32 v148, v148
    v_exp_f32 v149, v149
    v_add_f32 v5, v146, v147
    v_exp_f32 v150, v150
    v_exp_f32 v151, v151
    v_add_f32 v6, v148, v149
    v_add_f32 v7, v150, v151
    v_add_f32 v0, v0, v1
    v_add_f32 v1, v2, v3
    v_add_f32 v2, v4, v5
    v_add_f32 v3, v6, v7
    v_add_f32 v0, v0, v1
    v_add_f32 v2, v2, v3
    v_add_f32 v249, v0, v2
    v_cmp_lt_f32 vcc, s25, v249
    s_cbranch_vccnz L_gqa_attn_kernel_slow24
L_gqa_attn_kernel_res24:
    v_add_f32 v248, v248, v249
    v_cvt_pk_bf16_f32 v160, v136, v137
    v_cvt_pk_bf16_f32 v161, v138, v139
    v_cvt_pk_bf16_f32 v162, v140, v141
    v_cvt_pk_bf16_f32 v163, v142, v143
    v_cvt_pk_bf16_f32 v164, v144, v145
    v_cvt_pk_bf16_f32 v165, v146, v147
    v_cvt_pk_bf16_f32 v166, v148, v149
    v_cvt_pk_bf16_f32 v167, v150, v151
    s_waitcnt lgkmcnt(0)
    v_mfma_f32_32x32x16_bf16 v[40:55], v[200:203], v[160:163], v[40:55]
    v_mfma_f32_32x32x16_bf16 v[56:71], v[208:211], v[160:163], v[56:71]
    v_mfma_f32_32x32x16_bf16 v[72:87], v[216:219], v[160:163], v[72:87]
    v_mfma_f32_32x32x16_bf16 v[88:103], v[224:227], v[160:163], v[88:103]
    v_mfma_f32_32x32x16_bf16 v[40:55], v[204:207], v[164:167], v[40:55]
    v_mfma_f32_32x32x16_bf16 v[56:71], v[212:215], v[164:167], v[56:71]
    v_mfma_f32_32x32x16_bf16 v[72:87], v[220:223], v[164:167], v[72:87]
    v_mfma_f32_32x32x16_bf16 v[88:103], v[228:231], v[164:167], v[88:103]
    s_branch L_gqa_attn_kernel_epi
L_gqa_attn_kernel_slow1:
    v_max3_f32 v250, v104, v105, v106
    v_max3_f32 v251, v107, v108, v109
    v_max3_f32 v252, v110, v111, v112
    v_max3_f32 v253, v113, v114, v115
    v_max3_f32 v254, v116, v117, v118
    v_max3_f32 v250, v250, v251, v119
    v_max3_f32 v252, v252, v253, v254
    v_max_f32 v250, v250, v252
    v_mov_b32 v251, v250
    s_nop 1
    v_permlane32_swap_b32 v250, v251
    s_nop 1
    v_max3_f32 v246, v246, v250, v251
    v_mul_f32 v252, s24, v246
    v_sub_f32 v253, v247, v252
    v_exp_f32 v253, v253
    v_mov_b32 v247, v252
    s_nop 7
    s_nop 7
    v_mul_f32 v40, v40, v253
    v_mul_f32 v41, v41, v253
    v_mul_f32 v42, v42, v253
    v_mul_f32 v43, v43, v253
    v_mul_f32 v44, v44, v253
    v_mul_f32 v45, v45, v253
    v_mul_f32 v46, v46, v253
    v_mul_f32 v47, v47, v253
    v_mul_f32 v48, v48, v253
    v_mul_f32 v49, v49, v253
    v_mul_f32 v50, v50, v253
    v_mul_f32 v51, v51, v253
    v_mul_f32 v52, v52, v253
    v_mul_f32 v53, v53, v253
    v_mul_f32 v54, v54, v253
    v_mul_f32 v55, v55, v253
    v_mul_f32 v56, v56, v253
    v_mul_f32 v57, v57, v253
    v_mul_f32 v58, v58, v253
    v_mul_f32 v59, v59, v253
    v_mul_f32 v60, v60, v253
    v_mul_f32 v61, v61, v253
    v_mul_f32 v62, v62, v253
    v_mul_f32 v63, v63, v253
    v_mul_f32 v64, v64, v253
    v_mul_f32 v65, v65, v253
    v_mul_f32 v66, v66, v253
    v_mul_f32 v67, v67, v253
    v_mul_f32 v68, v68, v253
    v_mul_f32 v69, v69, v253
    v_mul_f32 v70, v70, v253
    v_mul_f32 v71, v71, v253
    v_mul_f32 v72, v72, v253
    v_mul_f32 v73, v73, v253
    v_mul_f32 v74, v74, v253
    v_mul_f32 v75, v75, v253
    v_mul_f32 v76, v76, v253
    v_mul_f32 v77, v77, v253
    v_mul_f32 v78, v78, v253
    v_mul_f32 v79, v79, v253
    v_mul_f32 v80, v80, v253
    v_mul_f32 v81, v81, v253
    v_mul_f32 v82, v82, v253
    v_mul_f32 v83, v83, v253
    v_mul_f32 v84, v84, v253
    v_mul_f32 v85, v85, v253
    v_mul_f32 v86, v86, v253
    v_mul_f32 v87, v87, v253
    v_mul_f32 v88, v88, v253
    v_mul_f32 v89, v89, v253
    v_mul_f32 v90, v90, v253
    v_mul_f32 v91, v91, v253
    v_mul_f32 v92, v92, v253
    v_mul_f32 v93, v93, v253
    v_mul_f32 v94, v94, v253
    v_mul_f32 v95, v95, v253
    v_mul_f32 v96, v96, v253
    v_mul_f32 v97, v97, v253
    v_mul_f32 v98, v98, v253
    v_mul_f32 v99, v99, v253
    v_mul_f32 v100, v100, v253
    v_mul_f32 v101, v101, v253
    v_mul_f32 v102, v102, v253
    v_mul_f32 v103, v103, v253
    v_mul_f32 v248, v248, v253
    v_fma_f32 v136, v104, s24, -v247
    v_fma_f32 v137, v105, s24, -v247
    v_fma_f32 v138, v106, s24, -v247
    v_fma_f32 v139, v107, s24, -v247
    v_fma_f32 v140, v108, s24, -v247
    v_fma_f32 v141, v109, s24, -v247
    v_exp_f32 v136, v136
    v_fma_f32 v142, v110, s24, -v247
    v_exp_f32 v137, v137
    v_fma_f32 v143, v111, s24, -v247
    v_exp_f32 v138, v138
    v_fma_f32 v144, v112, s24, -v247
    v_exp_f32 v139, v139
    v_fma_f32 v145, v113, s24, -v247
    v_add_f32 v0, v136, v137
    v_exp_f32 v140, v140
    v_fma_f32 v146, v114, s24, -v247
    v_exp_f32 v141, v141
    v_fma_f32 v147, v115, s24, -v247
    v_add_f32 v1, v138, v139
    v_exp_f32 v142, v142
    v_fma_f32 v148, v116, s24, -v247
    v_exp_f32 v143, v143
    v_fma_f32 v149, v117, s24, -v247
    v_add_f32 v2, v140, v141
    v_exp_f32 v144, v144
    v_fma_f32 v150, v118, s24, -v247
    v_exp_f32 v145, v145
    v_fma_f32 v151, v119, s24, -v247
    v_add_f32 v3, v142, v143
    v_exp_f32 v146, v146
    v_exp_f32 v147, v147
    v_add_f32 v4, v144, v145
    v_exp_f32 v148, v148
    v_exp_f32 v149, v149
    v_add_f32 v5, v146, v147
    v_exp_f32 v150, v150
    v_exp_f32 v151, v151
    v_add_f32 v6, v148, v149
    v_add_f32 v7, v150, v151
    v_add_f32 v0, v0, v1
    v_add_f32 v1, v2, v3
    v_add_f32 v2, v4, v5
    v_add_f32 v3, v6, v7
    v_add_f32 v0, v0, v1
    v_add_f32 v2, v2, v3
    v_add_f32 v249, v0, v2
    s_nop 1
    s_branch L_gqa_attn_kernel_res1
L_gqa_attn_kernel_slow2:
    v_max3_f32 v250, v120, v121, v122
    v_max3_f32 v251, v123, v124, v125
    v_max3_f32 v252, v126, v127, v128
    v_max3_f32 v253, v129, v130, v131
    v_max3_f32 v254, v132, v133, v134
    v_max3_f32 v250, v250, v251, v135
    v_max3_f32 v252, v252, v253, v254
    v_max_f32 v250, v250, v252
    v_mov_b32 v251, v250
    s_nop 1
    v_permlane32_swap_b32 v250, v251
    s_nop 1
    v_max3_f32 v246, v246, v250, v251
    v_mul_f32 v252, s24, v246
    v_sub_f32 v253, v247, v252
    v_exp_f32 v253, v253
    v_mov_b32 v247, v252
    s_nop 7
    s_nop 7
    v_mul_f32 v40, v40, v253
    v_mul_f32 v41, v41, v253
    v_mul_f32 v42, v42, v253
    v_mul_f32 v43, v43, v253
    v_mul_f32 v44, v44, v253
    v_mul_f32 v45, v45, v253
    v_mul_f32 v46, v46, v253
    v_mul_f32 v47, v47, v253
    v_mul_f32 v48, v48, v253
    v_mul_f32 v49, v49, v253
    v_mul_f32 v50, v50, v253
    v_mul_f32 v51, v51, v253
    v_mul_f32 v52, v52, v253
    v_mul_f32 v53, v53, v253
    v_mul_f32 v54, v54, v253
    v_mul_f32 v55, v55, v253
    v_mul_f32 v56, v56, v253
    v_mul_f32 v57, v57, v253
    v_mul_f32 v58, v58, v253
    v_mul_f32 v59, v59, v253
    v_mul_f32 v60, v60, v253
    v_mul_f32 v61, v61, v253
    v_mul_f32 v62, v62, v253
    v_mul_f32 v63, v63, v253
    v_mul_f32 v64, v64, v253
    v_mul_f32 v65, v65, v253
    v_mul_f32 v66, v66, v253
    v_mul_f32 v67, v67, v253
    v_mul_f32 v68, v68, v253
    v_mul_f32 v69, v69, v253
    v_mul_f32 v70, v70, v253
    v_mul_f32 v71, v71, v253
    v_mul_f32 v72, v72, v253
    v_mul_f32 v73, v73, v253
    v_mul_f32 v74, v74, v253
    v_mul_f32 v75, v75, v253
    v_mul_f32 v76, v76, v253
    v_mul_f32 v77, v77, v253
    v_mul_f32 v78, v78, v253
    v_mul_f32 v79, v79, v253
    v_mul_f32 v80, v80, v253
    v_mul_f32 v81, v81, v253
    v_mul_f32 v82, v82, v253
    v_mul_f32 v83, v83, v253
    v_mul_f32 v84, v84, v253
    v_mul_f32 v85, v85, v253
    v_mul_f32 v86, v86, v253
    v_mul_f32 v87, v87, v253
    v_mul_f32 v88, v88, v253
    v_mul_f32 v89, v89, v253
    v_mul_f32 v90, v90, v253
    v_mul_f32 v91, v91, v253
    v_mul_f32 v92, v92, v253
    v_mul_f32 v93, v93, v253
    v_mul_f32 v94, v94, v253
    v_mul_f32 v95, v95, v253
    v_mul_f32 v96, v96, v253
    v_mul_f32 v97, v97, v253
    v_mul_f32 v98, v98, v253
    v_mul_f32 v99, v99, v253
    v_mul_f32 v100, v100, v253
    v_mul_f32 v101, v101, v253
    v_mul_f32 v102, v102, v253
    v_mul_f32 v103, v103, v253
    v_mul_f32 v248, v248, v253
    v_fma_f32 v136, v120, s24, -v247
    v_fma_f32 v137, v121, s24, -v247
    v_fma_f32 v138, v122, s24, -v247
    v_fma_f32 v139, v123, s24, -v247
    v_fma_f32 v140, v124, s24, -v247
    v_fma_f32 v141, v125, s24, -v247
    v_exp_f32 v136, v136
    v_fma_f32 v142, v126, s24, -v247
    v_exp_f32 v137, v137
    v_fma_f32 v143, v127, s24, -v247
    v_exp_f32 v138, v138
    v_fma_f32 v144, v128, s24, -v247
    v_exp_f32 v139, v139
    v_fma_f32 v145, v129, s24, -v247
    v_add_f32 v0, v136, v137
    v_exp_f32 v140, v140
    v_fma_f32 v146, v130, s24, -v247
    v_exp_f32 v141, v141
    v_fma_f32 v147, v131, s24, -v247
    v_add_f32 v1, v138, v139
    v_exp_f32 v142, v142
    v_fma_f32 v148, v132, s24, -v247
    v_exp_f32 v143, v143
    v_fma_f32 v149, v133, s24, -v247
    v_add_f32 v2, v140, v141
    v_exp_f32 v144, v144
    v_fma_f32 v150, v134, s24, -v247
    v_exp_f32 v145, v145
    v_fma_f32 v151, v135, s24, -v247
    v_add_f32 v3, v142, v143
    v_exp_f32 v146, v146
    v_exp_f32 v147, v147
    v_add_f32 v4, v144, v145
    v_exp_f32 v148, v148
    v_exp_f32 v149, v149
    v_add_f32 v5, v146, v147
    v_exp_f32 v150, v150
    v_exp_f32 v151, v151
    v_add_f32 v6, v148, v149
    v_add_f32 v7, v150, v151
    v_add_f32 v0, v0, v1
    v_add_f32 v1, v2, v3
    v_add_f32 v2, v4, v5
    v_add_f32 v3, v6, v7
    v_add_f32 v0, v0, v1
    v_add_f32 v2, v2, v3
    v_add_f32 v249, v0, v2
    s_nop 1
    s_branch L_gqa_attn_kernel_res2
L_gqa_attn_kernel_slow3:
    v_max3_f32 v250, v104, v105, v106
    v_max3_f32 v251, v107, v108, v109
    v_max3_f32 v252, v110, v111, v112
    v_max3_f32 v253, v113, v114, v115
    v_max3_f32 v254, v116, v117, v118
    v_max3_f32 v250, v250, v251, v119
    v_max3_f32 v252, v252, v253, v254
    v_max_f32 v250, v250, v252
    v_mov_b32 v251, v250
    s_nop 1
    v_permlane32_swap_b32 v250, v251
    s_nop 1
    v_max3_f32 v246, v246, v250, v251
    v_mul_f32 v252, s24, v246
    v_sub_f32 v253, v247, v252
    v_exp_f32 v253, v253
    v_mov_b32 v247, v252
    s_nop 7
    s_nop 7
    v_mul_f32 v40, v40, v253
    v_mul_f32 v41, v41, v253
    v_mul_f32 v42, v42, v253
    v_mul_f32 v43, v43, v253
    v_mul_f32 v44, v44, v253
    v_mul_f32 v45, v45, v253
    v_mul_f32 v46, v46, v253
    v_mul_f32 v47, v47, v253
    v_mul_f32 v48, v48, v253
    v_mul_f32 v49, v49, v253
    v_mul_f32 v50, v50, v253
    v_mul_f32 v51, v51, v253
    v_mul_f32 v52, v52, v253
    v_mul_f32 v53, v53, v253
    v_mul_f32 v54, v54, v253
    v_mul_f32 v55, v55, v253
    v_mul_f32 v56, v56, v253
    v_mul_f32 v57, v57, v253
    v_mul_f32 v58, v58, v253
    v_mul_f32 v59, v59, v253
    v_mul_f32 v60, v60, v253
    v_mul_f32 v61, v61, v253
    v_mul_f32 v62, v62, v253
    v_mul_f32 v63, v63, v253
    v_mul_f32 v64, v64, v253
    v_mul_f32 v65, v65, v253
    v_mul_f32 v66, v66, v253
    v_mul_f32 v67, v67, v253
    v_mul_f32 v68, v68, v253
    v_mul_f32 v69, v69, v253
    v_mul_f32 v70, v70, v253
    v_mul_f32 v71, v71, v253
    v_mul_f32 v72, v72, v253
    v_mul_f32 v73, v73, v253
    v_mul_f32 v74, v74, v253
    v_mul_f32 v75, v75, v253
    v_mul_f32 v76, v76, v253
    v_mul_f32 v77, v77, v253
    v_mul_f32 v78, v78, v253
    v_mul_f32 v79, v79, v253
    v_mul_f32 v80, v80, v253
    v_mul_f32 v81, v81, v253
    v_mul_f32 v82, v82, v253
    v_mul_f32 v83, v83, v253
    v_mul_f32 v84, v84, v253
    v_mul_f32 v85, v85, v253
    v_mul_f32 v86, v86, v253
    v_mul_f32 v87, v87, v253
    v_mul_f32 v88, v88, v253
    v_mul_f32 v89, v89, v253
    v_mul_f32 v90, v90, v253
    v_mul_f32 v91, v91, v253
    v_mul_f32 v92, v92, v253
    v_mul_f32 v93, v93, v253
    v_mul_f32 v94, v94, v253
    v_mul_f32 v95, v95, v253
    v_mul_f32 v96, v96, v253
    v_mul_f32 v97, v97, v253
    v_mul_f32 v98, v98, v253
    v_mul_f32 v99, v99, v253
    v_mul_f32 v100, v100, v253
    v_mul_f32 v101, v101, v253
    v_mul_f32 v102, v102, v253
    v_mul_f32 v103, v103, v253
    v_mul_f32 v248, v248, v253
    v_fma_f32 v136, v104, s24, -v247
    v_fma_f32 v137, v105, s24, -v247
    v_fma_f32 v138, v106, s24, -v247
    v_fma_f32 v139, v107, s24, -v247
    v_fma_f32 v140, v108, s24, -v247
    v_fma_f32 v141, v109, s24, -v247
    v_exp_f32 v136, v136
    v_fma_f32 v142, v110, s24, -v247
    v_exp_f32 v137, v137
    v_fma_f32 v143, v111, s24, -v247
    v_exp_f32 v138, v138
    v_fma_f32 v144, v112, s24, -v247
    v_exp_f32 v139, v139
    v_fma_f32 v145, v113, s24, -v247
    v_add_f32 v0, v136, v137
    v_exp_f32 v140, v140
    v_fma_f32 v146, v114, s24, -v247
    v_exp_f32 v141, v141
    v_fma_f32 v147, v115, s24, -v247
    v_add_f32 v1, v138, v139
    v_exp_f32 v142, v142
    v_fma_f32 v148, v116, s24, -v247
    v_exp_f32 v143, v143
    v_fma_f32 v149, v117, s24, -v247
    v_add_f32 v2, v140, v141
    v_exp_f32 v144, v144
    v_fma_f32 v150, v118, s24, -v247
    v_exp_f32 v145, v145
    v_fma_f32 v151, v119, s24, -v247
    v_add_f32 v3, v142, v143
    v_exp_f32 v146, v146
    v_exp_f32 v147, v147
    v_add_f32 v4, v144, v145
    v_exp_f32 v148, v148
    v_exp_f32 v149, v149
    v_add_f32 v5, v146, v147
    v_exp_f32 v150, v150
    v_exp_f32 v151, v151
    v_add_f32 v6, v148, v149
    v_add_f32 v7, v150, v151
    v_add_f32 v0, v0, v1
    v_add_f32 v1, v2, v3
    v_add_f32 v2, v4, v5
    v_add_f32 v3, v6, v7
    v_add_f32 v0, v0, v1
    v_add_f32 v2, v2, v3
    v_add_f32 v249, v0, v2
    s_nop 1
    s_branch L_gqa_attn_kernel_res3
L_gqa_attn_kernel_slow4:
    v_max3_f32 v250, v120, v121, v122
    v_max3_f32 v251, v123, v124, v125
    v_max3_f32 v252, v126, v127, v128
    v_max3_f32 v253, v129, v130, v131
    v_max3_f32 v254, v132, v133, v134
    v_max3_f32 v250, v250, v251, v135
    v_max3_f32 v252, v252, v253, v254
    v_max_f32 v250, v250, v252
    v_mov_b32 v251, v250
    s_nop 1
    v_permlane32_swap_b32 v250, v251
    s_nop 1
    v_max3_f32 v246, v246, v250, v251
    v_mul_f32 v252, s24, v246
    v_sub_f32 v253, v247, v252
    v_exp_f32 v253, v253
    v_mov_b32 v247, v252
    s_nop 7
    s_nop 7
    v_mul_f32 v40, v40, v253
    v_mul_f32 v41, v41, v253
    v_mul_f32 v42, v42, v253
    v_mul_f32 v43, v43, v253
    v_mul_f32 v44, v44, v253
    v_mul_f32 v45, v45, v253
    v_mul_f32 v46, v46, v253
    v_mul_f32 v47, v47, v253
    v_mul_f32 v48, v48, v253
    v_mul_f32 v49, v49, v253
    v_mul_f32 v50, v50, v253
    v_mul_f32 v51, v51, v253
    v_mul_f32 v52, v52, v253
    v_mul_f32 v53, v53, v253
    v_mul_f32 v54, v54, v253
    v_mul_f32 v55, v55, v253
    v_mul_f32 v56, v56, v253
    v_mul_f32 v57, v57, v253
    v_mul_f32 v58, v58, v253
    v_mul_f32 v59, v59, v253
    v_mul_f32 v60, v60, v253
    v_mul_f32 v61, v61, v253
    v_mul_f32 v62, v62, v253
    v_mul_f32 v63, v63, v253
    v_mul_f32 v64, v64, v253
    v_mul_f32 v65, v65, v253
    v_mul_f32 v66, v66, v253
    v_mul_f32 v67, v67, v253
    v_mul_f32 v68, v68, v253
    v_mul_f32 v69, v69, v253
    v_mul_f32 v70, v70, v253
    v_mul_f32 v71, v71, v253
    v_mul_f32 v72, v72, v253
    v_mul_f32 v73, v73, v253
    v_mul_f32 v74, v74, v253
    v_mul_f32 v75, v75, v253
    v_mul_f32 v76, v76, v253
    v_mul_f32 v77, v77, v253
    v_mul_f32 v78, v78, v253
    v_mul_f32 v79, v79, v253
    v_mul_f32 v80, v80, v253
    v_mul_f32 v81, v81, v253
    v_mul_f32 v82, v82, v253
    v_mul_f32 v83, v83, v253
    v_mul_f32 v84, v84, v253
    v_mul_f32 v85, v85, v253
    v_mul_f32 v86, v86, v253
    v_mul_f32 v87, v87, v253
    v_mul_f32 v88, v88, v253
    v_mul_f32 v89, v89, v253
    v_mul_f32 v90, v90, v253
    v_mul_f32 v91, v91, v253
    v_mul_f32 v92, v92, v253
    v_mul_f32 v93, v93, v253
    v_mul_f32 v94, v94, v253
    v_mul_f32 v95, v95, v253
    v_mul_f32 v96, v96, v253
    v_mul_f32 v97, v97, v253
    v_mul_f32 v98, v98, v253
    v_mul_f32 v99, v99, v253
    v_mul_f32 v100, v100, v253
    v_mul_f32 v101, v101, v253
    v_mul_f32 v102, v102, v253
    v_mul_f32 v103, v103, v253
    v_mul_f32 v248, v248, v253
    v_fma_f32 v136, v120, s24, -v247
    v_fma_f32 v137, v121, s24, -v247
    v_fma_f32 v138, v122, s24, -v247
    v_fma_f32 v139, v123, s24, -v247
    v_fma_f32 v140, v124, s24, -v247
    v_fma_f32 v141, v125, s24, -v247
    v_exp_f32 v136, v136
    v_fma_f32 v142, v126, s24, -v247
    v_exp_f32 v137, v137
    v_fma_f32 v143, v127, s24, -v247
    v_exp_f32 v138, v138
    v_fma_f32 v144, v128, s24, -v247
    v_exp_f32 v139, v139
    v_fma_f32 v145, v129, s24, -v247
    v_add_f32 v0, v136, v137
    v_exp_f32 v140, v140
    v_fma_f32 v146, v130, s24, -v247
    v_exp_f32 v141, v141
    v_fma_f32 v147, v131, s24, -v247
    v_add_f32 v1, v138, v139
    v_exp_f32 v142, v142
    v_fma_f32 v148, v132, s24, -v247
    v_exp_f32 v143, v143
    v_fma_f32 v149, v133, s24, -v247
    v_add_f32 v2, v140, v141
    v_exp_f32 v144, v144
    v_fma_f32 v150, v134, s24, -v247
    v_exp_f32 v145, v145
    v_fma_f32 v151, v135, s24, -v247
    v_add_f32 v3, v142, v143
    v_exp_f32 v146, v146
    v_exp_f32 v147, v147
    v_add_f32 v4, v144, v145
    v_exp_f32 v148, v148
    v_exp_f32 v149, v149
    v_add_f32 v5, v146, v147
    v_exp_f32 v150, v150
    v_exp_f32 v151, v151
    v_add_f32 v6, v148, v149
    v_add_f32 v7, v150, v151
    v_add_f32 v0, v0, v1
    v_add_f32 v1, v2, v3
    v_add_f32 v2, v4, v5
    v_add_f32 v3, v6, v7
    v_add_f32 v0, v0, v1
    v_add_f32 v2, v2, v3
    v_add_f32 v249, v0, v2
    s_nop 1
    s_branch L_gqa_attn_kernel_res4
L_gqa_attn_kernel_slow5:
    v_max3_f32 v250, v104, v105, v106
    v_max3_f32 v251, v107, v108, v109
    v_max3_f32 v252, v110, v111, v112
    v_max3_f32 v253, v113, v114, v115
    v_max3_f32 v254, v116, v117, v118
    v_max3_f32 v250, v250, v251, v119
    v_max3_f32 v252, v252, v253, v254
    v_max_f32 v250, v250, v252
    v_mov_b32 v251, v250
    s_nop 1
    v_permlane32_swap_b32 v250, v251
    s_nop 1
    v_max3_f32 v246, v246, v250, v251
    v_mul_f32 v252, s24, v246
    v_sub_f32 v253, v247, v252
    v_exp_f32 v253, v253
    v_mov_b32 v247, v252
    s_nop 7
    s_nop 7
    v_mul_f32 v40, v40, v253
    v_mul_f32 v41, v41, v253
    v_mul_f32 v42, v42, v253
    v_mul_f32 v43, v43, v253
    v_mul_f32 v44, v44, v253
    v_mul_f32 v45, v45, v253
    v_mul_f32 v46, v46, v253
    v_mul_f32 v47, v47, v253
    v_mul_f32 v48, v48, v253
    v_mul_f32 v49, v49, v253
    v_mul_f32 v50, v50, v253
    v_mul_f32 v51, v51, v253
    v_mul_f32 v52, v52, v253
    v_mul_f32 v53, v53, v253
    v_mul_f32 v54, v54, v253
    v_mul_f32 v55, v55, v253
    v_mul_f32 v56, v56, v253
    v_mul_f32 v57, v57, v253
    v_mul_f32 v58, v58, v253
    v_mul_f32 v59, v59, v253
    v_mul_f32 v60, v60, v253
    v_mul_f32 v61, v61, v253
    v_mul_f32 v62, v62, v253
    v_mul_f32 v63, v63, v253
    v_mul_f32 v64, v64, v253
    v_mul_f32 v65, v65, v253
    v_mul_f32 v66, v66, v253
    v_mul_f32 v67, v67, v253
    v_mul_f32 v68, v68, v253
    v_mul_f32 v69, v69, v253
    v_mul_f32 v70, v70, v253
    v_mul_f32 v71, v71, v253
    v_mul_f32 v72, v72, v253
    v_mul_f32 v73, v73, v253
    v_mul_f32 v74, v74, v253
    v_mul_f32 v75, v75, v253
    v_mul_f32 v76, v76, v253
    v_mul_f32 v77, v77, v253
    v_mul_f32 v78, v78, v253
    v_mul_f32 v79, v79, v253
    v_mul_f32 v80, v80, v253
    v_mul_f32 v81, v81, v253
    v_mul_f32 v82, v82, v253
    v_mul_f32 v83, v83, v253
    v_mul_f32 v84, v84, v253
    v_mul_f32 v85, v85, v253
    v_mul_f32 v86, v86, v253
    v_mul_f32 v87, v87, v253
    v_mul_f32 v88, v88, v253
    v_mul_f32 v89, v89, v253
    v_mul_f32 v90, v90, v253
    v_mul_f32 v91, v91, v253
    v_mul_f32 v92, v92, v253
    v_mul_f32 v93, v93, v253
    v_mul_f32 v94, v94, v253
    v_mul_f32 v95, v95, v253
    v_mul_f32 v96, v96, v253
    v_mul_f32 v97, v97, v253
    v_mul_f32 v98, v98, v253
    v_mul_f32 v99, v99, v253
    v_mul_f32 v100, v100, v253
    v_mul_f32 v101, v101, v253
    v_mul_f32 v102, v102, v253
    v_mul_f32 v103, v103, v253
    v_mul_f32 v248, v248, v253
    v_fma_f32 v136, v104, s24, -v247
    v_fma_f32 v137, v105, s24, -v247
    v_fma_f32 v138, v106, s24, -v247
    v_fma_f32 v139, v107, s24, -v247
    v_fma_f32 v140, v108, s24, -v247
    v_fma_f32 v141, v109, s24, -v247
    v_exp_f32 v136, v136
    v_fma_f32 v142, v110, s24, -v247
    v_exp_f32 v137, v137
    v_fma_f32 v143, v111, s24, -v247
    v_exp_f32 v138, v138
    v_fma_f32 v144, v112, s24, -v247
    v_exp_f32 v139, v139
    v_fma_f32 v145, v113, s24, -v247
    v_add_f32 v0, v136, v137
    v_exp_f32 v140, v140
    v_fma_f32 v146, v114, s24, -v247
    v_exp_f32 v141, v141
    v_fma_f32 v147, v115, s24, -v247
    v_add_f32 v1, v138, v139
    v_exp_f32 v142, v142
    v_fma_f32 v148, v116, s24, -v247
    v_exp_f32 v143, v143
    v_fma_f32 v149, v117, s24, -v247
    v_add_f32 v2, v140, v141
    v_exp_f32 v144, v144
    v_fma_f32 v150, v118, s24, -v247
    v_exp_f32 v145, v145
    v_fma_f32 v151, v119, s24, -v247
    v_add_f32 v3, v142, v143
    v_exp_f32 v146, v146
    v_exp_f32 v147, v147
    v_add_f32 v4, v144, v145
    v_exp_f32 v148, v148
    v_exp_f32 v149, v149
    v_add_f32 v5, v146, v147
    v_exp_f32 v150, v150
    v_exp_f32 v151, v151
    v_add_f32 v6, v148, v149
    v_add_f32 v7, v150, v151
    v_add_f32 v0, v0, v1
    v_add_f32 v1, v2, v3
    v_add_f32 v2, v4, v5
    v_add_f32 v3, v6, v7
    v_add_f32 v0, v0, v1
    v_add_f32 v2, v2, v3
    v_add_f32 v249, v0, v2
    s_nop 1
    s_branch L_gqa_attn_kernel_res5
L_gqa_attn_kernel_slow6:
    v_max3_f32 v250, v120, v121, v122
    v_max3_f32 v251, v123, v124, v125
    v_max3_f32 v252, v126, v127, v128
    v_max3_f32 v253, v129, v130, v131
    v_max3_f32 v254, v132, v133, v134
    v_max3_f32 v250, v250, v251, v135
    v_max3_f32 v252, v252, v253, v254
    v_max_f32 v250, v250, v252
    v_mov_b32 v251, v250
    s_nop 1
    v_permlane32_swap_b32 v250, v251
    s_nop 1
    v_max3_f32 v246, v246, v250, v251
    v_mul_f32 v252, s24, v246
    v_sub_f32 v253, v247, v252
    v_exp_f32 v253, v253
    v_mov_b32 v247, v252
    s_nop 7
    s_nop 7
    v_mul_f32 v40, v40, v253
    v_mul_f32 v41, v41, v253
    v_mul_f32 v42, v42, v253
    v_mul_f32 v43, v43, v253
    v_mul_f32 v44, v44, v253
    v_mul_f32 v45, v45, v253
    v_mul_f32 v46, v46, v253
    v_mul_f32 v47, v47, v253
    v_mul_f32 v48, v48, v253
    v_mul_f32 v49, v49, v253
    v_mul_f32 v50, v50, v253
    v_mul_f32 v51, v51, v253
    v_mul_f32 v52, v52, v253
    v_mul_f32 v53, v53, v253
    v_mul_f32 v54, v54, v253
    v_mul_f32 v55, v55, v253
    v_mul_f32 v56, v56, v253
    v_mul_f32 v57, v57, v253
    v_mul_f32 v58, v58, v253
    v_mul_f32 v59, v59, v253
    v_mul_f32 v60, v60, v253
    v_mul_f32 v61, v61, v253
    v_mul_f32 v62, v62, v253
    v_mul_f32 v63, v63, v253
    v_mul_f32 v64, v64, v253
    v_mul_f32 v65, v65, v253
    v_mul_f32 v66, v66, v253
    v_mul_f32 v67, v67, v253
    v_mul_f32 v68, v68, v253
    v_mul_f32 v69, v69, v253
    v_mul_f32 v70, v70, v253
    v_mul_f32 v71, v71, v253
    v_mul_f32 v72, v72, v253
    v_mul_f32 v73, v73, v253
    v_mul_f32 v74, v74, v253
    v_mul_f32 v75, v75, v253
    v_mul_f32 v76, v76, v253
    v_mul_f32 v77, v77, v253
    v_mul_f32 v78, v78, v253
    v_mul_f32 v79, v79, v253
    v_mul_f32 v80, v80, v253
    v_mul_f32 v81, v81, v253
    v_mul_f32 v82, v82, v253
    v_mul_f32 v83, v83, v253
    v_mul_f32 v84, v84, v253
    v_mul_f32 v85, v85, v253
    v_mul_f32 v86, v86, v253
    v_mul_f32 v87, v87, v253
    v_mul_f32 v88, v88, v253
    v_mul_f32 v89, v89, v253
    v_mul_f32 v90, v90, v253
    v_mul_f32 v91, v91, v253
    v_mul_f32 v92, v92, v253
    v_mul_f32 v93, v93, v253
    v_mul_f32 v94, v94, v253
    v_mul_f32 v95, v95, v253
    v_mul_f32 v96, v96, v253
    v_mul_f32 v97, v97, v253
    v_mul_f32 v98, v98, v253
    v_mul_f32 v99, v99, v253
    v_mul_f32 v100, v100, v253
    v_mul_f32 v101, v101, v253
    v_mul_f32 v102, v102, v253
    v_mul_f32 v103, v103, v253
    v_mul_f32 v248, v248, v253
    v_fma_f32 v136, v120, s24, -v247
    v_fma_f32 v137, v121, s24, -v247
    v_fma_f32 v138, v122, s24, -v247
    v_fma_f32 v139, v123, s24, -v247
    v_fma_f32 v140, v124, s24, -v247
    v_fma_f32 v141, v125, s24, -v247
    v_exp_f32 v136, v136
    v_fma_f32 v142, v126, s24, -v247
    v_exp_f32 v137, v137
    v_fma_f32 v143, v127, s24, -v247
    v_exp_f32 v138, v138
    v_fma_f32 v144, v128, s24, -v247
    v_exp_f32 v139, v139
    v_fma_f32 v145, v129, s24, -v247
    v_add_f32 v0, v136, v137
    v_exp_f32 v140, v140
    v_fma_f32 v146, v130, s24, -v247
    v_exp_f32 v141, v141
    v_fma_f32 v147, v131, s24, -v247
    v_add_f32 v1, v138, v139
    v_exp_f32 v142, v142
    v_fma_f32 v148, v132, s24, -v247
    v_exp_f32 v143, v143
    v_fma_f32 v149, v133, s24, -v247
    v_add_f32 v2, v140, v141
    v_exp_f32 v144, v144
    v_fma_f32 v150, v134, s24, -v247
    v_exp_f32 v145, v145
    v_fma_f32 v151, v135, s24, -v247
    v_add_f32 v3, v142, v143
    v_exp_f32 v146, v146
    v_exp_f32 v147, v147
    v_add_f32 v4, v144, v145
    v_exp_f32 v148, v148
    v_exp_f32 v149, v149
    v_add_f32 v5, v146, v147
    v_exp_f32 v150, v150
    v_exp_f32 v151, v151
    v_add_f32 v6, v148, v149
    v_add_f32 v7, v150, v151
    v_add_f32 v0, v0, v1
    v_add_f32 v1, v2, v3
    v_add_f32 v2, v4, v5
    v_add_f32 v3, v6, v7
    v_add_f32 v0, v0, v1
    v_add_f32 v2, v2, v3
    v_add_f32 v249, v0, v2
    s_nop 1
    s_branch L_gqa_attn_kernel_res6
L_gqa_attn_kernel_slow7:
    v_max3_f32 v250, v104, v105, v106
    v_max3_f32 v251, v107, v108, v109
    v_max3_f32 v252, v110, v111, v112
    v_max3_f32 v253, v113, v114, v115
    v_max3_f32 v254, v116, v117, v118
    v_max3_f32 v250, v250, v251, v119
    v_max3_f32 v252, v252, v253, v254
    v_max_f32 v250, v250, v252
    v_mov_b32 v251, v250
    s_nop 1
    v_permlane32_swap_b32 v250, v251
    s_nop 1
    v_max3_f32 v246, v246, v250, v251
    v_mul_f32 v252, s24, v246
    v_sub_f32 v253, v247, v252
    v_exp_f32 v253, v253
    v_mov_b32 v247, v252
    s_nop 7
    s_nop 7
    v_mul_f32 v40, v40, v253
    v_mul_f32 v41, v41, v253
    v_mul_f32 v42, v42, v253
    v_mul_f32 v43, v43, v253
    v_mul_f32 v44, v44, v253
    v_mul_f32 v45, v45, v253
    v_mul_f32 v46, v46, v253
    v_mul_f32 v47, v47, v253
    v_mul_f32 v48, v48, v253
    v_mul_f32 v49, v49, v253
    v_mul_f32 v50, v50, v253
    v_mul_f32 v51, v51, v253
    v_mul_f32 v52, v52, v253
    v_mul_f32 v53, v53, v253
    v_mul_f32 v54, v54, v253
    v_mul_f32 v55, v55, v253
    v_mul_f32 v56, v56, v253
    v_mul_f32 v57, v57, v253
    v_mul_f32 v58, v58, v253
    v_mul_f32 v59, v59, v253
    v_mul_f32 v60, v60, v253
    v_mul_f32 v61, v61, v253
    v_mul_f32 v62, v62, v253
    v_mul_f32 v63, v63, v253
    v_mul_f32 v64, v64, v253
    v_mul_f32 v65, v65, v253
    v_mul_f32 v66, v66, v253
    v_mul_f32 v67, v67, v253
    v_mul_f32 v68, v68, v253
    v_mul_f32 v69, v69, v253
    v_mul_f32 v70, v70, v253
    v_mul_f32 v71, v71, v253
    v_mul_f32 v72, v72, v253
    v_mul_f32 v73, v73, v253
    v_mul_f32 v74, v74, v253
    v_mul_f32 v75, v75, v253
    v_mul_f32 v76, v76, v253
    v_mul_f32 v77, v77, v253
    v_mul_f32 v78, v78, v253
    v_mul_f32 v79, v79, v253
    v_mul_f32 v80, v80, v253
    v_mul_f32 v81, v81, v253
    v_mul_f32 v82, v82, v253
    v_mul_f32 v83, v83, v253
    v_mul_f32 v84, v84, v253
    v_mul_f32 v85, v85, v253
    v_mul_f32 v86, v86, v253
    v_mul_f32 v87, v87, v253
    v_mul_f32 v88, v88, v253
    v_mul_f32 v89, v89, v253
    v_mul_f32 v90, v90, v253
    v_mul_f32 v91, v91, v253
    v_mul_f32 v92, v92, v253
    v_mul_f32 v93, v93, v253
    v_mul_f32 v94, v94, v253
    v_mul_f32 v95, v95, v253
    v_mul_f32 v96, v96, v253
    v_mul_f32 v97, v97, v253
    v_mul_f32 v98, v98, v253
    v_mul_f32 v99, v99, v253
    v_mul_f32 v100, v100, v253
    v_mul_f32 v101, v101, v253
    v_mul_f32 v102, v102, v253
    v_mul_f32 v103, v103, v253
    v_mul_f32 v248, v248, v253
    v_fma_f32 v136, v104, s24, -v247
    v_fma_f32 v137, v105, s24, -v247
    v_fma_f32 v138, v106, s24, -v247
    v_fma_f32 v139, v107, s24, -v247
    v_fma_f32 v140, v108, s24, -v247
    v_fma_f32 v141, v109, s24, -v247
    v_exp_f32 v136, v136
    v_fma_f32 v142, v110, s24, -v247
    v_exp_f32 v137, v137
    v_fma_f32 v143, v111, s24, -v247
    v_exp_f32 v138, v138
    v_fma_f32 v144, v112, s24, -v247
    v_exp_f32 v139, v139
    v_fma_f32 v145, v113, s24, -v247
    v_add_f32 v0, v136, v137
    v_exp_f32 v140, v140
    v_fma_f32 v146, v114, s24, -v247
    v_exp_f32 v141, v141
    v_fma_f32 v147, v115, s24, -v247
    v_add_f32 v1, v138, v139
    v_exp_f32 v142, v142
    v_fma_f32 v148, v116, s24, -v247
    v_exp_f32 v143, v143
    v_fma_f32 v149, v117, s24, -v247
    v_add_f32 v2, v140, v141
    v_exp_f32 v144, v144
    v_fma_f32 v150, v118, s24, -v247
    v_exp_f32 v145, v145
    v_fma_f32 v151, v119, s24, -v247
    v_add_f32 v3, v142, v143
    v_exp_f32 v146, v146
    v_exp_f32 v147, v147
    v_add_f32 v4, v144, v145
    v_exp_f32 v148, v148
    v_exp_f32 v149, v149
    v_add_f32 v5, v146, v147
    v_exp_f32 v150, v150
    v_exp_f32 v151, v151
    v_add_f32 v6, v148, v149
    v_add_f32 v7, v150, v151
    v_add_f32 v0, v0, v1
    v_add_f32 v1, v2, v3
    v_add_f32 v2, v4, v5
    v_add_f32 v3, v6, v7
    v_add_f32 v0, v0, v1
    v_add_f32 v2, v2, v3
    v_add_f32 v249, v0, v2
    s_nop 1
    s_branch L_gqa_attn_kernel_res7
L_gqa_attn_kernel_slow8:
    v_max3_f32 v250, v120, v121, v122
    v_max3_f32 v251, v123, v124, v125
    v_max3_f32 v252, v126, v127, v128
    v_max3_f32 v253, v129, v130, v131
    v_max3_f32 v254, v132, v133, v134
    v_max3_f32 v250, v250, v251, v135
    v_max3_f32 v252, v252, v253, v254
    v_max_f32 v250, v250, v252
    v_mov_b32 v251, v250
    s_nop 1
    v_permlane32_swap_b32 v250, v251
    s_nop 1
    v_max3_f32 v246, v246, v250, v251
    v_mul_f32 v252, s24, v246
    v_sub_f32 v253, v247, v252
    v_exp_f32 v253, v253
    v_mov_b32 v247, v252
    s_nop 7
    s_nop 7
    v_mul_f32 v40, v40, v253
    v_mul_f32 v41, v41, v253
    v_mul_f32 v42, v42, v253
    v_mul_f32 v43, v43, v253
    v_mul_f32 v44, v44, v253
    v_mul_f32 v45, v45, v253
    v_mul_f32 v46, v46, v253
    v_mul_f32 v47, v47, v253
    v_mul_f32 v48, v48, v253
    v_mul_f32 v49, v49, v253
    v_mul_f32 v50, v50, v253
    v_mul_f32 v51, v51, v253
    v_mul_f32 v52, v52, v253
    v_mul_f32 v53, v53, v253
    v_mul_f32 v54, v54, v253
    v_mul_f32 v55, v55, v253
    v_mul_f32 v56, v56, v253
    v_mul_f32 v57, v57, v253
    v_mul_f32 v58, v58, v253
    v_mul_f32 v59, v59, v253
    v_mul_f32 v60, v60, v253
    v_mul_f32 v61, v61, v253
    v_mul_f32 v62, v62, v253
    v_mul_f32 v63, v63, v253
    v_mul_f32 v64, v64, v253
    v_mul_f32 v65, v65, v253
    v_mul_f32 v66, v66, v253
    v_mul_f32 v67, v67, v253
    v_mul_f32 v68, v68, v253
    v_mul_f32 v69, v69, v253
    v_mul_f32 v70, v70, v253
    v_mul_f32 v71, v71, v253
    v_mul_f32 v72, v72, v253
    v_mul_f32 v73, v73, v253
    v_mul_f32 v74, v74, v253
    v_mul_f32 v75, v75, v253
    v_mul_f32 v76, v76, v253
    v_mul_f32 v77, v77, v253
    v_mul_f32 v78, v78, v253
    v_mul_f32 v79, v79, v253
    v_mul_f32 v80, v80, v253
    v_mul_f32 v81, v81, v253
    v_mul_f32 v82, v82, v253
    v_mul_f32 v83, v83, v253
    v_mul_f32 v84, v84, v253
    v_mul_f32 v85, v85, v253
    v_mul_f32 v86, v86, v253
    v_mul_f32 v87, v87, v253
    v_mul_f32 v88, v88, v253
    v_mul_f32 v89, v89, v253
    v_mul_f32 v90, v90, v253
    v_mul_f32 v91, v91, v253
    v_mul_f32 v92, v92, v253
    v_mul_f32 v93, v93, v253
    v_mul_f32 v94, v94, v253
    v_mul_f32 v95, v95, v253
    v_mul_f32 v96, v96, v253
    v_mul_f32 v97, v97, v253
    v_mul_f32 v98, v98, v253
    v_mul_f32 v99, v99, v253
    v_mul_f32 v100, v100, v253
    v_mul_f32 v101, v101, v253
    v_mul_f32 v102, v102, v253
    v_mul_f32 v103, v103, v253
    v_mul_f32 v248, v248, v253
    v_fma_f32 v136, v120, s24, -v247
    v_fma_f32 v137, v121, s24, -v247
    v_fma_f32 v138, v122, s24, -v247
    v_fma_f32 v139, v123, s24, -v247
    v_fma_f32 v140, v124, s24, -v247
    v_fma_f32 v141, v125, s24, -v247
    v_exp_f32 v136, v136
    v_fma_f32 v142, v126, s24, -v247
    v_exp_f32 v137, v137
    v_fma_f32 v143, v127, s24, -v247
    v_exp_f32 v138, v138
    v_fma_f32 v144, v128, s24, -v247
    v_exp_f32 v139, v139
    v_fma_f32 v145, v129, s24, -v247
    v_add_f32 v0, v136, v137
    v_exp_f32 v140, v140
    v_fma_f32 v146, v130, s24, -v247
    v_exp_f32 v141, v141
    v_fma_f32 v147, v131, s24, -v247
    v_add_f32 v1, v138, v139
    v_exp_f32 v142, v142
    v_fma_f32 v148, v132, s24, -v247
    v_exp_f32 v143, v143
    v_fma_f32 v149, v133, s24, -v247
    v_add_f32 v2, v140, v141
    v_exp_f32 v144, v144
    v_fma_f32 v150, v134, s24, -v247
    v_exp_f32 v145, v145
    v_fma_f32 v151, v135, s24, -v247
    v_add_f32 v3, v142, v143
    v_exp_f32 v146, v146
    v_exp_f32 v147, v147
    v_add_f32 v4, v144, v145
    v_exp_f32 v148, v148
    v_exp_f32 v149, v149
    v_add_f32 v5, v146, v147
    v_exp_f32 v150, v150
    v_exp_f32 v151, v151
    v_add_f32 v6, v148, v149
    v_add_f32 v7, v150, v151
    v_add_f32 v0, v0, v1
    v_add_f32 v1, v2, v3
    v_add_f32 v2, v4, v5
    v_add_f32 v3, v6, v7
    v_add_f32 v0, v0, v1
    v_add_f32 v2, v2, v3
    v_add_f32 v249, v0, v2
    s_nop 1
    s_branch L_gqa_attn_kernel_res8
L_gqa_attn_kernel_slow9:
    v_max3_f32 v250, v104, v105, v106
    v_max3_f32 v251, v107, v108, v109
    v_max3_f32 v252, v110, v111, v112
    v_max3_f32 v253, v113, v114, v115
    v_max3_f32 v254, v116, v117, v118
    v_max3_f32 v250, v250, v251, v119
    v_max3_f32 v252, v252, v253, v254
    v_max_f32 v250, v250, v252
    v_mov_b32 v251, v250
    s_nop 1
    v_permlane32_swap_b32 v250, v251
    s_nop 1
    v_max3_f32 v246, v246, v250, v251
    v_mul_f32 v252, s24, v246
    v_sub_f32 v253, v247, v252
    v_exp_f32 v253, v253
    v_mov_b32 v247, v252
    s_nop 7
    s_nop 7
    v_mul_f32 v40, v40, v253
    v_mul_f32 v41, v41, v253
    v_mul_f32 v42, v42, v253
    v_mul_f32 v43, v43, v253
    v_mul_f32 v44, v44, v253
    v_mul_f32 v45, v45, v253
    v_mul_f32 v46, v46, v253
    v_mul_f32 v47, v47, v253
    v_mul_f32 v48, v48, v253
    v_mul_f32 v49, v49, v253
    v_mul_f32 v50, v50, v253
    v_mul_f32 v51, v51, v253
    v_mul_f32 v52, v52, v253
    v_mul_f32 v53, v53, v253
    v_mul_f32 v54, v54, v253
    v_mul_f32 v55, v55, v253
    v_mul_f32 v56, v56, v253
    v_mul_f32 v57, v57, v253
    v_mul_f32 v58, v58, v253
    v_mul_f32 v59, v59, v253
    v_mul_f32 v60, v60, v253
    v_mul_f32 v61, v61, v253
    v_mul_f32 v62, v62, v253
    v_mul_f32 v63, v63, v253
    v_mul_f32 v64, v64, v253
    v_mul_f32 v65, v65, v253
    v_mul_f32 v66, v66, v253
    v_mul_f32 v67, v67, v253
    v_mul_f32 v68, v68, v253
    v_mul_f32 v69, v69, v253
    v_mul_f32 v70, v70, v253
    v_mul_f32 v71, v71, v253
    v_mul_f32 v72, v72, v253
    v_mul_f32 v73, v73, v253
    v_mul_f32 v74, v74, v253
    v_mul_f32 v75, v75, v253
    v_mul_f32 v76, v76, v253
    v_mul_f32 v77, v77, v253
    v_mul_f32 v78, v78, v253
    v_mul_f32 v79, v79, v253
    v_mul_f32 v80, v80, v253
    v_mul_f32 v81, v81, v253
    v_mul_f32 v82, v82, v253
    v_mul_f32 v83, v83, v253
    v_mul_f32 v84, v84, v253
    v_mul_f32 v85, v85, v253
    v_mul_f32 v86, v86, v253
    v_mul_f32 v87, v87, v253
    v_mul_f32 v88, v88, v253
    v_mul_f32 v89, v89, v253
    v_mul_f32 v90, v90, v253
    v_mul_f32 v91, v91, v253
    v_mul_f32 v92, v92, v253
    v_mul_f32 v93, v93, v253
    v_mul_f32 v94, v94, v253
    v_mul_f32 v95, v95, v253
    v_mul_f32 v96, v96, v253
    v_mul_f32 v97, v97, v253
    v_mul_f32 v98, v98, v253
    v_mul_f32 v99, v99, v253
    v_mul_f32 v100, v100, v253
    v_mul_f32 v101, v101, v253
    v_mul_f32 v102, v102, v253
    v_mul_f32 v103, v103, v253
    v_mul_f32 v248, v248, v253
    v_fma_f32 v136, v104, s24, -v247
    v_fma_f32 v137, v105, s24, -v247
    v_fma_f32 v138, v106, s24, -v247
    v_fma_f32 v139, v107, s24, -v247
    v_fma_f32 v140, v108, s24, -v247
    v_fma_f32 v141, v109, s24, -v247
    v_exp_f32 v136, v136
    v_fma_f32 v142, v110, s24, -v247
    v_exp_f32 v137, v137
    v_fma_f32 v143, v111, s24, -v247
    v_exp_f32 v138, v138
    v_fma_f32 v144, v112, s24, -v247
    v_exp_f32 v139, v139
    v_fma_f32 v145, v113, s24, -v247
    v_add_f32 v0, v136, v137
    v_exp_f32 v140, v140
    v_fma_f32 v146, v114, s24, -v247
    v_exp_f32 v141, v141
    v_fma_f32 v147, v115, s24, -v247
    v_add_f32 v1, v138, v139
    v_exp_f32 v142, v142
    v_fma_f32 v148, v116, s24, -v247
    v_exp_f32 v143, v143
    v_fma_f32 v149, v117, s24, -v247
    v_add_f32 v2, v140, v141
    v_exp_f32 v144, v144
    v_fma_f32 v150, v118, s24, -v247
    v_exp_f32 v145, v145
    v_fma_f32 v151, v119, s24, -v247
    v_add_f32 v3, v142, v143
    v_exp_f32 v146, v146
    v_exp_f32 v147, v147
    v_add_f32 v4, v144, v145
    v_exp_f32 v148, v148
    v_exp_f32 v149, v149
    v_add_f32 v5, v146, v147
    v_exp_f32 v150, v150
    v_exp_f32 v151, v151
    v_add_f32 v6, v148, v149
    v_add_f32 v7, v150, v151
    v_add_f32 v0, v0, v1
    v_add_f32 v1, v2, v3
    v_add_f32 v2, v4, v5
    v_add_f32 v3, v6, v7
    v_add_f32 v0, v0, v1
    v_add_f32 v2, v2, v3
    v_add_f32 v249, v0, v2
    s_nop 1
    s_branch L_gqa_attn_kernel_res9
L_gqa_attn_kernel_slow10:
    v_max3_f32 v250, v120, v121, v122
    v_max3_f32 v251, v123, v124, v125
    v_max3_f32 v252, v126, v127, v128
    v_max3_f32 v253, v129, v130, v131
    v_max3_f32 v254, v132, v133, v134
    v_max3_f32 v250, v250, v251, v135
    v_max3_f32 v252, v252, v253, v254
    v_max_f32 v250, v250, v252
    v_mov_b32 v251, v250
    s_nop 1
    v_permlane32_swap_b32 v250, v251
    s_nop 1
    v_max3_f32 v246, v246, v250, v251
    v_mul_f32 v252, s24, v246
    v_sub_f32 v253, v247, v252
    v_exp_f32 v253, v253
    v_mov_b32 v247, v252
    s_nop 7
    s_nop 7
    v_mul_f32 v40, v40, v253
    v_mul_f32 v41, v41, v253
    v_mul_f32 v42, v42, v253
    v_mul_f32 v43, v43, v253
    v_mul_f32 v44, v44, v253
    v_mul_f32 v45, v45, v253
    v_mul_f32 v46, v46, v253
    v_mul_f32 v47, v47, v253
    v_mul_f32 v48, v48, v253
    v_mul_f32 v49, v49, v253
    v_mul_f32 v50, v50, v253
    v_mul_f32 v51, v51, v253
    v_mul_f32 v52, v52, v253
    v_mul_f32 v53, v53, v253
    v_mul_f32 v54, v54, v253
    v_mul_f32 v55, v55, v253
    v_mul_f32 v56, v56, v253
    v_mul_f32 v57, v57, v253
    v_mul_f32 v58, v58, v253
    v_mul_f32 v59, v59, v253
    v_mul_f32 v60, v60, v253
    v_mul_f32 v61, v61, v253
    v_mul_f32 v62, v62, v253
    v_mul_f32 v63, v63, v253
    v_mul_f32 v64, v64, v253
    v_mul_f32 v65, v65, v253
    v_mul_f32 v66, v66, v253
    v_mul_f32 v67, v67, v253
    v_mul_f32 v68, v68, v253
    v_mul_f32 v69, v69, v253
    v_mul_f32 v70, v70, v253
    v_mul_f32 v71, v71, v253
    v_mul_f32 v72, v72, v253
    v_mul_f32 v73, v73, v253
    v_mul_f32 v74, v74, v253
    v_mul_f32 v75, v75, v253
    v_mul_f32 v76, v76, v253
    v_mul_f32 v77, v77, v253
    v_mul_f32 v78, v78, v253
    v_mul_f32 v79, v79, v253
    v_mul_f32 v80, v80, v253
    v_mul_f32 v81, v81, v253
    v_mul_f32 v82, v82, v253
    v_mul_f32 v83, v83, v253
    v_mul_f32 v84, v84, v253
    v_mul_f32 v85, v85, v253
    v_mul_f32 v86, v86, v253
    v_mul_f32 v87, v87, v253
    v_mul_f32 v88, v88, v253
    v_mul_f32 v89, v89, v253
    v_mul_f32 v90, v90, v253
    v_mul_f32 v91, v91, v253
    v_mul_f32 v92, v92, v253
    v_mul_f32 v93, v93, v253
    v_mul_f32 v94, v94, v253
    v_mul_f32 v95, v95, v253
    v_mul_f32 v96, v96, v253
    v_mul_f32 v97, v97, v253
    v_mul_f32 v98, v98, v253
    v_mul_f32 v99, v99, v253
    v_mul_f32 v100, v100, v253
    v_mul_f32 v101, v101, v253
    v_mul_f32 v102, v102, v253
    v_mul_f32 v103, v103, v253
    v_mul_f32 v248, v248, v253
    v_fma_f32 v136, v120, s24, -v247
    v_fma_f32 v137, v121, s24, -v247
    v_fma_f32 v138, v122, s24, -v247
    v_fma_f32 v139, v123, s24, -v247
    v_fma_f32 v140, v124, s24, -v247
    v_fma_f32 v141, v125, s24, -v247
    v_exp_f32 v136, v136
    v_fma_f32 v142, v126, s24, -v247
    v_exp_f32 v137, v137
    v_fma_f32 v143, v127, s24, -v247
    v_exp_f32 v138, v138
    v_fma_f32 v144, v128, s24, -v247
    v_exp_f32 v139, v139
    v_fma_f32 v145, v129, s24, -v247
    v_add_f32 v0, v136, v137
    v_exp_f32 v140, v140
    v_fma_f32 v146, v130, s24, -v247
    v_exp_f32 v141, v141
    v_fma_f32 v147, v131, s24, -v247
    v_add_f32 v1, v138, v139
    v_exp_f32 v142, v142
    v_fma_f32 v148, v132, s24, -v247
    v_exp_f32 v143, v143
    v_fma_f32 v149, v133, s24, -v247
    v_add_f32 v2, v140, v141
    v_exp_f32 v144, v144
    v_fma_f32 v150, v134, s24, -v247
    v_exp_f32 v145, v145
    v_fma_f32 v151, v135, s24, -v247
    v_add_f32 v3, v142, v143
    v_exp_f32 v146, v146
    v_exp_f32 v147, v147
    v_add_f32 v4, v144, v145
    v_exp_f32 v148, v148
    v_exp_f32 v149, v149
    v_add_f32 v5, v146, v147
    v_exp_f32 v150, v150
    v_exp_f32 v151, v151
    v_add_f32 v6, v148, v149
    v_add_f32 v7, v150, v151
    v_add_f32 v0, v0, v1
    v_add_f32 v1, v2, v3
    v_add_f32 v2, v4, v5
    v_add_f32 v3, v6, v7
    v_add_f32 v0, v0, v1
    v_add_f32 v2, v2, v3
    v_add_f32 v249, v0, v2
    s_nop 1
    s_branch L_gqa_attn_kernel_res10
L_gqa_attn_kernel_slow11:
    v_max3_f32 v250, v104, v105, v106
    v_max3_f32 v251, v107, v108, v109
    v_max3_f32 v252, v110, v111, v112
    v_max3_f32 v253, v113, v114, v115
    v_max3_f32 v254, v116, v117, v118
    v_max3_f32 v250, v250, v251, v119
    v_max3_f32 v252, v252, v253, v254
    v_max_f32 v250, v250, v252
    v_mov_b32 v251, v250
    s_nop 1
    v_permlane32_swap_b32 v250, v251
    s_nop 1
    v_max3_f32 v246, v246, v250, v251
    v_mul_f32 v252, s24, v246
    v_sub_f32 v253, v247, v252
    v_exp_f32 v253, v253
    v_mov_b32 v247, v252
    s_nop 7
    s_nop 7
    v_mul_f32 v40, v40, v253
    v_mul_f32 v41, v41, v253
    v_mul_f32 v42, v42, v253
    v_mul_f32 v43, v43, v253
    v_mul_f32 v44, v44, v253
    v_mul_f32 v45, v45, v253
    v_mul_f32 v46, v46, v253
    v_mul_f32 v47, v47, v253
    v_mul_f32 v48, v48, v253
    v_mul_f32 v49, v49, v253
    v_mul_f32 v50, v50, v253
    v_mul_f32 v51, v51, v253
    v_mul_f32 v52, v52, v253
    v_mul_f32 v53, v53, v253
    v_mul_f32 v54, v54, v253
    v_mul_f32 v55, v55, v253
    v_mul_f32 v56, v56, v253
    v_mul_f32 v57, v57, v253
    v_mul_f32 v58, v58, v253
    v_mul_f32 v59, v59, v253
    v_mul_f32 v60, v60, v253
    v_mul_f32 v61, v61, v253
    v_mul_f32 v62, v62, v253
    v_mul_f32 v63, v63, v253
    v_mul_f32 v64, v64, v253
    v_mul_f32 v65, v65, v253
    v_mul_f32 v66, v66, v253
    v_mul_f32 v67, v67, v253
    v_mul_f32 v68, v68, v253
    v_mul_f32 v69, v69, v253
    v_mul_f32 v70, v70, v253
    v_mul_f32 v71, v71, v253
    v_mul_f32 v72, v72, v253
    v_mul_f32 v73, v73, v253
    v_mul_f32 v74, v74, v253
    v_mul_f32 v75, v75, v253
    v_mul_f32 v76, v76, v253
    v_mul_f32 v77, v77, v253
    v_mul_f32 v78, v78, v253
    v_mul_f32 v79, v79, v253
    v_mul_f32 v80, v80, v253
    v_mul_f32 v81, v81, v253
    v_mul_f32 v82, v82, v253
    v_mul_f32 v83, v83, v253
    v_mul_f32 v84, v84, v253
    v_mul_f32 v85, v85, v253
    v_mul_f32 v86, v86, v253
    v_mul_f32 v87, v87, v253
    v_mul_f32 v88, v88, v253
    v_mul_f32 v89, v89, v253
    v_mul_f32 v90, v90, v253
    v_mul_f32 v91, v91, v253
    v_mul_f32 v92, v92, v253
    v_mul_f32 v93, v93, v253
    v_mul_f32 v94, v94, v253
    v_mul_f32 v95, v95, v253
    v_mul_f32 v96, v96, v253
    v_mul_f32 v97, v97, v253
    v_mul_f32 v98, v98, v253
    v_mul_f32 v99, v99, v253
    v_mul_f32 v100, v100, v253
    v_mul_f32 v101, v101, v253
    v_mul_f32 v102, v102, v253
    v_mul_f32 v103, v103, v253
    v_mul_f32 v248, v248, v253
    v_fma_f32 v136, v104, s24, -v247
    v_fma_f32 v137, v105, s24, -v247
    v_fma_f32 v138, v106, s24, -v247
    v_fma_f32 v139, v107, s24, -v247
    v_fma_f32 v140, v108, s24, -v247
    v_fma_f32 v141, v109, s24, -v247
    v_exp_f32 v136, v136
    v_fma_f32 v142, v110, s24, -v247
    v_exp_f32 v137, v137
    v_fma_f32 v143, v111, s24, -v247
    v_exp_f32 v138, v138
    v_fma_f32 v144, v112, s24, -v247
    v_exp_f32 v139, v139
    v_fma_f32 v145, v113, s24, -v247
    v_add_f32 v0, v136, v137
    v_exp_f32 v140, v140
    v_fma_f32 v146, v114, s24, -v247
    v_exp_f32 v141, v141
    v_fma_f32 v147, v115, s24, -v247
    v_add_f32 v1, v138, v139
    v_exp_f32 v142, v142
    v_fma_f32 v148, v116, s24, -v247
    v_exp_f32 v143, v143
    v_fma_f32 v149, v117, s24, -v247
    v_add_f32 v2, v140, v141
    v_exp_f32 v144, v144
    v_fma_f32 v150, v118, s24, -v247
    v_exp_f32 v145, v145
    v_fma_f32 v151, v119, s24, -v247
    v_add_f32 v3, v142, v143
    v_exp_f32 v146, v146
    v_exp_f32 v147, v147
    v_add_f32 v4, v144, v145
    v_exp_f32 v148, v148
    v_exp_f32 v149, v149
    v_add_f32 v5, v146, v147
    v_exp_f32 v150, v150
    v_exp_f32 v151, v151
    v_add_f32 v6, v148, v149
    v_add_f32 v7, v150, v151
    v_add_f32 v0, v0, v1
    v_add_f32 v1, v2, v3
    v_add_f32 v2, v4, v5
    v_add_f32 v3, v6, v7
    v_add_f32 v0, v0, v1
    v_add_f32 v2, v2, v3
    v_add_f32 v249, v0, v2
    s_nop 1
    s_branch L_gqa_attn_kernel_res11
L_gqa_attn_kernel_slow12:
    v_max3_f32 v250, v120, v121, v122
    v_max3_f32 v251, v123, v124, v125
    v_max3_f32 v252, v126, v127, v128
    v_max3_f32 v253, v129, v130, v131
    v_max3_f32 v254, v132, v133, v134
    v_max3_f32 v250, v250, v251, v135
    v_max3_f32 v252, v252, v253, v254
    v_max_f32 v250, v250, v252
    v_mov_b32 v251, v250
    s_nop 1
    v_permlane32_swap_b32 v250, v251
    s_nop 1
    v_max3_f32 v246, v246, v250, v251
    v_mul_f32 v252, s24, v246
    v_sub_f32 v253, v247, v252
    v_exp_f32 v253, v253
    v_mov_b32 v247, v252
    s_nop 7
    s_nop 7
    v_mul_f32 v40, v40, v253
    v_mul_f32 v41, v41, v253
    v_mul_f32 v42, v42, v253
    v_mul_f32 v43, v43, v253
    v_mul_f32 v44, v44, v253
    v_mul_f32 v45, v45, v253
    v_mul_f32 v46, v46, v253
    v_mul_f32 v47, v47, v253
    v_mul_f32 v48, v48, v253
    v_mul_f32 v49, v49, v253
    v_mul_f32 v50, v50, v253
    v_mul_f32 v51, v51, v253
    v_mul_f32 v52, v52, v253
    v_mul_f32 v53, v53, v253
    v_mul_f32 v54, v54, v253
    v_mul_f32 v55, v55, v253
    v_mul_f32 v56, v56, v253
    v_mul_f32 v57, v57, v253
    v_mul_f32 v58, v58, v253
    v_mul_f32 v59, v59, v253
    v_mul_f32 v60, v60, v253
    v_mul_f32 v61, v61, v253
    v_mul_f32 v62, v62, v253
    v_mul_f32 v63, v63, v253
    v_mul_f32 v64, v64, v253
    v_mul_f32 v65, v65, v253
    v_mul_f32 v66, v66, v253
    v_mul_f32 v67, v67, v253
    v_mul_f32 v68, v68, v253
    v_mul_f32 v69, v69, v253
    v_mul_f32 v70, v70, v253
    v_mul_f32 v71, v71, v253
    v_mul_f32 v72, v72, v253
    v_mul_f32 v73, v73, v253
    v_mul_f32 v74, v74, v253
    v_mul_f32 v75, v75, v253
    v_mul_f32 v76, v76, v253
    v_mul_f32 v77, v77, v253
    v_mul_f32 v78, v78, v253
    v_mul_f32 v79, v79, v253
    v_mul_f32 v80, v80, v253
    v_mul_f32 v81, v81, v253
    v_mul_f32 v82, v82, v253
    v_mul_f32 v83, v83, v253
    v_mul_f32 v84, v84, v253
    v_mul_f32 v85, v85, v253
    v_mul_f32 v86, v86, v253
    v_mul_f32 v87, v87, v253
    v_mul_f32 v88, v88, v253
    v_mul_f32 v89, v89, v253
    v_mul_f32 v90, v90, v253
    v_mul_f32 v91, v91, v253
    v_mul_f32 v92, v92, v253
    v_mul_f32 v93, v93, v253
    v_mul_f32 v94, v94, v253
    v_mul_f32 v95, v95, v253
    v_mul_f32 v96, v96, v253
    v_mul_f32 v97, v97, v253
    v_mul_f32 v98, v98, v253
    v_mul_f32 v99, v99, v253
    v_mul_f32 v100, v100, v253
    v_mul_f32 v101, v101, v253
    v_mul_f32 v102, v102, v253
    v_mul_f32 v103, v103, v253
    v_mul_f32 v248, v248, v253
    v_fma_f32 v136, v120, s24, -v247
    v_fma_f32 v137, v121, s24, -v247
    v_fma_f32 v138, v122, s24, -v247
    v_fma_f32 v139, v123, s24, -v247
    v_fma_f32 v140, v124, s24, -v247
    v_fma_f32 v141, v125, s24, -v247
    v_exp_f32 v136, v136
    v_fma_f32 v142, v126, s24, -v247
    v_exp_f32 v137, v137
    v_fma_f32 v143, v127, s24, -v247
    v_exp_f32 v138, v138
    v_fma_f32 v144, v128, s24, -v247
    v_exp_f32 v139, v139
    v_fma_f32 v145, v129, s24, -v247
    v_add_f32 v0, v136, v137
    v_exp_f32 v140, v140
    v_fma_f32 v146, v130, s24, -v247
    v_exp_f32 v141, v141
    v_fma_f32 v147, v131, s24, -v247
    v_add_f32 v1, v138, v139
    v_exp_f32 v142, v142
    v_fma_f32 v148, v132, s24, -v247
    v_exp_f32 v143, v143
    v_fma_f32 v149, v133, s24, -v247
    v_add_f32 v2, v140, v141
    v_exp_f32 v144, v144
    v_fma_f32 v150, v134, s24, -v247
    v_exp_f32 v145, v145
    v_fma_f32 v151, v135, s24, -v247
    v_add_f32 v3, v142, v143
    v_exp_f32 v146, v146
    v_exp_f32 v147, v147
    v_add_f32 v4, v144, v145
    v_exp_f32 v148, v148
    v_exp_f32 v149, v149
    v_add_f32 v5, v146, v147
    v_exp_f32 v150, v150
    v_exp_f32 v151, v151
    v_add_f32 v6, v148, v149
    v_add_f32 v7, v150, v151
    v_add_f32 v0, v0, v1
    v_add_f32 v1, v2, v3
    v_add_f32 v2, v4, v5
    v_add_f32 v3, v6, v7
    v_add_f32 v0, v0, v1
    v_add_f32 v2, v2, v3
    v_add_f32 v249, v0, v2
    s_nop 1
    s_branch L_gqa_attn_kernel_res12
L_gqa_attn_kernel_slow13:
    v_max3_f32 v250, v104, v105, v106
    v_max3_f32 v251, v107, v108, v109
    v_max3_f32 v252, v110, v111, v112
    v_max3_f32 v253, v113, v114, v115
    v_max3_f32 v254, v116, v117, v118
    v_max3_f32 v250, v250, v251, v119
    v_max3_f32 v252, v252, v253, v254
    v_max_f32 v250, v250, v252
    v_mov_b32 v251, v250
    s_nop 1
    v_permlane32_swap_b32 v250, v251
    s_nop 1
    v_max3_f32 v246, v246, v250, v251
    v_mul_f32 v252, s24, v246
    v_sub_f32 v253, v247, v252
    v_exp_f32 v253, v253
    v_mov_b32 v247, v252
    s_nop 7
    s_nop 7
    v_mul_f32 v40, v40, v253
    v_mul_f32 v41, v41, v253
    v_mul_f32 v42, v42, v253
    v_mul_f32 v43, v43, v253
    v_mul_f32 v44, v44, v253
    v_mul_f32 v45, v45, v253
    v_mul_f32 v46, v46, v253
    v_mul_f32 v47, v47, v253
    v_mul_f32 v48, v48, v253
    v_mul_f32 v49, v49, v253
    v_mul_f32 v50, v50, v253
    v_mul_f32 v51, v51, v253
    v_mul_f32 v52, v52, v253
    v_mul_f32 v53, v53, v253
    v_mul_f32 v54, v54, v253
    v_mul_f32 v55, v55, v253
    v_mul_f32 v56, v56, v253
    v_mul_f32 v57, v57, v253
    v_mul_f32 v58, v58, v253
    v_mul_f32 v59, v59, v253
    v_mul_f32 v60, v60, v253
    v_mul_f32 v61, v61, v253
    v_mul_f32 v62, v62, v253
    v_mul_f32 v63, v63, v253
    v_mul_f32 v64, v64, v253
    v_mul_f32 v65, v65, v253
    v_mul_f32 v66, v66, v253
    v_mul_f32 v67, v67, v253
    v_mul_f32 v68, v68, v253
    v_mul_f32 v69, v69, v253
    v_mul_f32 v70, v70, v253
    v_mul_f32 v71, v71, v253
    v_mul_f32 v72, v72, v253
    v_mul_f32 v73, v73, v253
    v_mul_f32 v74, v74, v253
    v_mul_f32 v75, v75, v253
    v_mul_f32 v76, v76, v253
    v_mul_f32 v77, v77, v253
    v_mul_f32 v78, v78, v253
    v_mul_f32 v79, v79, v253
    v_mul_f32 v80, v80, v253
    v_mul_f32 v81, v81, v253
    v_mul_f32 v82, v82, v253
    v_mul_f32 v83, v83, v253
    v_mul_f32 v84, v84, v253
    v_mul_f32 v85, v85, v253
    v_mul_f32 v86, v86, v253
    v_mul_f32 v87, v87, v253
    v_mul_f32 v88, v88, v253
    v_mul_f32 v89, v89, v253
    v_mul_f32 v90, v90, v253
    v_mul_f32 v91, v91, v253
    v_mul_f32 v92, v92, v253
    v_mul_f32 v93, v93, v253
    v_mul_f32 v94, v94, v253
    v_mul_f32 v95, v95, v253
    v_mul_f32 v96, v96, v253
    v_mul_f32 v97, v97, v253
    v_mul_f32 v98, v98, v253
    v_mul_f32 v99, v99, v253
    v_mul_f32 v100, v100, v253
    v_mul_f32 v101, v101, v253
    v_mul_f32 v102, v102, v253
    v_mul_f32 v103, v103, v253
    v_mul_f32 v248, v248, v253
    v_fma_f32 v136, v104, s24, -v247
    v_fma_f32 v137, v105, s24, -v247
    v_fma_f32 v138, v106, s24, -v247
    v_fma_f32 v139, v107, s24, -v247
    v_fma_f32 v140, v108, s24, -v247
    v_fma_f32 v141, v109, s24, -v247
    v_exp_f32 v136, v136
    v_fma_f32 v142, v110, s24, -v247
    v_exp_f32 v137, v137
    v_fma_f32 v143, v111, s24, -v247
    v_exp_f32 v138, v138
    v_fma_f32 v144, v112, s24, -v247
    v_exp_f32 v139, v139
    v_fma_f32 v145, v113, s24, -v247
    v_add_f32 v0, v136, v137
    v_exp_f32 v140, v140
    v_fma_f32 v146, v114, s24, -v247
    v_exp_f32 v141, v141
    v_fma_f32 v147, v115, s24, -v247
    v_add_f32 v1, v138, v139
    v_exp_f32 v142, v142
    v_fma_f32 v148, v116, s24, -v247
    v_exp_f32 v143, v143
    v_fma_f32 v149, v117, s24, -v247
    v_add_f32 v2, v140, v141
    v_exp_f32 v144, v144
    v_fma_f32 v150, v118, s24, -v247
    v_exp_f32 v145, v145
    v_fma_f32 v151, v119, s24, -v247
    v_add_f32 v3, v142, v143
    v_exp_f32 v146, v146
    v_exp_f32 v147, v147
    v_add_f32 v4, v144, v145
    v_exp_f32 v148, v148
    v_exp_f32 v149, v149
    v_add_f32 v5, v146, v147
    v_exp_f32 v150, v150
    v_exp_f32 v151, v151
    v_add_f32 v6, v148, v149
    v_add_f32 v7, v150, v151
    v_add_f32 v0, v0, v1
    v_add_f32 v1, v2, v3
    v_add_f32 v2, v4, v5
    v_add_f32 v3, v6, v7
    v_add_f32 v0, v0, v1
    v_add_f32 v2, v2, v3
    v_add_f32 v249, v0, v2
    s_nop 1
    s_branch L_gqa_attn_kernel_res13
L_gqa_attn_kernel_slow14:
    v_max3_f32 v250, v120, v121, v122
    v_max3_f32 v251, v123, v124, v125
    v_max3_f32 v252, v126, v127, v128
    v_max3_f32 v253, v129, v130, v131
    v_max3_f32 v254, v132, v133, v134
    v_max3_f32 v250, v250, v251, v135
    v_max3_f32 v252, v252, v253, v254
    v_max_f32 v250, v250, v252
    v_mov_b32 v251, v250
    s_nop 1
    v_permlane32_swap_b32 v250, v251
    s_nop 1
    v_max3_f32 v246, v246, v250, v251
    v_mul_f32 v252, s24, v246
    v_sub_f32 v253, v247, v252
    v_exp_f32 v253, v253
    v_mov_b32 v247, v252
    s_nop 7
    s_nop 7
    v_mul_f32 v40, v40, v253
    v_mul_f32 v41, v41, v253
    v_mul_f32 v42, v42, v253
    v_mul_f32 v43, v43, v253
    v_mul_f32 v44, v44, v253
    v_mul_f32 v45, v45, v253
    v_mul_f32 v46, v46, v253
    v_mul_f32 v47, v47, v253
    v_mul_f32 v48, v48, v253
    v_mul_f32 v49, v49, v253
    v_mul_f32 v50, v50, v253
    v_mul_f32 v51, v51, v253
    v_mul_f32 v52, v52, v253
    v_mul_f32 v53, v53, v253
    v_mul_f32 v54, v54, v253
    v_mul_f32 v55, v55, v253
    v_mul_f32 v56, v56, v253
    v_mul_f32 v57, v57, v253
    v_mul_f32 v58, v58, v253
    v_mul_f32 v59, v59, v253
    v_mul_f32 v60, v60, v253
    v_mul_f32 v61, v61, v253
    v_mul_f32 v62, v62, v253
    v_mul_f32 v63, v63, v253
    v_mul_f32 v64, v64, v253
    v_mul_f32 v65, v65, v253
    v_mul_f32 v66, v66, v253
    v_mul_f32 v67, v67, v253
    v_mul_f32 v68, v68, v253
    v_mul_f32 v69, v69, v253
    v_mul_f32 v70, v70, v253
    v_mul_f32 v71, v71, v253
    v_mul_f32 v72, v72, v253
    v_mul_f32 v73, v73, v253
    v_mul_f32 v74, v74, v253
    v_mul_f32 v75, v75, v253
    v_mul_f32 v76, v76, v253
    v_mul_f32 v77, v77, v253
    v_mul_f32 v78, v78, v253
    v_mul_f32 v79, v79, v253
    v_mul_f32 v80, v80, v253
    v_mul_f32 v81, v81, v253
    v_mul_f32 v82, v82, v253
    v_mul_f32 v83, v83, v253
    v_mul_f32 v84, v84, v253
    v_mul_f32 v85, v85, v253
    v_mul_f32 v86, v86, v253
    v_mul_f32 v87, v87, v253
    v_mul_f32 v88, v88, v253
    v_mul_f32 v89, v89, v253
    v_mul_f32 v90, v90, v253
    v_mul_f32 v91, v91, v253
    v_mul_f32 v92, v92, v253
    v_mul_f32 v93, v93, v253
    v_mul_f32 v94, v94, v253
    v_mul_f32 v95, v95, v253
    v_mul_f32 v96, v96, v253
    v_mul_f32 v97, v97, v253
    v_mul_f32 v98, v98, v253
    v_mul_f32 v99, v99, v253
    v_mul_f32 v100, v100, v253
    v_mul_f32 v101, v101, v253
    v_mul_f32 v102, v102, v253
    v_mul_f32 v103, v103, v253
    v_mul_f32 v248, v248, v253
    v_fma_f32 v136, v120, s24, -v247
    v_fma_f32 v137, v121, s24, -v247
    v_fma_f32 v138, v122, s24, -v247
    v_fma_f32 v139, v123, s24, -v247
    v_fma_f32 v140, v124, s24, -v247
    v_fma_f32 v141, v125, s24, -v247
    v_exp_f32 v136, v136
    v_fma_f32 v142, v126, s24, -v247
    v_exp_f32 v137, v137
    v_fma_f32 v143, v127, s24, -v247
    v_exp_f32 v138, v138
    v_fma_f32 v144, v128, s24, -v247
    v_exp_f32 v139, v139
    v_fma_f32 v145, v129, s24, -v247
    v_add_f32 v0, v136, v137
    v_exp_f32 v140, v140
    v_fma_f32 v146, v130, s24, -v247
    v_exp_f32 v141, v141
    v_fma_f32 v147, v131, s24, -v247
    v_add_f32 v1, v138, v139
    v_exp_f32 v142, v142
    v_fma_f32 v148, v132, s24, -v247
    v_exp_f32 v143, v143
    v_fma_f32 v149, v133, s24, -v247
    v_add_f32 v2, v140, v141
    v_exp_f32 v144, v144
    v_fma_f32 v150, v134, s24, -v247
    v_exp_f32 v145, v145
    v_fma_f32 v151, v135, s24, -v247
    v_add_f32 v3, v142, v143
    v_exp_f32 v146, v146
    v_exp_f32 v147, v147
    v_add_f32 v4, v144, v145
    v_exp_f32 v148, v148
    v_exp_f32 v149, v149
    v_add_f32 v5, v146, v147
    v_exp_f32 v150, v150
    v_exp_f32 v151, v151
    v_add_f32 v6, v148, v149
    v_add_f32 v7, v150, v151
    v_add_f32 v0, v0, v1
    v_add_f32 v1, v2, v3
    v_add_f32 v2, v4, v5
    v_add_f32 v3, v6, v7
    v_add_f32 v0, v0, v1
    v_add_f32 v2, v2, v3
    v_add_f32 v249, v0, v2
    s_nop 1
    s_branch L_gqa_attn_kernel_res14
L_gqa_attn_kernel_slow15:
    v_max3_f32 v250, v104, v105, v106
    v_max3_f32 v251, v107, v108, v109
    v_max3_f32 v252, v110, v111, v112
    v_max3_f32 v253, v113, v114, v115
    v_max3_f32 v254, v116, v117, v118
    v_max3_f32 v250, v250, v251, v119
    v_max3_f32 v252, v252, v253, v254
    v_max_f32 v250, v250, v252
    v_mov_b32 v251, v250
    s_nop 1
    v_permlane32_swap_b32 v250, v251
    s_nop 1
    v_max3_f32 v246, v246, v250, v251
    v_mul_f32 v252, s24, v246
    v_sub_f32 v253, v247, v252
    v_exp_f32 v253, v253
    v_mov_b32 v247, v252
    s_nop 7
    s_nop 7
    v_mul_f32 v40, v40, v253
    v_mul_f32 v41, v41, v253
    v_mul_f32 v42, v42, v253
    v_mul_f32 v43, v43, v253
    v_mul_f32 v44, v44, v253
    v_mul_f32 v45, v45, v253
    v_mul_f32 v46, v46, v253
    v_mul_f32 v47, v47, v253
    v_mul_f32 v48, v48, v253
    v_mul_f32 v49, v49, v253
    v_mul_f32 v50, v50, v253
    v_mul_f32 v51, v51, v253
    v_mul_f32 v52, v52, v253
    v_mul_f32 v53, v53, v253
    v_mul_f32 v54, v54, v253
    v_mul_f32 v55, v55, v253
    v_mul_f32 v56, v56, v253
    v_mul_f32 v57, v57, v253
    v_mul_f32 v58, v58, v253
    v_mul_f32 v59, v59, v253
    v_mul_f32 v60, v60, v253
    v_mul_f32 v61, v61, v253
    v_mul_f32 v62, v62, v253
    v_mul_f32 v63, v63, v253
    v_mul_f32 v64, v64, v253
    v_mul_f32 v65, v65, v253
    v_mul_f32 v66, v66, v253
    v_mul_f32 v67, v67, v253
    v_mul_f32 v68, v68, v253
    v_mul_f32 v69, v69, v253
    v_mul_f32 v70, v70, v253
    v_mul_f32 v71, v71, v253
    v_mul_f32 v72, v72, v253
    v_mul_f32 v73, v73, v253
    v_mul_f32 v74, v74, v253
    v_mul_f32 v75, v75, v253
    v_mul_f32 v76, v76, v253
    v_mul_f32 v77, v77, v253
    v_mul_f32 v78, v78, v253
    v_mul_f32 v79, v79, v253
    v_mul_f32 v80, v80, v253
    v_mul_f32 v81, v81, v253
    v_mul_f32 v82, v82, v253
    v_mul_f32 v83, v83, v253
    v_mul_f32 v84, v84, v253
    v_mul_f32 v85, v85, v253
    v_mul_f32 v86, v86, v253
    v_mul_f32 v87, v87, v253
    v_mul_f32 v88, v88, v253
    v_mul_f32 v89, v89, v253
    v_mul_f32 v90, v90, v253
    v_mul_f32 v91, v91, v253
    v_mul_f32 v92, v92, v253
    v_mul_f32 v93, v93, v253
    v_mul_f32 v94, v94, v253
    v_mul_f32 v95, v95, v253
    v_mul_f32 v96, v96, v253
    v_mul_f32 v97, v97, v253
    v_mul_f32 v98, v98, v253
    v_mul_f32 v99, v99, v253
    v_mul_f32 v100, v100, v253
    v_mul_f32 v101, v101, v253
    v_mul_f32 v102, v102, v253
    v_mul_f32 v103, v103, v253
    v_mul_f32 v248, v248, v253
    v_fma_f32 v136, v104, s24, -v247
    v_fma_f32 v137, v105, s24, -v247
    v_fma_f32 v138, v106, s24, -v247
    v_fma_f32 v139, v107, s24, -v247
    v_fma_f32 v140, v108, s24, -v247
    v_fma_f32 v141, v109, s24, -v247
    v_exp_f32 v136, v136
    v_fma_f32 v142, v110, s24, -v247
    v_exp_f32 v137, v137
    v_fma_f32 v143, v111, s24, -v247
    v_exp_f32 v138, v138
    v_fma_f32 v144, v112, s24, -v247
    v_exp_f32 v139, v139
    v_fma_f32 v145, v113, s24, -v247
    v_add_f32 v0, v136, v137
    v_exp_f32 v140, v140
    v_fma_f32 v146, v114, s24, -v247
    v_exp_f32 v141, v141
    v_fma_f32 v147, v115, s24, -v247
    v_add_f32 v1, v138, v139
    v_exp_f32 v142, v142
    v_fma_f32 v148, v116, s24, -v247
    v_exp_f32 v143, v143
    v_fma_f32 v149, v117, s24, -v247
    v_add_f32 v2, v140, v141
    v_exp_f32 v144, v144
    v_fma_f32 v150, v118, s24, -v247
    v_exp_f32 v145, v145
    v_fma_f32 v151, v119, s24, -v247
    v_add_f32 v3, v142, v143
    v_exp_f32 v146, v146
    v_exp_f32 v147, v147
    v_add_f32 v4, v144, v145
    v_exp_f32 v148, v148
    v_exp_f32 v149, v149
    v_add_f32 v5, v146, v147
    v_exp_f32 v150, v150
    v_exp_f32 v151, v151
    v_add_f32 v6, v148, v149
    v_add_f32 v7, v150, v151
    v_add_f32 v0, v0, v1
    v_add_f32 v1, v2, v3
    v_add_f32 v2, v4, v5
    v_add_f32 v3, v6, v7
    v_add_f32 v0, v0, v1
    v_add_f32 v2, v2, v3
    v_add_f32 v249, v0, v2
    s_nop 1
    s_branch L_gqa_attn_kernel_res15
L_gqa_attn_kernel_slow16:
    v_max3_f32 v250, v120, v121, v122
    v_max3_f32 v251, v123, v124, v125
    v_max3_f32 v252, v126, v127, v128
    v_max3_f32 v253, v129, v130, v131
    v_max3_f32 v254, v132, v133, v134
    v_max3_f32 v250, v250, v251, v135
    v_max3_f32 v252, v252, v253, v254
    v_max_f32 v250, v250, v252
    v_mov_b32 v251, v250
    s_nop 1
    v_permlane32_swap_b32 v250, v251
    s_nop 1
    v_max3_f32 v246, v246, v250, v251
    v_mul_f32 v252, s24, v246
    v_sub_f32 v253, v247, v252
    v_exp_f32 v253, v253
    v_mov_b32 v247, v252
    s_nop 7
    s_nop 7
    v_mul_f32 v40, v40, v253
    v_mul_f32 v41, v41, v253
    v_mul_f32 v42, v42, v253
    v_mul_f32 v43, v43, v253
    v_mul_f32 v44, v44, v253
    v_mul_f32 v45, v45, v253
    v_mul_f32 v46, v46, v253
    v_mul_f32 v47, v47, v253
    v_mul_f32 v48, v48, v253
    v_mul_f32 v49, v49, v253
    v_mul_f32 v50, v50, v253
    v_mul_f32 v51, v51, v253
    v_mul_f32 v52, v52, v253
    v_mul_f32 v53, v53, v253
    v_mul_f32 v54, v54, v253
    v_mul_f32 v55, v55, v253
    v_mul_f32 v56, v56, v253
    v_mul_f32 v57, v57, v253
    v_mul_f32 v58, v58, v253
    v_mul_f32 v59, v59, v253
    v_mul_f32 v60, v60, v253
    v_mul_f32 v61, v61, v253
    v_mul_f32 v62, v62, v253
    v_mul_f32 v63, v63, v253
    v_mul_f32 v64, v64, v253
    v_mul_f32 v65, v65, v253
    v_mul_f32 v66, v66, v253
    v_mul_f32 v67, v67, v253
    v_mul_f32 v68, v68, v253
    v_mul_f32 v69, v69, v253
    v_mul_f32 v70, v70, v253
    v_mul_f32 v71, v71, v253
    v_mul_f32 v72, v72, v253
    v_mul_f32 v73, v73, v253
    v_mul_f32 v74, v74, v253
    v_mul_f32 v75, v75, v253
    v_mul_f32 v76, v76, v253
    v_mul_f32 v77, v77, v253
    v_mul_f32 v78, v78, v253
    v_mul_f32 v79, v79, v253
    v_mul_f32 v80, v80, v253
    v_mul_f32 v81, v81, v253
    v_mul_f32 v82, v82, v253
    v_mul_f32 v83, v83, v253
    v_mul_f32 v84, v84, v253
    v_mul_f32 v85, v85, v253
    v_mul_f32 v86, v86, v253
    v_mul_f32 v87, v87, v253
    v_mul_f32 v88, v88, v253
    v_mul_f32 v89, v89, v253
    v_mul_f32 v90, v90, v253
    v_mul_f32 v91, v91, v253
    v_mul_f32 v92, v92, v253
    v_mul_f32 v93, v93, v253
    v_mul_f32 v94, v94, v253
    v_mul_f32 v95, v95, v253
    v_mul_f32 v96, v96, v253
    v_mul_f32 v97, v97, v253
    v_mul_f32 v98, v98, v253
    v_mul_f32 v99, v99, v253
    v_mul_f32 v100, v100, v253
    v_mul_f32 v101, v101, v253
    v_mul_f32 v102, v102, v253
    v_mul_f32 v103, v103, v253
    v_mul_f32 v248, v248, v253
    v_fma_f32 v136, v120, s24, -v247
    v_fma_f32 v137, v121, s24, -v247
    v_fma_f32 v138, v122, s24, -v247
    v_fma_f32 v139, v123, s24, -v247
    v_fma_f32 v140, v124, s24, -v247
    v_fma_f32 v141, v125, s24, -v247
    v_exp_f32 v136, v136
    v_fma_f32 v142, v126, s24, -v247
    v_exp_f32 v137, v137
    v_fma_f32 v143, v127, s24, -v247
    v_exp_f32 v138, v138
    v_fma_f32 v144, v128, s24, -v247
    v_exp_f32 v139, v139
    v_fma_f32 v145, v129, s24, -v247
    v_add_f32 v0, v136, v137
    v_exp_f32 v140, v140
    v_fma_f32 v146, v130, s24, -v247
    v_exp_f32 v141, v141
    v_fma_f32 v147, v131, s24, -v247
    v_add_f32 v1, v138, v139
    v_exp_f32 v142, v142
    v_fma_f32 v148, v132, s24, -v247
    v_exp_f32 v143, v143
    v_fma_f32 v149, v133, s24, -v247
    v_add_f32 v2, v140, v141
    v_exp_f32 v144, v144
    v_fma_f32 v150, v134, s24, -v247
    v_exp_f32 v145, v145
    v_fma_f32 v151, v135, s24, -v247
    v_add_f32 v3, v142, v143
    v_exp_f32 v146, v146
    v_exp_f32 v147, v147
    v_add_f32 v4, v144, v145
    v_exp_f32 v148, v148
    v_exp_f32 v149, v149
    v_add_f32 v5, v146, v147
    v_exp_f32 v150, v150
    v_exp_f32 v151, v151
    v_add_f32 v6, v148, v149
    v_add_f32 v7, v150, v151
    v_add_f32 v0, v0, v1
    v_add_f32 v1, v2, v3
    v_add_f32 v2, v4, v5
    v_add_f32 v3, v6, v7
    v_add_f32 v0, v0, v1
    v_add_f32 v2, v2, v3
    v_add_f32 v249, v0, v2
    s_nop 1
    s_branch L_gqa_attn_kernel_res16
L_gqa_attn_kernel_slow17:
    v_max3_f32 v250, v104, v105, v106
    v_max3_f32 v251, v107, v108, v109
    v_max3_f32 v252, v110, v111, v112
    v_max3_f32 v253, v113, v114, v115
    v_max3_f32 v254, v116, v117, v118
    v_max3_f32 v250, v250, v251, v119
    v_max3_f32 v252, v252, v253, v254
    v_max_f32 v250, v250, v252
    v_mov_b32 v251, v250
    s_nop 1
    v_permlane32_swap_b32 v250, v251
    s_nop 1
    v_max3_f32 v246, v246, v250, v251
    v_mul_f32 v252, s24, v246
    v_sub_f32 v253, v247, v252
    v_exp_f32 v253, v253
    v_mov_b32 v247, v252
    s_nop 7
    s_nop 7
    v_mul_f32 v40, v40, v253
    v_mul_f32 v41, v41, v253
    v_mul_f32 v42, v42, v253
    v_mul_f32 v43, v43, v253
    v_mul_f32 v44, v44, v253
    v_mul_f32 v45, v45, v253
    v_mul_f32 v46, v46, v253
    v_mul_f32 v47, v47, v253
    v_mul_f32 v48, v48, v253
    v_mul_f32 v49, v49, v253
    v_mul_f32 v50, v50, v253
    v_mul_f32 v51, v51, v253
    v_mul_f32 v52, v52, v253
    v_mul_f32 v53, v53, v253
    v_mul_f32 v54, v54, v253
    v_mul_f32 v55, v55, v253
    v_mul_f32 v56, v56, v253
    v_mul_f32 v57, v57, v253
    v_mul_f32 v58, v58, v253
    v_mul_f32 v59, v59, v253
    v_mul_f32 v60, v60, v253
    v_mul_f32 v61, v61, v253
    v_mul_f32 v62, v62, v253
    v_mul_f32 v63, v63, v253
    v_mul_f32 v64, v64, v253
    v_mul_f32 v65, v65, v253
    v_mul_f32 v66, v66, v253
    v_mul_f32 v67, v67, v253
    v_mul_f32 v68, v68, v253
    v_mul_f32 v69, v69, v253
    v_mul_f32 v70, v70, v253
    v_mul_f32 v71, v71, v253
    v_mul_f32 v72, v72, v253
    v_mul_f32 v73, v73, v253
    v_mul_f32 v74, v74, v253
    v_mul_f32 v75, v75, v253
    v_mul_f32 v76, v76, v253
    v_mul_f32 v77, v77, v253
    v_mul_f32 v78, v78, v253
    v_mul_f32 v79, v79, v253
    v_mul_f32 v80, v80, v253
    v_mul_f32 v81, v81, v253
    v_mul_f32 v82, v82, v253
    v_mul_f32 v83, v83, v253
    v_mul_f32 v84, v84, v253
    v_mul_f32 v85, v85, v253
    v_mul_f32 v86, v86, v253
    v_mul_f32 v87, v87, v253
    v_mul_f32 v88, v88, v253
    v_mul_f32 v89, v89, v253
    v_mul_f32 v90, v90, v253
    v_mul_f32 v91, v91, v253
    v_mul_f32 v92, v92, v253
    v_mul_f32 v93, v93, v253
    v_mul_f32 v94, v94, v253
    v_mul_f32 v95, v95, v253
    v_mul_f32 v96, v96, v253
    v_mul_f32 v97, v97, v253
    v_mul_f32 v98, v98, v253
    v_mul_f32 v99, v99, v253
    v_mul_f32 v100, v100, v253
    v_mul_f32 v101, v101, v253
    v_mul_f32 v102, v102, v253
    v_mul_f32 v103, v103, v253
    v_mul_f32 v248, v248, v253
    v_fma_f32 v136, v104, s24, -v247
    v_fma_f32 v137, v105, s24, -v247
    v_fma_f32 v138, v106, s24, -v247
    v_fma_f32 v139, v107, s24, -v247
    v_fma_f32 v140, v108, s24, -v247
    v_fma_f32 v141, v109, s24, -v247
    v_exp_f32 v136, v136
    v_fma_f32 v142, v110, s24, -v247
    v_exp_f32 v137, v137
    v_fma_f32 v143, v111, s24, -v247
    v_exp_f32 v138, v138
    v_fma_f32 v144, v112, s24, -v247
    v_exp_f32 v139, v139
    v_fma_f32 v145, v113, s24, -v247
    v_add_f32 v0, v136, v137
    v_exp_f32 v140, v140
    v_fma_f32 v146, v114, s24, -v247
    v_exp_f32 v141, v141
    v_fma_f32 v147, v115, s24, -v247
    v_add_f32 v1, v138, v139
    v_exp_f32 v142, v142
    v_fma_f32 v148, v116, s24, -v247
    v_exp_f32 v143, v143
    v_fma_f32 v149, v117, s24, -v247
    v_add_f32 v2, v140, v141
    v_exp_f32 v144, v144
    v_fma_f32 v150, v118, s24, -v247
    v_exp_f32 v145, v145
    v_fma_f32 v151, v119, s24, -v247
    v_add_f32 v3, v142, v143
    v_exp_f32 v146, v146
    v_exp_f32 v147, v147
    v_add_f32 v4, v144, v145
    v_exp_f32 v148, v148
    v_exp_f32 v149, v149
    v_add_f32 v5, v146, v147
    v_exp_f32 v150, v150
    v_exp_f32 v151, v151
    v_add_f32 v6, v148, v149
    v_add_f32 v7, v150, v151
    v_add_f32 v0, v0, v1
    v_add_f32 v1, v2, v3
    v_add_f32 v2, v4, v5
    v_add_f32 v3, v6, v7
    v_add_f32 v0, v0, v1
    v_add_f32 v2, v2, v3
    v_add_f32 v249, v0, v2
    s_nop 1
    s_branch L_gqa_attn_kernel_res17
L_gqa_attn_kernel_slow18:
    v_max3_f32 v250, v120, v121, v122
    v_max3_f32 v251, v123, v124, v125
    v_max3_f32 v252, v126, v127, v128
    v_max3_f32 v253, v129, v130, v131
    v_max3_f32 v254, v132, v133, v134
    v_max3_f32 v250, v250, v251, v135
    v_max3_f32 v252, v252, v253, v254
    v_max_f32 v250, v250, v252
    v_mov_b32 v251, v250
    s_nop 1
    v_permlane32_swap_b32 v250, v251
    s_nop 1
    v_max3_f32 v246, v246, v250, v251
    v_mul_f32 v252, s24, v246
    v_sub_f32 v253, v247, v252
    v_exp_f32 v253, v253
    v_mov_b32 v247, v252
    s_nop 7
    s_nop 7
    v_mul_f32 v40, v40, v253
    v_mul_f32 v41, v41, v253
    v_mul_f32 v42, v42, v253
    v_mul_f32 v43, v43, v253
    v_mul_f32 v44, v44, v253
    v_mul_f32 v45, v45, v253
    v_mul_f32 v46, v46, v253
    v_mul_f32 v47, v47, v253
    v_mul_f32 v48, v48, v253
    v_mul_f32 v49, v49, v253
    v_mul_f32 v50, v50, v253
    v_mul_f32 v51, v51, v253
    v_mul_f32 v52, v52, v253
    v_mul_f32 v53, v53, v253
    v_mul_f32 v54, v54, v253
    v_mul_f32 v55, v55, v253
    v_mul_f32 v56, v56, v253
    v_mul_f32 v57, v57, v253
    v_mul_f32 v58, v58, v253
    v_mul_f32 v59, v59, v253
    v_mul_f32 v60, v60, v253
    v_mul_f32 v61, v61, v253
    v_mul_f32 v62, v62, v253
    v_mul_f32 v63, v63, v253
    v_mul_f32 v64, v64, v253
    v_mul_f32 v65, v65, v253
    v_mul_f32 v66, v66, v253
    v_mul_f32 v67, v67, v253
    v_mul_f32 v68, v68, v253
    v_mul_f32 v69, v69, v253
    v_mul_f32 v70, v70, v253
    v_mul_f32 v71, v71, v253
    v_mul_f32 v72, v72, v253
    v_mul_f32 v73, v73, v253
    v_mul_f32 v74, v74, v253
    v_mul_f32 v75, v75, v253
    v_mul_f32 v76, v76, v253
    v_mul_f32 v77, v77, v253
    v_mul_f32 v78, v78, v253
    v_mul_f32 v79, v79, v253
    v_mul_f32 v80, v80, v253
    v_mul_f32 v81, v81, v253
    v_mul_f32 v82, v82, v253
    v_mul_f32 v83, v83, v253
    v_mul_f32 v84, v84, v253
    v_mul_f32 v85, v85, v253
    v_mul_f32 v86, v86, v253
    v_mul_f32 v87, v87, v253
    v_mul_f32 v88, v88, v253
    v_mul_f32 v89, v89, v253
    v_mul_f32 v90, v90, v253
    v_mul_f32 v91, v91, v253
    v_mul_f32 v92, v92, v253
    v_mul_f32 v93, v93, v253
    v_mul_f32 v94, v94, v253
    v_mul_f32 v95, v95, v253
    v_mul_f32 v96, v96, v253
    v_mul_f32 v97, v97, v253
    v_mul_f32 v98, v98, v253
    v_mul_f32 v99, v99, v253
    v_mul_f32 v100, v100, v253
    v_mul_f32 v101, v101, v253
    v_mul_f32 v102, v102, v253
    v_mul_f32 v103, v103, v253
    v_mul_f32 v248, v248, v253
    v_fma_f32 v136, v120, s24, -v247
    v_fma_f32 v137, v121, s24, -v247
    v_fma_f32 v138, v122, s24, -v247
    v_fma_f32 v139, v123, s24, -v247
    v_fma_f32 v140, v124, s24, -v247
    v_fma_f32 v141, v125, s24, -v247
    v_exp_f32 v136, v136
    v_fma_f32 v142, v126, s24, -v247
    v_exp_f32 v137, v137
    v_fma_f32 v143, v127, s24, -v247
    v_exp_f32 v138, v138
    v_fma_f32 v144, v128, s24, -v247
    v_exp_f32 v139, v139
    v_fma_f32 v145, v129, s24, -v247
    v_add_f32 v0, v136, v137
    v_exp_f32 v140, v140
    v_fma_f32 v146, v130, s24, -v247
    v_exp_f32 v141, v141
    v_fma_f32 v147, v131, s24, -v247
    v_add_f32 v1, v138, v139
    v_exp_f32 v142, v142
    v_fma_f32 v148, v132, s24, -v247
    v_exp_f32 v143, v143
    v_fma_f32 v149, v133, s24, -v247
    v_add_f32 v2, v140, v141
    v_exp_f32 v144, v144
    v_fma_f32 v150, v134, s24, -v247
    v_exp_f32 v145, v145
    v_fma_f32 v151, v135, s24, -v247
    v_add_f32 v3, v142, v143
    v_exp_f32 v146, v146
    v_exp_f32 v147, v147
    v_add_f32 v4, v144, v145
    v_exp_f32 v148, v148
    v_exp_f32 v149, v149
    v_add_f32 v5, v146, v147
    v_exp_f32 v150, v150
    v_exp_f32 v151, v151
    v_add_f32 v6, v148, v149
    v_add_f32 v7, v150, v151
    v_add_f32 v0, v0, v1
    v_add_f32 v1, v2, v3
    v_add_f32 v2, v4, v5
    v_add_f32 v3, v6, v7
    v_add_f32 v0, v0, v1
    v_add_f32 v2, v2, v3
    v_add_f32 v249, v0, v2
    s_nop 1
    s_branch L_gqa_attn_kernel_res18
L_gqa_attn_kernel_slow19:
    v_max3_f32 v250, v104, v105, v106
    v_max3_f32 v251, v107, v108, v109
    v_max3_f32 v252, v110, v111, v112
    v_max3_f32 v253, v113, v114, v115
    v_max3_f32 v254, v116, v117, v118
    v_max3_f32 v250, v250, v251, v119
    v_max3_f32 v252, v252, v253, v254
    v_max_f32 v250, v250, v252
    v_mov_b32 v251, v250
    s_nop 1
    v_permlane32_swap_b32 v250, v251
    s_nop 1
    v_max3_f32 v246, v246, v250, v251
    v_mul_f32 v252, s24, v246
    v_sub_f32 v253, v247, v252
    v_exp_f32 v253, v253
    v_mov_b32 v247, v252
    s_nop 7
    s_nop 7
    v_mul_f32 v40, v40, v253
    v_mul_f32 v41, v41, v253
    v_mul_f32 v42, v42, v253
    v_mul_f32 v43, v43, v253
    v_mul_f32 v44, v44, v253
    v_mul_f32 v45, v45, v253
    v_mul_f32 v46, v46, v253
    v_mul_f32 v47, v47, v253
    v_mul_f32 v48, v48, v253
    v_mul_f32 v49, v49, v253
    v_mul_f32 v50, v50, v253
    v_mul_f32 v51, v51, v253
    v_mul_f32 v52, v52, v253
    v_mul_f32 v53, v53, v253
    v_mul_f32 v54, v54, v253
    v_mul_f32 v55, v55, v253
    v_mul_f32 v56, v56, v253
    v_mul_f32 v57, v57, v253
    v_mul_f32 v58, v58, v253
    v_mul_f32 v59, v59, v253
    v_mul_f32 v60, v60, v253
    v_mul_f32 v61, v61, v253
    v_mul_f32 v62, v62, v253
    v_mul_f32 v63, v63, v253
    v_mul_f32 v64, v64, v253
    v_mul_f32 v65, v65, v253
    v_mul_f32 v66, v66, v253
    v_mul_f32 v67, v67, v253
    v_mul_f32 v68, v68, v253
    v_mul_f32 v69, v69, v253
    v_mul_f32 v70, v70, v253
    v_mul_f32 v71, v71, v253
    v_mul_f32 v72, v72, v253
    v_mul_f32 v73, v73, v253
    v_mul_f32 v74, v74, v253
    v_mul_f32 v75, v75, v253
    v_mul_f32 v76, v76, v253
    v_mul_f32 v77, v77, v253
    v_mul_f32 v78, v78, v253
    v_mul_f32 v79, v79, v253
    v_mul_f32 v80, v80, v253
    v_mul_f32 v81, v81, v253
    v_mul_f32 v82, v82, v253
    v_mul_f32 v83, v83, v253
    v_mul_f32 v84, v84, v253
    v_mul_f32 v85, v85, v253
    v_mul_f32 v86, v86, v253
    v_mul_f32 v87, v87, v253
    v_mul_f32 v88, v88, v253
    v_mul_f32 v89, v89, v253
    v_mul_f32 v90, v90, v253
    v_mul_f32 v91, v91, v253
    v_mul_f32 v92, v92, v253
    v_mul_f32 v93, v93, v253
    v_mul_f32 v94, v94, v253
    v_mul_f32 v95, v95, v253
    v_mul_f32 v96, v96, v253
    v_mul_f32 v97, v97, v253
    v_mul_f32 v98, v98, v253
    v_mul_f32 v99, v99, v253
    v_mul_f32 v100, v100, v253
    v_mul_f32 v101, v101, v253
    v_mul_f32 v102, v102, v253
    v_mul_f32 v103, v103, v253
    v_mul_f32 v248, v248, v253
    v_fma_f32 v136, v104, s24, -v247
    v_fma_f32 v137, v105, s24, -v247
    v_fma_f32 v138, v106, s24, -v247
    v_fma_f32 v139, v107, s24, -v247
    v_fma_f32 v140, v108, s24, -v247
    v_fma_f32 v141, v109, s24, -v247
    v_exp_f32 v136, v136
    v_fma_f32 v142, v110, s24, -v247
    v_exp_f32 v137, v137
    v_fma_f32 v143, v111, s24, -v247
    v_exp_f32 v138, v138
    v_fma_f32 v144, v112, s24, -v247
    v_exp_f32 v139, v139
    v_fma_f32 v145, v113, s24, -v247
    v_add_f32 v0, v136, v137
    v_exp_f32 v140, v140
    v_fma_f32 v146, v114, s24, -v247
    v_exp_f32 v141, v141
    v_fma_f32 v147, v115, s24, -v247
    v_add_f32 v1, v138, v139
    v_exp_f32 v142, v142
    v_fma_f32 v148, v116, s24, -v247
    v_exp_f32 v143, v143
    v_fma_f32 v149, v117, s24, -v247
    v_add_f32 v2, v140, v141
    v_exp_f32 v144, v144
    v_fma_f32 v150, v118, s24, -v247
    v_exp_f32 v145, v145
    v_fma_f32 v151, v119, s24, -v247
    v_add_f32 v3, v142, v143
    v_exp_f32 v146, v146
    v_exp_f32 v147, v147
    v_add_f32 v4, v144, v145
    v_exp_f32 v148, v148
    v_exp_f32 v149, v149
    v_add_f32 v5, v146, v147
    v_exp_f32 v150, v150
    v_exp_f32 v151, v151
    v_add_f32 v6, v148, v149
    v_add_f32 v7, v150, v151
    v_add_f32 v0, v0, v1
    v_add_f32 v1, v2, v3
    v_add_f32 v2, v4, v5
    v_add_f32 v3, v6, v7
    v_add_f32 v0, v0, v1
    v_add_f32 v2, v2, v3
    v_add_f32 v249, v0, v2
    s_nop 1
    s_branch L_gqa_attn_kernel_res19
L_gqa_attn_kernel_slow20:
    v_max3_f32 v250, v120, v121, v122
    v_max3_f32 v251, v123, v124, v125
    v_max3_f32 v252, v126, v127, v128
    v_max3_f32 v253, v129, v130, v131
    v_max3_f32 v254, v132, v133, v134
    v_max3_f32 v250, v250, v251, v135
    v_max3_f32 v252, v252, v253, v254
    v_max_f32 v250, v250, v252
    v_mov_b32 v251, v250
    s_nop 1
    v_permlane32_swap_b32 v250, v251
    s_nop 1
    v_max3_f32 v246, v246, v250, v251
    v_mul_f32 v252, s24, v246
    v_sub_f32 v253, v247, v252
    v_exp_f32 v253, v253
    v_mov_b32 v247, v252
    s_nop 7
    s_nop 7
    v_mul_f32 v40, v40, v253
    v_mul_f32 v41, v41, v253
    v_mul_f32 v42, v42, v253
    v_mul_f32 v43, v43, v253
    v_mul_f32 v44, v44, v253
    v_mul_f32 v45, v45, v253
    v_mul_f32 v46, v46, v253
    v_mul_f32 v47, v47, v253
    v_mul_f32 v48, v48, v253
    v_mul_f32 v49, v49, v253
    v_mul_f32 v50, v50, v253
    v_mul_f32 v51, v51, v253
    v_mul_f32 v52, v52, v253
    v_mul_f32 v53, v53, v253
    v_mul_f32 v54, v54, v253
    v_mul_f32 v55, v55, v253
    v_mul_f32 v56, v56, v253
    v_mul_f32 v57, v57, v253
    v_mul_f32 v58, v58, v253
    v_mul_f32 v59, v59, v253
    v_mul_f32 v60, v60, v253
    v_mul_f32 v61, v61, v253
    v_mul_f32 v62, v62, v253
    v_mul_f32 v63, v63, v253
    v_mul_f32 v64, v64, v253
    v_mul_f32 v65, v65, v253
    v_mul_f32 v66, v66, v253
    v_mul_f32 v67, v67, v253
    v_mul_f32 v68, v68, v253
    v_mul_f32 v69, v69, v253
    v_mul_f32 v70, v70, v253
    v_mul_f32 v71, v71, v253
    v_mul_f32 v72, v72, v253
    v_mul_f32 v73, v73, v253
    v_mul_f32 v74, v74, v253
    v_mul_f32 v75, v75, v253
    v_mul_f32 v76, v76, v253
    v_mul_f32 v77, v77, v253
    v_mul_f32 v78, v78, v253
    v_mul_f32 v79, v79, v253
    v_mul_f32 v80, v80, v253
    v_mul_f32 v81, v81, v253
    v_mul_f32 v82, v82, v253
    v_mul_f32 v83, v83, v253
    v_mul_f32 v84, v84, v253
    v_mul_f32 v85, v85, v253
    v_mul_f32 v86, v86, v253
    v_mul_f32 v87, v87, v253
    v_mul_f32 v88, v88, v253
    v_mul_f32 v89, v89, v253
    v_mul_f32 v90, v90, v253
    v_mul_f32 v91, v91, v253
    v_mul_f32 v92, v92, v253
    v_mul_f32 v93, v93, v253
    v_mul_f32 v94, v94, v253
    v_mul_f32 v95, v95, v253
    v_mul_f32 v96, v96, v253
    v_mul_f32 v97, v97, v253
    v_mul_f32 v98, v98, v253
    v_mul_f32 v99, v99, v253
    v_mul_f32 v100, v100, v253
    v_mul_f32 v101, v101, v253
    v_mul_f32 v102, v102, v253
    v_mul_f32 v103, v103, v253
    v_mul_f32 v248, v248, v253
    v_fma_f32 v136, v120, s24, -v247
    v_fma_f32 v137, v121, s24, -v247
    v_fma_f32 v138, v122, s24, -v247
    v_fma_f32 v139, v123, s24, -v247
    v_fma_f32 v140, v124, s24, -v247
    v_fma_f32 v141, v125, s24, -v247
    v_exp_f32 v136, v136
    v_fma_f32 v142, v126, s24, -v247
    v_exp_f32 v137, v137
    v_fma_f32 v143, v127, s24, -v247
    v_exp_f32 v138, v138
    v_fma_f32 v144, v128, s24, -v247
    v_exp_f32 v139, v139
    v_fma_f32 v145, v129, s24, -v247
    v_add_f32 v0, v136, v137
    v_exp_f32 v140, v140
    v_fma_f32 v146, v130, s24, -v247
    v_exp_f32 v141, v141
    v_fma_f32 v147, v131, s24, -v247
    v_add_f32 v1, v138, v139
    v_exp_f32 v142, v142
    v_fma_f32 v148, v132, s24, -v247
    v_exp_f32 v143, v143
    v_fma_f32 v149, v133, s24, -v247
    v_add_f32 v2, v140, v141
    v_exp_f32 v144, v144
    v_fma_f32 v150, v134, s24, -v247
    v_exp_f32 v145, v145
    v_fma_f32 v151, v135, s24, -v247
    v_add_f32 v3, v142, v143
    v_exp_f32 v146, v146
    v_exp_f32 v147, v147
    v_add_f32 v4, v144, v145
    v_exp_f32 v148, v148
    v_exp_f32 v149, v149
    v_add_f32 v5, v146, v147
    v_exp_f32 v150, v150
    v_exp_f32 v151, v151
    v_add_f32 v6, v148, v149
    v_add_f32 v7, v150, v151
    v_add_f32 v0, v0, v1
    v_add_f32 v1, v2, v3
    v_add_f32 v2, v4, v5
    v_add_f32 v3, v6, v7
    v_add_f32 v0, v0, v1
    v_add_f32 v2, v2, v3
    v_add_f32 v249, v0, v2
    s_nop 1
    s_branch L_gqa_attn_kernel_res20
L_gqa_attn_kernel_slow21:
    v_max3_f32 v250, v104, v105, v106
    v_max3_f32 v251, v107, v108, v109
    v_max3_f32 v252, v110, v111, v112
    v_max3_f32 v253, v113, v114, v115
    v_max3_f32 v254, v116, v117, v118
    v_max3_f32 v250, v250, v251, v119
    v_max3_f32 v252, v252, v253, v254
    v_max_f32 v250, v250, v252
    v_mov_b32 v251, v250
    s_nop 1
    v_permlane32_swap_b32 v250, v251
    s_nop 1
    v_max3_f32 v246, v246, v250, v251
    v_mul_f32 v252, s24, v246
    v_sub_f32 v253, v247, v252
    v_exp_f32 v253, v253
    v_mov_b32 v247, v252
    s_nop 7
    s_nop 7
    v_mul_f32 v40, v40, v253
    v_mul_f32 v41, v41, v253
    v_mul_f32 v42, v42, v253
    v_mul_f32 v43, v43, v253
    v_mul_f32 v44, v44, v253
    v_mul_f32 v45, v45, v253
    v_mul_f32 v46, v46, v253
    v_mul_f32 v47, v47, v253
    v_mul_f32 v48, v48, v253
    v_mul_f32 v49, v49, v253
    v_mul_f32 v50, v50, v253
    v_mul_f32 v51, v51, v253
    v_mul_f32 v52, v52, v253
    v_mul_f32 v53, v53, v253
    v_mul_f32 v54, v54, v253
    v_mul_f32 v55, v55, v253
    v_mul_f32 v56, v56, v253
    v_mul_f32 v57, v57, v253
    v_mul_f32 v58, v58, v253
    v_mul_f32 v59, v59, v253
    v_mul_f32 v60, v60, v253
    v_mul_f32 v61, v61, v253
    v_mul_f32 v62, v62, v253
    v_mul_f32 v63, v63, v253
    v_mul_f32 v64, v64, v253
    v_mul_f32 v65, v65, v253
    v_mul_f32 v66, v66, v253
    v_mul_f32 v67, v67, v253
    v_mul_f32 v68, v68, v253
    v_mul_f32 v69, v69, v253
    v_mul_f32 v70, v70, v253
    v_mul_f32 v71, v71, v253
    v_mul_f32 v72, v72, v253
    v_mul_f32 v73, v73, v253
    v_mul_f32 v74, v74, v253
    v_mul_f32 v75, v75, v253
    v_mul_f32 v76, v76, v253
    v_mul_f32 v77, v77, v253
    v_mul_f32 v78, v78, v253
    v_mul_f32 v79, v79, v253
    v_mul_f32 v80, v80, v253
    v_mul_f32 v81, v81, v253
    v_mul_f32 v82, v82, v253
    v_mul_f32 v83, v83, v253
    v_mul_f32 v84, v84, v253
    v_mul_f32 v85, v85, v253
    v_mul_f32 v86, v86, v253
    v_mul_f32 v87, v87, v253
    v_mul_f32 v88, v88, v253
    v_mul_f32 v89, v89, v253
    v_mul_f32 v90, v90, v253
    v_mul_f32 v91, v91, v253
    v_mul_f32 v92, v92, v253
    v_mul_f32 v93, v93, v253
    v_mul_f32 v94, v94, v253
    v_mul_f32 v95, v95, v253
    v_mul_f32 v96, v96, v253
    v_mul_f32 v97, v97, v253
    v_mul_f32 v98, v98, v253
    v_mul_f32 v99, v99, v253
    v_mul_f32 v100, v100, v253
    v_mul_f32 v101, v101, v253
    v_mul_f32 v102, v102, v253
    v_mul_f32 v103, v103, v253
    v_mul_f32 v248, v248, v253
    v_fma_f32 v136, v104, s24, -v247
    v_fma_f32 v137, v105, s24, -v247
    v_fma_f32 v138, v106, s24, -v247
    v_fma_f32 v139, v107, s24, -v247
    v_fma_f32 v140, v108, s24, -v247
    v_fma_f32 v141, v109, s24, -v247
    v_exp_f32 v136, v136
    v_fma_f32 v142, v110, s24, -v247
    v_exp_f32 v137, v137
    v_fma_f32 v143, v111, s24, -v247
    v_exp_f32 v138, v138
    v_fma_f32 v144, v112, s24, -v247
    v_exp_f32 v139, v139
    v_fma_f32 v145, v113, s24, -v247
    v_add_f32 v0, v136, v137
    v_exp_f32 v140, v140
    v_fma_f32 v146, v114, s24, -v247
    v_exp_f32 v141, v141
    v_fma_f32 v147, v115, s24, -v247
    v_add_f32 v1, v138, v139
    v_exp_f32 v142, v142
    v_fma_f32 v148, v116, s24, -v247
    v_exp_f32 v143, v143
    v_fma_f32 v149, v117, s24, -v247
    v_add_f32 v2, v140, v141
    v_exp_f32 v144, v144
    v_fma_f32 v150, v118, s24, -v247
    v_exp_f32 v145, v145
    v_fma_f32 v151, v119, s24, -v247
    v_add_f32 v3, v142, v143
    v_exp_f32 v146, v146
    v_exp_f32 v147, v147
    v_add_f32 v4, v144, v145
    v_exp_f32 v148, v148
    v_exp_f32 v149, v149
    v_add_f32 v5, v146, v147
    v_exp_f32 v150, v150
    v_exp_f32 v151, v151
    v_add_f32 v6, v148, v149
    v_add_f32 v7, v150, v151
    v_add_f32 v0, v0, v1
    v_add_f32 v1, v2, v3
    v_add_f32 v2, v4, v5
    v_add_f32 v3, v6, v7
    v_add_f32 v0, v0, v1
    v_add_f32 v2, v2, v3
    v_add_f32 v249, v0, v2
    s_nop 1
    s_branch L_gqa_attn_kernel_res21
L_gqa_attn_kernel_slow22:
    v_max3_f32 v250, v120, v121, v122
    v_max3_f32 v251, v123, v124, v125
    v_max3_f32 v252, v126, v127, v128
    v_max3_f32 v253, v129, v130, v131
    v_max3_f32 v254, v132, v133, v134
    v_max3_f32 v250, v250, v251, v135
    v_max3_f32 v252, v252, v253, v254
    v_max_f32 v250, v250, v252
    v_mov_b32 v251, v250
    s_nop 1
    v_permlane32_swap_b32 v250, v251
    s_nop 1
    v_max3_f32 v246, v246, v250, v251
    v_mul_f32 v252, s24, v246
    v_sub_f32 v253, v247, v252
    v_exp_f32 v253, v253
    v_mov_b32 v247, v252
    s_nop 7
    s_nop 7
    v_mul_f32 v40, v40, v253
    v_mul_f32 v41, v41, v253
    v_mul_f32 v42, v42, v253
    v_mul_f32 v43, v43, v253
    v_mul_f32 v44, v44, v253
    v_mul_f32 v45, v45, v253
    v_mul_f32 v46, v46, v253
    v_mul_f32 v47, v47, v253
    v_mul_f32 v48, v48, v253
    v_mul_f32 v49, v49, v253
    v_mul_f32 v50, v50, v253
    v_mul_f32 v51, v51, v253
    v_mul_f32 v52, v52, v253
    v_mul_f32 v53, v53, v253
    v_mul_f32 v54, v54, v253
    v_mul_f32 v55, v55, v253
    v_mul_f32 v56, v56, v253
    v_mul_f32 v57, v57, v253
    v_mul_f32 v58, v58, v253
    v_mul_f32 v59, v59, v253
    v_mul_f32 v60, v60, v253
    v_mul_f32 v61, v61, v253
    v_mul_f32 v62, v62, v253
    v_mul_f32 v63, v63, v253
    v_mul_f32 v64, v64, v253
    v_mul_f32 v65, v65, v253
    v_mul_f32 v66, v66, v253
    v_mul_f32 v67, v67, v253
    v_mul_f32 v68, v68, v253
    v_mul_f32 v69, v69, v253
    v_mul_f32 v70, v70, v253
    v_mul_f32 v71, v71, v253
    v_mul_f32 v72, v72, v253
    v_mul_f32 v73, v73, v253
    v_mul_f32 v74, v74, v253
    v_mul_f32 v75, v75, v253
    v_mul_f32 v76, v76, v253
    v_mul_f32 v77, v77, v253
    v_mul_f32 v78, v78, v253
    v_mul_f32 v79, v79, v253
    v_mul_f32 v80, v80, v253
    v_mul_f32 v81, v81, v253
    v_mul_f32 v82, v82, v253
    v_mul_f32 v83, v83, v253
    v_mul_f32 v84, v84, v253
    v_mul_f32 v85, v85, v253
    v_mul_f32 v86, v86, v253
    v_mul_f32 v87, v87, v253
    v_mul_f32 v88, v88, v253
    v_mul_f32 v89, v89, v253
    v_mul_f32 v90, v90, v253
    v_mul_f32 v91, v91, v253
    v_mul_f32 v92, v92, v253
    v_mul_f32 v93, v93, v253
    v_mul_f32 v94, v94, v253
    v_mul_f32 v95, v95, v253
    v_mul_f32 v96, v96, v253
    v_mul_f32 v97, v97, v253
    v_mul_f32 v98, v98, v253
    v_mul_f32 v99, v99, v253
    v_mul_f32 v100, v100, v253
    v_mul_f32 v101, v101, v253
    v_mul_f32 v102, v102, v253
    v_mul_f32 v103, v103, v253
    v_mul_f32 v248, v248, v253
    v_fma_f32 v136, v120, s24, -v247
    v_fma_f32 v137, v121, s24, -v247
    v_fma_f32 v138, v122, s24, -v247
    v_fma_f32 v139, v123, s24, -v247
    v_fma_f32 v140, v124, s24, -v247
    v_fma_f32 v141, v125, s24, -v247
    v_exp_f32 v136, v136
    v_fma_f32 v142, v126, s24, -v247
    v_exp_f32 v137, v137
    v_fma_f32 v143, v127, s24, -v247
    v_exp_f32 v138, v138
    v_fma_f32 v144, v128, s24, -v247
    v_exp_f32 v139, v139
    v_fma_f32 v145, v129, s24, -v247
    v_add_f32 v0, v136, v137
    v_exp_f32 v140, v140
    v_fma_f32 v146, v130, s24, -v247
    v_exp_f32 v141, v141
    v_fma_f32 v147, v131, s24, -v247
    v_add_f32 v1, v138, v139
    v_exp_f32 v142, v142
    v_fma_f32 v148, v132, s24, -v247
    v_exp_f32 v143, v143
    v_fma_f32 v149, v133, s24, -v247
    v_add_f32 v2, v140, v141
    v_exp_f32 v144, v144
    v_fma_f32 v150, v134, s24, -v247
    v_exp_f32 v145, v145
    v_fma_f32 v151, v135, s24, -v247
    v_add_f32 v3, v142, v143
    v_exp_f32 v146, v146
    v_exp_f32 v147, v147
    v_add_f32 v4, v144, v145
    v_exp_f32 v148, v148
    v_exp_f32 v149, v149
    v_add_f32 v5, v146, v147
    v_exp_f32 v150, v150
    v_exp_f32 v151, v151
    v_add_f32 v6, v148, v149
    v_add_f32 v7, v150, v151
    v_add_f32 v0, v0, v1
    v_add_f32 v1, v2, v3
    v_add_f32 v2, v4, v5
    v_add_f32 v3, v6, v7
    v_add_f32 v0, v0, v1
    v_add_f32 v2, v2, v3
    v_add_f32 v249, v0, v2
    s_nop 1
    s_branch L_gqa_attn_kernel_res22
L_gqa_attn_kernel_slow23:
    v_max3_f32 v250, v104, v105, v106
    v_max3_f32 v251, v107, v108, v109
    v_max3_f32 v252, v110, v111, v112
    v_max3_f32 v253, v113, v114, v115
    v_max3_f32 v254, v116, v117, v118
    v_max3_f32 v250, v250, v251, v119
    v_max3_f32 v252, v252, v253, v254
    v_max_f32 v250, v250, v252
    v_mov_b32 v251, v250
    s_nop 1
    v_permlane32_swap_b32 v250, v251
    s_nop 1
    v_max3_f32 v246, v246, v250, v251
    v_mul_f32 v252, s24, v246
    v_sub_f32 v253, v247, v252
    v_exp_f32 v253, v253
    v_mov_b32 v247, v252
    s_nop 7
    s_nop 7
    v_mul_f32 v40, v40, v253
    v_mul_f32 v41, v41, v253
    v_mul_f32 v42, v42, v253
    v_mul_f32 v43, v43, v253
    v_mul_f32 v44, v44, v253
    v_mul_f32 v45, v45, v253
    v_mul_f32 v46, v46, v253
    v_mul_f32 v47, v47, v253
    v_mul_f32 v48, v48, v253
    v_mul_f32 v49, v49, v253
    v_mul_f32 v50, v50, v253
    v_mul_f32 v51, v51, v253
    v_mul_f32 v52, v52, v253
    v_mul_f32 v53, v53, v253
    v_mul_f32 v54, v54, v253
    v_mul_f32 v55, v55, v253
    v_mul_f32 v56, v56, v253
    v_mul_f32 v57, v57, v253
    v_mul_f32 v58, v58, v253
    v_mul_f32 v59, v59, v253
    v_mul_f32 v60, v60, v253
    v_mul_f32 v61, v61, v253
    v_mul_f32 v62, v62, v253
    v_mul_f32 v63, v63, v253
    v_mul_f32 v64, v64, v253
    v_mul_f32 v65, v65, v253
    v_mul_f32 v66, v66, v253
    v_mul_f32 v67, v67, v253
    v_mul_f32 v68, v68, v253
    v_mul_f32 v69, v69, v253
    v_mul_f32 v70, v70, v253
    v_mul_f32 v71, v71, v253
    v_mul_f32 v72, v72, v253
    v_mul_f32 v73, v73, v253
    v_mul_f32 v74, v74, v253
    v_mul_f32 v75, v75, v253
    v_mul_f32 v76, v76, v253
    v_mul_f32 v77, v77, v253
    v_mul_f32 v78, v78, v253
    v_mul_f32 v79, v79, v253
    v_mul_f32 v80, v80, v253
    v_mul_f32 v81, v81, v253
    v_mul_f32 v82, v82, v253
    v_mul_f32 v83, v83, v253
    v_mul_f32 v84, v84, v253
    v_mul_f32 v85, v85, v253
    v_mul_f32 v86, v86, v253
    v_mul_f32 v87, v87, v253
    v_mul_f32 v88, v88, v253
    v_mul_f32 v89, v89, v253
    v_mul_f32 v90, v90, v253
    v_mul_f32 v91, v91, v253
    v_mul_f32 v92, v92, v253
    v_mul_f32 v93, v93, v253
    v_mul_f32 v94, v94, v253
    v_mul_f32 v95, v95, v253
    v_mul_f32 v96, v96, v253
    v_mul_f32 v97, v97, v253
    v_mul_f32 v98, v98, v253
    v_mul_f32 v99, v99, v253
    v_mul_f32 v100, v100, v253
    v_mul_f32 v101, v101, v253
    v_mul_f32 v102, v102, v253
    v_mul_f32 v103, v103, v253
    v_mul_f32 v248, v248, v253
    v_fma_f32 v136, v104, s24, -v247
    v_fma_f32 v137, v105, s24, -v247
    v_fma_f32 v138, v106, s24, -v247
    v_fma_f32 v139, v107, s24, -v247
    v_fma_f32 v140, v108, s24, -v247
    v_fma_f32 v141, v109, s24, -v247
    v_exp_f32 v136, v136
    v_fma_f32 v142, v110, s24, -v247
    v_exp_f32 v137, v137
    v_fma_f32 v143, v111, s24, -v247
    v_exp_f32 v138, v138
    v_fma_f32 v144, v112, s24, -v247
    v_exp_f32 v139, v139
    v_fma_f32 v145, v113, s24, -v247
    v_add_f32 v0, v136, v137
    v_exp_f32 v140, v140
    v_fma_f32 v146, v114, s24, -v247
    v_exp_f32 v141, v141
    v_fma_f32 v147, v115, s24, -v247
    v_add_f32 v1, v138, v139
    v_exp_f32 v142, v142
    v_fma_f32 v148, v116, s24, -v247
    v_exp_f32 v143, v143
    v_fma_f32 v149, v117, s24, -v247
    v_add_f32 v2, v140, v141
    v_exp_f32 v144, v144
    v_fma_f32 v150, v118, s24, -v247
    v_exp_f32 v145, v145
    v_fma_f32 v151, v119, s24, -v247
    v_add_f32 v3, v142, v143
    v_exp_f32 v146, v146
    v_exp_f32 v147, v147
    v_add_f32 v4, v144, v145
    v_exp_f32 v148, v148
    v_exp_f32 v149, v149
    v_add_f32 v5, v146, v147
    v_exp_f32 v150, v150
    v_exp_f32 v151, v151
    v_add_f32 v6, v148, v149
    v_add_f32 v7, v150, v151
    v_add_f32 v0, v0, v1
    v_add_f32 v1, v2, v3
    v_add_f32 v2, v4, v5
    v_add_f32 v3, v6, v7
    v_add_f32 v0, v0, v1
    v_add_f32 v2, v2, v3
    v_add_f32 v249, v0, v2
    s_nop 1
    s_branch L_gqa_attn_kernel_res23
L_gqa_attn_kernel_slow24:
    v_max3_f32 v250, v120, v121, v122
    v_max3_f32 v251, v123, v124, v125
    v_max3_f32 v252, v126, v127, v128
    v_max3_f32 v253, v129, v130, v131
    v_max3_f32 v254, v132, v133, v134
    v_max3_f32 v250, v250, v251, v135
    v_max3_f32 v252, v252, v253, v254
    v_max_f32 v250, v250, v252
    v_mov_b32 v251, v250
    s_nop 1
    v_permlane32_swap_b32 v250, v251
    s_nop 1
    v_max3_f32 v246, v246, v250, v251
    v_mul_f32 v252, s24, v246
    v_sub_f32 v253, v247, v252
    v_exp_f32 v253, v253
    v_mov_b32 v247, v252
    s_nop 7
    s_nop 7
    v_mul_f32 v40, v40, v253
    v_mul_f32 v41, v41, v253
    v_mul_f32 v42, v42, v253
    v_mul_f32 v43, v43, v253
    v_mul_f32 v44, v44, v253
    v_mul_f32 v45, v45, v253
    v_mul_f32 v46, v46, v253
    v_mul_f32 v47, v47, v253
    v_mul_f32 v48, v48, v253
    v_mul_f32 v49, v49, v253
    v_mul_f32 v50, v50, v253
    v_mul_f32 v51, v51, v253
    v_mul_f32 v52, v52, v253
    v_mul_f32 v53, v53, v253
    v_mul_f32 v54, v54, v253
    v_mul_f32 v55, v55, v253
    v_mul_f32 v56, v56, v253
    v_mul_f32 v57, v57, v253
    v_mul_f32 v58, v58, v253
    v_mul_f32 v59, v59, v253
    v_mul_f32 v60, v60, v253
    v_mul_f32 v61, v61, v253
    v_mul_f32 v62, v62, v253
    v_mul_f32 v63, v63, v253
    v_mul_f32 v64, v64, v253
    v_mul_f32 v65, v65, v253
    v_mul_f32 v66, v66, v253
    v_mul_f32 v67, v67, v253
    v_mul_f32 v68, v68, v253
    v_mul_f32 v69, v69, v253
    v_mul_f32 v70, v70, v253
    v_mul_f32 v71, v71, v253
    v_mul_f32 v72, v72, v253
    v_mul_f32 v73, v73, v253
    v_mul_f32 v74, v74, v253
    v_mul_f32 v75, v75, v253
    v_mul_f32 v76, v76, v253
    v_mul_f32 v77, v77, v253
    v_mul_f32 v78, v78, v253
    v_mul_f32 v79, v79, v253
    v_mul_f32 v80, v80, v253
    v_mul_f32 v81, v81, v253
    v_mul_f32 v82, v82, v253
    v_mul_f32 v83, v83, v253
    v_mul_f32 v84, v84, v253
    v_mul_f32 v85, v85, v253
    v_mul_f32 v86, v86, v253
    v_mul_f32 v87, v87, v253
    v_mul_f32 v88, v88, v253
    v_mul_f32 v89, v89, v253
    v_mul_f32 v90, v90, v253
    v_mul_f32 v91, v91, v253
    v_mul_f32 v92, v92, v253
    v_mul_f32 v93, v93, v253
    v_mul_f32 v94, v94, v253
    v_mul_f32 v95, v95, v253
    v_mul_f32 v96, v96, v253
    v_mul_f32 v97, v97, v253
    v_mul_f32 v98, v98, v253
    v_mul_f32 v99, v99, v253
    v_mul_f32 v100, v100, v253
    v_mul_f32 v101, v101, v253
    v_mul_f32 v102, v102, v253
    v_mul_f32 v103, v103, v253
    v_mul_f32 v248, v248, v253
    v_fma_f32 v136, v120, s24, -v247
    v_fma_f32 v137, v121, s24, -v247
    v_fma_f32 v138, v122, s24, -v247
    v_fma_f32 v139, v123, s24, -v247
    v_fma_f32 v140, v124, s24, -v247
    v_fma_f32 v141, v125, s24, -v247
    v_exp_f32 v136, v136
    v_fma_f32 v142, v126, s24, -v247
    v_exp_f32 v137, v137
    v_fma_f32 v143, v127, s24, -v247
    v_exp_f32 v138, v138
    v_fma_f32 v144, v128, s24, -v247
    v_exp_f32 v139, v139
    v_fma_f32 v145, v129, s24, -v247
    v_add_f32 v0, v136, v137
    v_exp_f32 v140, v140
    v_fma_f32 v146, v130, s24, -v247
    v_exp_f32 v141, v141
    v_fma_f32 v147, v131, s24, -v247
    v_add_f32 v1, v138, v139
    v_exp_f32 v142, v142
    v_fma_f32 v148, v132, s24, -v247
    v_exp_f32 v143, v143
    v_fma_f32 v149, v133, s24, -v247
    v_add_f32 v2, v140, v141
    v_exp_f32 v144, v144
    v_fma_f32 v150, v134, s24, -v247
    v_exp_f32 v145, v145
    v_fma_f32 v151, v135, s24, -v247
    v_add_f32 v3, v142, v143
    v_exp_f32 v146, v146
    v_exp_f32 v147, v147
    v_add_f32 v4, v144, v145
    v_exp_f32 v148, v148
    v_exp_f32 v149, v149
    v_add_f32 v5, v146, v147
    v_exp_f32 v150, v150
    v_exp_f32 v151, v151
    v_add_f32 v6, v148, v149
    v_add_f32 v7, v150, v151
    v_add_f32 v0, v0, v1
    v_add_f32 v1, v2, v3
    v_add_f32 v2, v4, v5
    v_add_f32 v3, v6, v7
    v_add_f32 v0, v0, v1
    v_add_f32 v2, v2, v3
    v_add_f32 v249, v0, v2
    s_nop 1
    s_branch L_gqa_attn_kernel_res24
L_gqa_attn_kernel_epi:
    s_nop 15
    s_nop 3
    s_waitcnt lgkmcnt(0)
    s_barrier
    v_mbcnt_lo_u32_b32 v1, -1, 0
    v_mbcnt_hi_u32_b32 v1, -1, v1
    v_mov_b32 v250, v248
    s_nop 1
    v_permlane32_swap_b32 v248, v250
    s_nop 1
    v_add_f32 v248, v248, v250
    v_lshlrev_b32 v2, 4, v1
    s_lshl_b32 s37, s29, 13
    v_add_u32 v2, s37, v2
    v_lshlrev_b32 v3, 2, v1
    s_lshl_b32 s39, s29, 9
    s_add_u32 s39, s39, 65536
    v_add_u32 v3, s39, v3
    ds_write_b32 v3, v246
    ds_write_b32 v3, v248 offset:256
    s_cmp_ge_u32 s29, 4
    s_cbranch_scc1 L_gqa_attn_kernel_epi1
    ds_write_b128 v2, v[72:75] offset:0
    ds_write_b128 v2, v[76:79] offset:1024
    ds_write_b128 v2, v[80:83] offset:2048
    ds_write_b128 v2, v[84:87] offset:3072
    ds_write_b128 v2, v[88:91] offset:4096
    ds_write_b128 v2, v[92:95] offset:5120
    ds_write_b128 v2, v[96:99] offset:6144
    ds_write_b128 v2, v[100:103] offset:7168
    s_branch L_gqa_attn_kernel_epi2
L_gqa_attn_kernel_epi1:
    ds_write_b128 v2, v[40:43] offset:0
    ds_write_b128 v2, v[44:47] offset:1024
    ds_write_b128 v2, v[48:51] offset:2048
    ds_write_b128 v2, v[52:55] offset:3072
    ds_write_b128 v2, v[56:59] offset:4096
    ds_write_b128 v2, v[60:63] offset:5120
    ds_write_b128 v2, v[64:67] offset:6144
    ds_write_b128 v2, v[68:71] offset:7168
L_gqa_attn_kernel_epi2:
    s_waitcnt lgkmcnt(0)
    s_barrier
    s_xor_b32 s37, s29, 4
    v_lshlrev_b32 v2, 4, v1
    s_lshl_b32 s38, s37, 13
    v_add_u32 v2, s38, v2
    v_lshlrev_b32 v3, 2, v1
    s_lshl_b32 s39, s37, 9
    s_add_u32 s39, s39, 65536
    v_add_u32 v3, s39, v3
    ds_read_b32 v250, v3
    ds_read_b32 v251, v3 offset:256
    ds_read_b128 v[168:171], v2 offset:0
    ds_read_b128 v[172:175], v2 offset:1024
    ds_read_b128 v[176:179], v2 offset:2048
    ds_read_b128 v[180:183], v2 offset:3072
    ds_read_b128 v[184:187], v2 offset:4096
    ds_read_b128 v[188:191], v2 offset:5120
    ds_read_b128 v[192:195], v2 offset:6144
    ds_read_b128 v[196:199], v2 offset:7168
    s_waitcnt lgkmcnt(0)
    v_max_f32 v252, v246, v250
    v_sub_f32 v253, v246, v252
    v_mul_f32 v253, s24, v253
    v_exp_f32 v253, v253
    v_sub_f32 v254, v250, v252
    v_mul_f32 v254, s24, v254
    v_exp_f32 v254, v254
    s_nop 0
    v_mul_f32 v4, v248, v253
    v_fma_f32 v4, v251, v254, v4
    v_rcp_f32 v4, v4
    s_nop 0
    v_mul_f32 v253, v253, v4
    v_mul_f32 v254, v254, v4
    s_cmp_ge_u32 s29, 4
    s_cbranch_scc1 L_gqa_attn_kernel_fin1
    s_mov_b32 s40, s32
    v_mul_f32 v40, v40, v253
    v_mul_f32 v41, v41, v253
    v_mul_f32 v42, v42, v253
    v_mul_f32 v43, v43, v253
    v_mul_f32 v44, v44, v253
    v_mul_f32 v45, v45, v253
    v_mul_f32 v46, v46, v253
    v_mul_f32 v47, v47, v253
    v_mul_f32 v48, v48, v253
    v_mul_f32 v49, v49, v253
    v_mul_f32 v50, v50, v253
    v_mul_f32 v51, v51, v253
    v_mul_f32 v52, v52, v253
    v_mul_f32 v53, v53, v253
    v_mul_f32 v54, v54, v253
    v_mul_f32 v55, v55, v253
    v_mul_f32 v56, v56, v253
    v_mul_f32 v57, v57, v253
    v_mul_f32 v58, v58, v253
    v_mul_f32 v59, v59, v253
    v_mul_f32 v60, v60, v253
    v_mul_f32 v61, v61, v253
    v_mul_f32 v62, v62, v253
    v_mul_f32 v63, v63, v253
    v_mul_f32 v64, v64, v253
    v_mul_f32 v65, v65, v253
    v_mul_f32 v66, v66, v253
    v_mul_f32 v67, v67, v253
    v_mul_f32 v68, v68, v253
    v_mul_f32 v69, v69, v253
    v_mul_f32 v70, v70, v253
    v_mul_f32 v71, v71, v253
    v_fma_f32 v40, v168, v254, v40
    v_fma_f32 v41, v169, v254, v41
    v_fma_f32 v42, v170, v254, v42
    v_fma_f32 v43, v171, v254, v43
    v_fma_f32 v44, v172, v254, v44
    v_fma_f32 v45, v173, v254, v45
    v_fma_f32 v46, v174, v254, v46
    v_fma_f32 v47, v175, v254, v47
    v_fma_f32 v48, v176, v254, v48
    v_fma_f32 v49, v177, v254, v49
    v_fma_f32 v50, v178, v254, v50
    v_fma_f32 v51, v179, v254, v51
    v_fma_f32 v52, v180, v254, v52
    v_fma_f32 v53, v181, v254, v53
    v_fma_f32 v54, v182, v254, v54
    v_fma_f32 v55, v183, v254, v55
    v_fma_f32 v56, v184, v254, v56
    v_fma_f32 v57, v185, v254, v57
    v_fma_f32 v58, v186, v254, v58
    v_fma_f32 v59, v187, v254, v59
    v_fma_f32 v60, v188, v254, v60
    v_fma_f32 v61, v189, v254, v61
    v_fma_f32 v62, v190, v254, v62
    v_fma_f32 v63, v191, v254, v63
    v_fma_f32 v64, v192, v254, v64
    v_fma_f32 v65, v193, v254, v65
    v_fma_f32 v66, v194, v254, v66
    v_fma_f32 v67, v195, v254, v67
    v_fma_f32 v68, v196, v254, v68
    v_fma_f32 v69, v197, v254, v69
    v_fma_f32 v70, v198, v254, v70
    v_fma_f32 v71, v199, v254, v71
    v_cvt_pk_bf16_f32 v136, v40, v41
    v_cvt_pk_bf16_f32 v137, v42, v43
    v_cvt_pk_bf16_f32 v138, v44, v45
    v_cvt_pk_bf16_f32 v139, v46, v47
    s_nop 1
    v_permlane32_swap_b32 v136, v138
    v_permlane32_swap_b32 v137, v139
    s_nop 0
    buffer_store_dwordx4 v[136:139], v255, s[20:23], s40 offen offset:0
    s_nop 1
    v_cvt_pk_bf16_f32 v136, v48, v49
    v_cvt_pk_bf16_f32 v137, v50, v51
    v_cvt_pk_bf16_f32 v138, v52, v53
    v_cvt_pk_bf16_f32 v139, v54, v55
    s_nop 1
    v_permlane32_swap_b32 v136, v138
    v_permlane32_swap_b32 v137, v139
    s_nop 0
    buffer_store_dwordx4 v[136:139], v255, s[20:23], s40 offen offset:32
    s_nop 1
    v_cvt_pk_bf16_f32 v136, v56, v57
    v_cvt_pk_bf16_f32 v137, v58, v59
    v_cvt_pk_bf16_f32 v138, v60, v61
    v_cvt_pk_bf16_f32 v139, v62, v63
    s_nop 1
    v_permlane32_swap_b32 v136, v138
    v_permlane32_swap_b32 v137, v139
    s_nop 0
    buffer_store_dwordx4 v[136:139], v255, s[20:23], s40 offen offset:64
    s_nop 1
    v_cvt_pk_bf16_f32 v136, v64, v65
    v_cvt_pk_bf16_f32 v137, v66, v67
    v_cvt_pk_bf16_f32 v138, v68, v69
    v_cvt_pk_bf16_f32 v139, v70, v71
    s_nop 1
    v_permlane32_swap_b32 v136, v138
    v_permlane32_swap_b32 v137, v139
    s_nop 0
    buffer_store_dwordx4 v[136:139], v255, s[20:23], s40 offen offset:96
    s_nop 1
    s_branch L_gqa_attn_kernel_fin2
L_gqa_attn_kernel_fin1:
    s_add_u32 s40, s32, 128
    v_mul_f32 v72, v72, v253
    v_mul_f32 v73, v73, v253
    v_mul_f32 v74, v74, v253
    v_mul_f32 v75, v75, v253
    v_mul_f32 v76, v76, v253
    v_mul_f32 v77, v77, v253
    v_mul_f32 v78, v78, v253
    v_mul_f32 v79, v79, v253
    v_mul_f32 v80, v80, v253
    v_mul_f32 v81, v81, v253
    v_mul_f32 v82, v82, v253
    v_mul_f32 v83, v83, v253
    v_mul_f32 v84, v84, v253
    v_mul_f32 v85, v85, v253
    v_mul_f32 v86, v86, v253
    v_mul_f32 v87, v87, v253
    v_mul_f32 v88, v88, v253
    v_mul_f32 v89, v89, v253
    v_mul_f32 v90, v90, v253
    v_mul_f32 v91, v91, v253
    v_mul_f32 v92, v92, v253
    v_mul_f32 v93, v93, v253
    v_mul_f32 v94, v94, v253
    v_mul_f32 v95, v95, v253
    v_mul_f32 v96, v96, v253
    v_mul_f32 v97, v97, v253
    v_mul_f32 v98, v98, v253
    v_mul_f32 v99, v99, v253
    v_mul_f32 v100, v100, v253
    v_mul_f32 v101, v101, v253
    v_mul_f32 v102, v102, v253
    v_mul_f32 v103, v103, v253
    v_fma_f32 v72, v168, v254, v72
    v_fma_f32 v73, v169, v254, v73
    v_fma_f32 v74, v170, v254, v74
    v_fma_f32 v75, v171, v254, v75
    v_fma_f32 v76, v172, v254, v76
    v_fma_f32 v77, v173, v254, v77
    v_fma_f32 v78, v174, v254, v78
    v_fma_f32 v79, v175, v254, v79
    v_fma_f32 v80, v176, v254, v80
    v_fma_f32 v81, v177, v254, v81
    v_fma_f32 v82, v178, v254, v82
    v_fma_f32 v83, v179, v254, v83
    v_fma_f32 v84, v180, v254, v84
    v_fma_f32 v85, v181, v254, v85
    v_fma_f32 v86, v182, v254, v86
    v_fma_f32 v87, v183, v254, v87
    v_fma_f32 v88, v184, v254, v88
    v_fma_f32 v89, v185, v254, v89
    v_fma_f32 v90, v186, v254, v90
    v_fma_f32 v91, v187, v254, v91
    v_fma_f32 v92, v188, v254, v92
    v_fma_f32 v93, v189, v254, v93
    v_fma_f32 v94, v190, v254, v94
    v_fma_f32 v95, v191, v254, v95
    v_fma_f32 v96, v192, v254, v96
    v_fma_f32 v97, v193, v254, v97
    v_fma_f32 v98, v194, v254, v98
    v_fma_f32 v99, v195, v254, v99
    v_fma_f32 v100, v196, v254, v100
    v_fma_f32 v101, v197, v254, v101
    v_fma_f32 v102, v198, v254, v102
    v_fma_f32 v103, v199, v254, v103
    v_cvt_pk_bf16_f32 v136, v72, v73
    v_cvt_pk_bf16_f32 v137, v74, v75
    v_cvt_pk_bf16_f32 v138, v76, v77
    v_cvt_pk_bf16_f32 v139, v78, v79
    s_nop 1
    v_permlane32_swap_b32 v136, v138
    v_permlane32_swap_b32 v137, v139
    s_nop 0
    buffer_store_dwordx4 v[136:139], v255, s[20:23], s40 offen offset:0
    s_nop 1
    v_cvt_pk_bf16_f32 v136, v80, v81
    v_cvt_pk_bf16_f32 v137, v82, v83
    v_cvt_pk_bf16_f32 v138, v84, v85
    v_cvt_pk_bf16_f32 v139, v86, v87
    s_nop 1
    v_permlane32_swap_b32 v136, v138
    v_permlane32_swap_b32 v137, v139
    s_nop 0
    buffer_store_dwordx4 v[136:139], v255, s[20:23], s40 offen offset:32
    s_nop 1
    v_cvt_pk_bf16_f32 v136, v88, v89
    v_cvt_pk_bf16_f32 v137, v90, v91
    v_cvt_pk_bf16_f32 v138, v92, v93
    v_cvt_pk_bf16_f32 v139, v94, v95
    s_nop 1
    v_permlane32_swap_b32 v136, v138
    v_permlane32_swap_b32 v137, v139
    s_nop 0
    buffer_store_dwordx4 v[136:139], v255, s[20:23], s40 offen offset:64
    s_nop 1
    v_cvt_pk_bf16_f32 v136, v96, v97
    v_cvt_pk_bf16_f32 v137, v98, v99
    v_cvt_pk_bf16_f32 v138, v100, v101
    v_cvt_pk_bf16_f32 v139, v102, v103
    s_nop 1
    v_permlane32_swap_b32 v136, v138
    v_permlane32_swap_b32 v137, v139
    s_nop 0
    buffer_store_dwordx4 v[136:139], v255, s[20:23], s40 offen offset:96
    s_nop 1
L_gqa_attn_kernel_fin2:
L_gqa_attn_kernel_end:
    s_endpgm
.globl gqa_oproj_kernel
.p2align 8
.type gqa_oproj_kernel,@function
gqa_oproj_kernel:
    s_cmp_ge_u32 s2, 256
    s_cbranch_scc1 L_gqa_oproj_kernel_end
    s_load_dwordx2 s[4:5], s[0:1], 56
    s_load_dwordx2 s[6:7], s[0:1], 32
    s_load_dwordx2 s[8:9], s[0:1], 40
    v_and_b32 v1, 63, v0
    v_lshrrev_b32 v2, 6, v0
    s_nop 0
    v_readfirstlane_b32 s24, v2
    s_and_b32 s30, s2, 7
    s_lshr_b32 s31, s2, 3
    s_lshr_b32 s25, s30, 2
    s_lshl_b32 s25, s25, 3
    s_lshr_b32 s33, s31, 2
    s_add_u32 s25, s25, s33
    s_and_b32 s26, s30, 3
    s_lshl_b32 s26, s26, 2
    s_and_b32 s33, s31, 3
    s_add_u32 s26, s26, s33
    s_lshl_b32 s25, s25, 6
    s_lshl_b32 s26, s26, 6
    s_waitcnt lgkmcnt(0)
    s_add_u32 s12, s4, 8388608
    s_addc_u32 s13, s5, 0
    s_and_b32 s13, s13, 0xffff
    s_mov_b32 s14, 8388608
    s_mov_b32 s15, 0x00020000
    s_mov_b32 s16, s6
    s_and_b32 s17, s7, 0xffff
    s_mov_b32 s18, 8388608
    s_mov_b32 s19, 0x00020000
    s_mov_b32 s20, s8
    s_and_b32 s21, s9, 0xffff
    s_mov_b32 s22, 2097152
    s_mov_b32 s23, 0x00020000
    v_lshrrev_b32 v2, 3, v1
    v_lshrrev_b32 v3, 4, v1
    s_and_b32 s30, s24, 1
    s_lshl_b32 s30, s30, 2
    v_add_u32 v3, s30, v3
    v_and_b32 v3, 7, v3
    v_and_b32 v4, 7, v1
    v_xor_b32 v4, v4, v3
    s_mov_b32 s30, 8192
    v_mul_lo_u32 v5, v2, s30
    v_lshlrev_b32 v4, 4, v4
    v_add_u32 v10, v5, v4
    v_lshrrev_b32 v3, 4, v1
    v_and_b32 v3, 1, v3
    v_lshlrev_b32 v3, 2, v3
    v_and_b32 v4, 7, v1
    v_xor_b32 v4, v4, v3
    s_mov_b32 s30, 2048
    v_mul_lo_u32 v5, v2, s30
    v_lshlrev_b32 v4, 4, v4
    v_add_u32 v11, v5, v4
    s_lshl_b32 s30, s24, 3
    s_add_u32 s30, s30, s25
    s_mul_i32 s27, s30, 8192
    s_mul_i32 s28, s24, 16384
    s_lshl_b32 s30, s26, 1
    s_add_u32 s28, s28, s30
    v_and_b32 v2, 31, v1
    v_lshrrev_b32 v3, 5, v1
    v_lshrrev_b32 v4, 1, v2
    v_and_b32 v4, 7, v4
    v_xor_b32 v4, v4, v3
    v_lshlrev_b32 v4, 4, v4
    v_lshlrev_b32 v5, 7, v2
    v_add_u32 v12, v5, v4
    s_lshl_b32 s30, s24, 5
    v_xor_b32 v12, s30, v12
    v_and_b32 v2, 15, v1
    v_lshrrev_b32 v3, 2, v2
    v_lshrrev_b32 v4, 5, v1
    v_lshlrev_b32 v4, 3, v4
    v_add_u32 v4, v4, v3
    v_lshlrev_b32 v16, 7, v4
    v_lshrrev_b32 v4, 1, v3
    v_lshlrev_b32 v4, 6, v4
    v_add_u32 v16, v16, v4
    v_lshrrev_b32 v4, 4, v1
    v_and_b32 v4, 1, v4
    v_lshlrev_b32 v4, 5, v4
    v_add_u32 v16, v16, v4
    v_and_b32 v4, 3, v1
    v_lshlrev_b32 v4, 3, v4
    v_add_u32 v16, v16, v4
    s_lshl_b32 s30, s24, 11
    s_add_u32 s30, s30, 8192
    v_add_u32 v16, s30, v16
    v_xor_b32 v17, 64, v16
    v_and_b32 v2, 31, v1
    s_mov_b32 s30, 2048
    v_mul_lo_u32 v18, v2, s30
    v_lshrrev_b32 v3, 5, v1
    v_lshlrev_b32 v3, 4, v3
    v_add_u32 v18, v18, v3
    v_mov_b32 v64, 0
    v_mov_b32 v65, 0
    v_mov_b32 v66, 0
    v_mov_b32 v67, 0
    v_mov_b32 v68, 0
    v_mov_b32 v69, 0
    v_mov_b32 v70, 0
    v_mov_b32 v71, 0
    v_mov_b32 v72, 0
    v_mov_b32 v73, 0
    v_mov_b32 v74, 0
    v_mov_b32 v75, 0
    v_mov_b32 v76, 0
    v_mov_b32 v77, 0
    v_mov_b32 v78, 0
    v_mov_b32 v79, 0
    v_mov_b32 v80, 0
    v_mov_b32 v81, 0
    v_mov_b32 v82, 0
    v_mov_b32 v83, 0
    v_mov_b32 v84, 0
    v_mov_b32 v85, 0
    v_mov_b32 v86, 0
    v_mov_b32 v87, 0
    v_mov_b32 v88, 0
    v_mov_b32 v89, 0
    v_mov_b32 v90, 0
    v_mov_b32 v91, 0
    v_mov_b32 v92, 0
    v_mov_b32 v93, 0
    v_mov_b32 v94, 0
    v_mov_b32 v95, 0
    v_mov_b32 v96, 0
    v_mov_b32 v97, 0
    v_mov_b32 v98, 0
    v_mov_b32 v99, 0
    v_mov_b32 v100, 0
    v_mov_b32 v101, 0
    v_mov_b32 v102, 0
    v_mov_b32 v103, 0
    v_mov_b32 v104, 0
    v_mov_b32 v105, 0
    v_mov_b32 v106, 0
    v_mov_b32 v107, 0
    v_mov_b32 v108, 0
    v_mov_b32 v109, 0
    v_mov_b32 v110, 0
    v_mov_b32 v111, 0
    v_mov_b32 v112, 0
    v_mov_b32 v113, 0
    v_mov_b32 v114, 0
    v_mov_b32 v115, 0
    v_mov_b32 v116, 0
    v_mov_b32 v117, 0
    v_mov_b32 v118, 0
    v_mov_b32 v119, 0
    v_mov_b32 v120, 0
    v_mov_b32 v121, 0
    v_mov_b32 v122, 0
    v_mov_b32 v123, 0
    v_mov_b32 v124, 0
    v_mov_b32 v125, 0
    v_mov_b32 v126, 0
    v_mov_b32 v127, 0
    s_lshl_b32 s34, s24, 10
    s_lshr_b32 s56, s2, 3
    s_and_b32 s56, s56, 31
    s_lshl_b32 s56, s56, 8
    s_mul_i32 s57, s56, 1024
    s_add_u32 s35, s34, 0
    s_mov_b32 m0, s35
    s_add_u32 s30, s27, 0
    s_add_u32 s30, s30, s56
    buffer_load_dwordx4 v10, s[12:15], s30 offen  lds
    s_add_u32 s35, s34, 4096
    s_mov_b32 m0, s35
    s_add_u32 s30, s27, 262144
    s_add_u32 s30, s30, s56
    buffer_load_dwordx4 v10, s[12:15], s30 offen  lds
    s_add_u32 s35, s34, 8192
    s_mov_b32 m0, s35
    s_add_u32 s30, s28, 0
    s_add_u32 s30, s30, s57
    buffer_load_dwordx4 v11, s[16:19], s30 offen  lds
    s_add_u32 s35, s34, 12288
    s_mov_b32 m0, s35
    s_add_u32 s30, s28, 65536
    s_add_u32 s30, s30, s57
    buffer_load_dwordx4 v11, s[16:19], s30 offen  lds
    s_add_u32 s56, s56, 128
    s_and_b32 s56, s56, 8191
    s_add_u32 s57, s57, 131072
    s_and_b32 s57, s57, 8388607
    s_add_u32 s35, s34, 16384
    s_mov_b32 m0, s35
    s_add_u32 s30, s27, 0
    s_add_u32 s30, s30, s56
    buffer_load_dwordx4 v10, s[12:15], s30 offen  lds
    s_add_u32 s35, s34, 20480
    s_mov_b32 m0, s35
    s_add_u32 s30, s27, 262144
    s_add_u32 s30, s30, s56
    buffer_load_dwordx4 v10, s[12:15], s30 offen  lds
    s_add_u32 s35, s34, 24576
    s_mov_b32 m0, s35
    s_add_u32 s30, s28, 0
    s_add_u32 s30, s30, s57
    buffer_load_dwordx4 v11, s[16:19], s30 offen  lds
    s_add_u32 s35, s34, 28672
    s_mov_b32 m0, s35
    s_add_u32 s30, s28, 65536
    s_add_u32 s30, s30, s57
    buffer_load_dwordx4 v11, s[16:19], s30 offen  lds
    s_add_u32 s56, s56, 128
    s_and_b32 s56, s56, 8191
    s_add_u32 s57, s57, 131072
    s_and_b32 s57, s57, 8388607
    s_add_u32 s35, s34, 32768
    s_mov_b32 m0, s35
    s_add_u32 s30, s27, 0
    s_add_u32 s30, s30, s56
    buffer_load_dwordx4 v10, s[12:15], s30 offen  lds
    s_add_u32 s35, s34, 36864
    s_mov_b32 m0, s35
    s_add_u32 s30, s27, 262144
    s_add_u32 s30, s30, s56
    buffer_load_dwordx4 v10, s[12:15], s30 offen  lds
    s_add_u32 s35, s34, 40960
    s_mov_b32 m0, s35
    s_add_u32 s30, s28, 0
    s_add_u32 s30, s30, s57
    buffer_load_dwordx4 v11, s[16:19], s30 offen  lds
    s_add_u32 s35, s34, 45056
    s_mov_b32 m0, s35
    s_add_u32 s30, s28, 65536
    s_add_u32 s30, s30, s57
    buffer_load_dwordx4 v11, s[16:19], s30 offen  lds
    s_add_u32 s56, s56, 128
    s_and_b32 s56, s56, 8191
    s_add_u32 s57, s57, 131072
    s_and_b32 s57, s57, 8388607
    s_add_u32 s35, s34, 49152
    s_mov_b32 m0, s35
    s_add_u32 s30, s27, 0
    s_add_u32 s30, s30, s56
    buffer_load_dwordx4 v10, s[12:15], s30 offen  lds
    s_add_u32 s35, s34, 53248
    s_mov_b32 m0, s35
    s_add_u32 s30, s27, 262144
    s_add_u32 s30, s30, s56
    buffer_load_dwordx4 v10, s[12:15], s30 offen  lds
    s_add_u32 s35, s34, 57344
    s_mov_b32 m0, s35
    s_add_u32 s30, s28, 0
    s_add_u32 s30, s30, s57
    buffer_load_dwordx4 v11, s[16:19], s30 offen  lds
    s_add_u32 s35, s34, 61440
    s_mov_b32 m0, s35
    s_add_u32 s30, s28, 65536
    s_add_u32 s30, s30, s57
    buffer_load_dwordx4 v11, s[16:19], s30 offen  lds
    s_add_u32 s56, s56, 128
    s_and_b32 s56, s56, 8191
    s_add_u32 s57, s57, 131072
    s_and_b32 s57, s57, 8388607
    s_add_u32 s35, s34, 65536
    s_mov_b32 m0, s35
    s_add_u32 s30, s27, 0
    s_add_u32 s30, s30, s56
    buffer_load_dwordx4 v10, s[12:15], s30 offen  lds
    s_add_u32 s35, s34, 69632
    s_mov_b32 m0, s35
    s_add_u32 s30, s27, 262144
    s_add_u32 s30, s30, s56
    buffer_load_dwordx4 v10, s[12:15], s30 offen  lds
    s_add_u32 s35, s34, 73728
    s_mov_b32 m0, s35
    s_add_u32 s30, s28, 0
    s_add_u32 s30, s30, s57
    buffer_load_dwordx4 v11, s[16:19], s30 offen  lds
    s_add_u32 s35, s34, 77824
    s_mov_b32 m0, s35
    s_add_u32 s30, s28, 65536
    s_add_u32 s30, s30, s57
    buffer_load_dwordx4 v11, s[16:19], s30 offen  lds
    s_add_u32 s56, s56, 128
    s_and_b32 s56, s56, 8191
    s_add_u32 s57, s57, 131072
    s_and_b32 s57, s57, 8388607
    s_add_u32 s35, s34, 81920
    s_mov_b32 m0, s35
    s_add_u32 s30, s27, 0
    s_add_u32 s30, s30, s56
    buffer_load_dwordx4 v10, s[12:15], s30 offen  lds
    s_add_u32 s35, s34, 86016
    s_mov_b32 m0, s35
    s_add_u32 s30, s27, 262144
    s_add_u32 s30, s30, s56
    buffer_load_dwordx4 v10, s[12:15], s30 offen  lds
    s_add_u32 s35, s34, 90112
    s_mov_b32 m0, s35
    s_add_u32 s30, s28, 0
    s_add_u32 s30, s30, s57
    buffer_load_dwordx4 v11, s[16:19], s30 offen  lds
    s_add_u32 s35, s34, 94208
    s_mov_b32 m0, s35
    s_add_u32 s30, s28, 65536
    s_add_u32 s30, s30, s57
    buffer_load_dwordx4 v11, s[16:19], s30 offen  lds
    s_add_u32 s56, s56, 128
    s_and_b32 s56, s56, 8191
    s_add_u32 s57, s57, 131072
    s_and_b32 s57, s57, 8388607
    s_add_u32 s35, s34, 98304
    s_mov_b32 m0, s35
    s_add_u32 s30, s27, 0
    s_add_u32 s30, s30, s56
    buffer_load_dwordx4 v10, s[12:15], s30 offen  lds
    s_add_u32 s35, s34, 102400
    s_mov_b32 m0, s35
    s_add_u32 s30, s27, 262144
    s_add_u32 s30, s30, s56
    buffer_load_dwordx4 v10, s[12:15], s30 offen  lds
    s_add_u32 s35, s34, 106496
    s_mov_b32 m0, s35
    s_add_u32 s30, s28, 0
    s_add_u32 s30, s30, s57
    buffer_load_dwordx4 v11, s[16:19], s30 offen  lds
    s_add_u32 s35, s34, 110592
    s_mov_b32 m0, s35
    s_add_u32 s30, s28, 65536
    s_add_u32 s30, s30, s57
    buffer_load_dwordx4 v11, s[16:19], s30 offen  lds
    s_add_u32 s56, s56, 128
    s_and_b32 s56, s56, 8191
    s_add_u32 s57, s57, 131072
    s_and_b32 s57, s57, 8388607
    s_waitcnt vmcnt(24)
    s_barrier
    ds_read_b128 v[20:23], v12 offset:0
    ds_read_b128 v[24:27], v12 offset:4096
    ds_read_b64_tr_b16 v[28:29], v16 offset:0
    ds_read_b64_tr_b16 v[30:31], v16 offset:512
    ds_read_b64_tr_b16 v[32:33], v17 offset:0
    ds_read_b64_tr_b16 v[34:35], v17 offset:512
    s_waitcnt vmcnt(20)
    s_barrier
    s_add_u32 s35, s34, 114688
    s_mov_b32 m0, s35
    s_add_u32 s30, s27, 0
    s_add_u32 s30, s30, s56
    buffer_load_dwordx4 v10, s[12:15], s30 offen  lds
    s_add_u32 s35, s34, 118784
    s_mov_b32 m0, s35
    s_add_u32 s30, s27, 262144
    s_add_u32 s30, s30, s56
    buffer_load_dwordx4 v10, s[12:15], s30 offen  lds
    s_add_u32 s35, s34, 122880
    s_mov_b32 m0, s35
    s_add_u32 s30, s28, 0
    s_add_u32 s30, s30, s57
    buffer_load_dwordx4 v11, s[16:19], s30 offen  lds
    s_add_u32 s35, s34, 126976
    s_mov_b32 m0, s35
    s_add_u32 s30, s28, 65536
    s_add_u32 s30, s30, s57
    buffer_load_dwordx4 v11, s[16:19], s30 offen  lds
    s_add_u32 s56, s56, 128
    s_and_b32 s56, s56, 8191
    s_add_u32 s57, s57, 131072
    s_and_b32 s57, s57, 8388607
    ds_read_b128 v[36:39], v12 offset:16384
    ds_read_b128 v[40:43], v12 offset:20480
    ds_read_b64_tr_b16 v[44:45], v16 offset:16384
    ds_read_b64_tr_b16 v[46:47], v16 offset:16896
    ds_read_b64_tr_b16 v[48:49], v17 offset:16384
    ds_read_b64_tr_b16 v[50:51], v17 offset:16896
    s_waitcnt lgkmcnt(6)
    v_mfma_f32_32x32x16_bf16 v[64:79], v[28:31], v[20:23], v[64:79]
    v_mfma_f32_32x32x16_bf16 v[80:95], v[28:31], v[24:27], v[80:95]
    v_mfma_f32_32x32x16_bf16 v[96:111], v[32:35], v[20:23], v[96:111]
    v_mfma_f32_32x32x16_bf16 v[112:127], v[32:35], v[24:27], v[112:127]
    s_waitcnt vmcnt(20)
    s_barrier
    s_add_u32 s35, s34, 0
    s_mov_b32 m0, s35
    s_add_u32 s30, s27, 0
    s_add_u32 s30, s30, s56
    buffer_load_dwordx4 v10, s[12:15], s30 offen  lds
    s_add_u32 s35, s34, 4096
    s_mov_b32 m0, s35
    s_add_u32 s30, s27, 262144
    s_add_u32 s30, s30, s56
    buffer_load_dwordx4 v10, s[12:15], s30 offen  lds
    s_add_u32 s35, s34, 8192
    s_mov_b32 m0, s35
    s_add_u32 s30, s28, 0
    s_add_u32 s30, s30, s57
    buffer_load_dwordx4 v11, s[16:19], s30 offen  lds
    s_add_u32 s35, s34, 12288
    s_mov_b32 m0, s35
    s_add_u32 s30, s28, 65536
    s_add_u32 s30, s30, s57
    buffer_load_dwordx4 v11, s[16:19], s30 offen  lds
    s_add_u32 s56, s56, 128
    s_and_b32 s56, s56, 8191
    s_add_u32 s57, s57, 131072
    s_and_b32 s57, s57, 8388607
    ds_read_b128 v[20:23], v12 offset:32768
    ds_read_b128 v[24:27], v12 offset:36864
    ds_read_b64_tr_b16 v[28:29], v16 offset:32768
    ds_read_b64_tr_b16 v[30:31], v16 offset:33280
    ds_read_b64_tr_b16 v[32:33], v17 offset:32768
    ds_read_b64_tr_b16 v[34:35], v17 offset:33280
    s_waitcnt lgkmcnt(6)
    v_mfma_f32_32x32x16_bf16 v[64:79], v[44:47], v[36:39], v[64:79]
    v_mfma_f32_32x32x16_bf16 v[80:95], v[44:47], v[40:43], v[80:95]
    v_mfma_f32_32x32x16_bf16 v[96:111], v[48:51], v[36:39], v[96:111]
    v_mfma_f32_32x32x16_bf16 v[112:127], v[48:51], v[40:43], v[112:127]
    s_waitcnt vmcnt(20)
    s_barrier
    s_add_u32 s35, s34, 16384
    s_mov_b32 m0, s35
    s_add_u32 s30, s27, 0
    s_add_u32 s30, s30, s56
    buffer_load_dwordx4 v10, s[12:15], s30 offen  lds
    s_add_u32 s35, s34, 20480
    s_mov_b32 m0, s35
    s_add_u32 s30, s27, 262144
    s_add_u32 s30, s30, s56
    buffer_load_dwordx4 v10, s[12:15], s30 offen  lds
    s_add_u32 s35, s34, 24576
    s_mov_b32 m0, s35
    s_add_u32 s30, s28, 0
    s_add_u32 s30, s30, s57
    buffer_load_dwordx4 v11, s[16:19], s30 offen  lds
    s_add_u32 s35, s34, 28672
    s_mov_b32 m0, s35
    s_add_u32 s30, s28, 65536
    s_add_u32 s30, s30, s57
    buffer_load_dwordx4 v11, s[16:19], s30 offen  lds
    s_add_u32 s56, s56, 128
    s_and_b32 s56, s56, 8191
    s_add_u32 s57, s57, 131072
    s_and_b32 s57, s57, 8388607
    ds_read_b128 v[36:39], v12 offset:49152
    ds_read_b128 v[40:43], v12 offset:53248
    ds_read_b64_tr_b16 v[44:45], v16 offset:49152
    ds_read_b64_tr_b16 v[46:47], v16 offset:49664
    ds_read_b64_tr_b16 v[48:49], v17 offset:49152
    ds_read_b64_tr_b16 v[50:51], v17 offset:49664
    s_waitcnt lgkmcnt(6)
    v_mfma_f32_32x32x16_bf16 v[64:79], v[28:31], v[20:23], v[64:79]
    v_mfma_f32_32x32x16_bf16 v[80:95], v[28:31], v[24:27], v[80:95]
    v_mfma_f32_32x32x16_bf16 v[96:111], v[32:35], v[20:23], v[96:111]
    v_mfma_f32_32x32x16_bf16 v[112:127], v[32:35], v[24:27], v[112:127]
    s_waitcnt vmcnt(20)
    s_barrier
    s_add_u32 s35, s34, 32768
    s_mov_b32 m0, s35
    s_add_u32 s30, s27, 0
    s_add_u32 s30, s30, s56
    buffer_load_dwordx4 v10, s[12:15], s30 offen  lds
    s_add_u32 s35, s34, 36864
    s_mov_b32 m0, s35
    s_add_u32 s30, s27, 262144
    s_add_u32 s30, s30, s56
    buffer_load_dwordx4 v10, s[12:15], s30 offen  lds
    s_add_u32 s35, s34, 40960
    s_mov_b32 m0, s35
    s_add_u32 s30, s28, 0
    s_add_u32 s30, s30, s57
    buffer_load_dwordx4 v11, s[16:19], s30 offen  lds
    s_add_u32 s35, s34, 45056
    s_mov_b32 m0, s35
    s_add_u32 s30, s28, 65536
    s_add_u32 s30, s30, s57
    buffer_load_dwordx4 v11, s[16:19], s30 offen  lds
    s_add_u32 s56, s56, 128
    s_and_b32 s56, s56, 8191
    s_add_u32 s57, s57, 131072
    s_and_b32 s57, s57, 8388607
    v_add_u32 v52, 0x10000, v12
    ds_read_b128 v[20:23], v52 offset:0
    v_add_u32 v52, 0x10000, v12
    ds_read_b128 v[24:27], v52 offset:4096
    v_add_u32 v53, 0x10000, v16
    ds_read_b64_tr_b16 v[28:29], v53 offset:0
    v_add_u32 v53, 0x10000, v16
    ds_read_b64_tr_b16 v[30:31], v53 offset:512
    v_add_u32 v53, 0x10000, v17
    ds_read_b64_tr_b16 v[32:33], v53 offset:0
    v_add_u32 v53, 0x10000, v17
    ds_read_b64_tr_b16 v[34:35], v53 offset:512
    s_waitcnt lgkmcnt(6)
    v_mfma_f32_32x32x16_bf16 v[64:79], v[44:47], v[36:39], v[64:79]
    v_mfma_f32_32x32x16_bf16 v[80:95], v[44:47], v[40:43], v[80:95]
    v_mfma_f32_32x32x16_bf16 v[96:111], v[48:51], v[36:39], v[96:111]
    v_mfma_f32_32x32x16_bf16 v[112:127], v[48:51], v[40:43], v[112:127]
    s_waitcnt vmcnt(20)
    s_barrier
    s_add_u32 s35, s34, 49152
    s_mov_b32 m0, s35
    s_add_u32 s30, s27, 0
    s_add_u32 s30, s30, s56
    buffer_load_dwordx4 v10, s[12:15], s30 offen  lds
    s_add_u32 s35, s34, 53248
    s_mov_b32 m0, s35
    s_add_u32 s30, s27, 262144
    s_add_u32 s30, s30, s56
    buffer_load_dwordx4 v10, s[12:15], s30 offen  lds
    s_add_u32 s35, s34, 57344
    s_mov_b32 m0, s35
    s_add_u32 s30, s28, 0
    s_add_u32 s30, s30, s57
    buffer_load_dwordx4 v11, s[16:19], s30 offen  lds
    s_add_u32 s35, s34, 61440
    s_mov_b32 m0, s35
    s_add_u32 s30, s28, 65536
    s_add_u32 s30, s30, s57
    buffer_load_dwordx4 v11, s[16:19], s30 offen  lds
    s_add_u32 s56, s56, 128
    s_and_b32 s56, s56, 8191
    s_add_u32 s57, s57, 131072
    s_and_b32 s57, s57, 8388607
    v_add_u32 v52, 0x10000, v12
    ds_read_b128 v[36:39], v52 offset:16384
    v_add_u32 v52, 0x10000, v12
    ds_read_b128 v[40:43], v52 offset:20480
    v_add_u32 v53, 0x10000, v16
    ds_read_b64_tr_b16 v[44:45], v53 offset:16384
    v_add_u32 v53, 0x10000, v16
    ds_read_b64_tr_b16 v[46:47], v53 offset:16896
    v_add_u32 v53, 0x10000, v17
    ds_read_b64_tr_b16 v[48:49], v53 offset:16384
    v_add_u32 v53, 0x10000, v17
    ds_read_b64_tr_b16 v[50:51], v53 offset:16896
    s_waitcnt lgkmcnt(6)
    v_mfma_f32_32x32x16_bf16 v[64:79], v[28:31], v[20:23], v[64:79]
    v_mfma_f32_32x32x16_bf16 v[80:95], v[28:31], v[24:27], v[80:95]
    v_mfma_f32_32x32x16_bf16 v[96:111], v[32:35], v[20:23], v[96:111]
    v_mfma_f32_32x32x16_bf16 v[112:127], v[32:35], v[24:27], v[112:127]
    s_waitcnt vmcnt(20)
    s_barrier
    s_add_u32 s35, s34, 65536
    s_mov_b32 m0, s35
    s_add_u32 s30, s27, 0
    s_add_u32 s30, s30, s56
    buffer_load_dwordx4 v10, s[12:15], s30 offen  lds
    s_add_u32 s35, s34, 69632
    s_mov_b32 m0, s35
    s_add_u32 s30, s27, 262144
    s_add_u32 s30, s30, s56
    buffer_load_dwordx4 v10, s[12:15], s30 offen  lds
    s_add_u32 s35, s34, 73728
    s_mov_b32 m0, s35
    s_add_u32 s30, s28, 0
    s_add_u32 s30, s30, s57
    buffer_load_dwordx4 v11, s[16:19], s30 offen  lds
    s_add_u32 s35, s34, 77824
    s_mov_b32 m0, s35
    s_add_u32 s30, s28, 65536
    s_add_u32 s30, s30, s57
    buffer_load_dwordx4 v11, s[16:19], s30 offen  lds
    s_add_u32 s56, s56, 128
    s_and_b32 s56, s56, 8191
    s_add_u32 s57, s57, 131072
    s_and_b32 s57, s57, 8388607
    v_add_u32 v52, 0x10000, v12
    ds_read_b128 v[20:23], v52 offset:32768
    v_add_u32 v52, 0x10000, v12
    ds_read_b128 v[24:27], v52 offset:36864
    v_add_u32 v53, 0x10000, v16
    ds_read_b64_tr_b16 v[28:29], v53 offset:32768
    v_add_u32 v53, 0x10000, v16
    ds_read_b64_tr_b16 v[30:31], v53 offset:33280
    v_add_u32 v53, 0x10000, v17
    ds_read_b64_tr_b16 v[32:33], v53 offset:32768
    v_add_u32 v53, 0x10000, v17
    ds_read_b64_tr_b16 v[34:35], v53 offset:33280
    s_waitcnt lgkmcnt(6)
    v_mfma_f32_32x32x16_bf16 v[64:79], v[44:47], v[36:39], v[64:79]
    v_mfma_f32_32x32x16_bf16 v[80:95], v[44:47], v[40:43], v[80:95]
    v_mfma_f32_32x32x16_bf16 v[96:111], v[48:51], v[36:39], v[96:111]
    v_mfma_f32_32x32x16_bf16 v[112:127], v[48:51], v[40:43], v[112:127]
    s_waitcnt vmcnt(20)
    s_barrier
    s_add_u32 s35, s34, 81920
    s_mov_b32 m0, s35
    s_add_u32 s30, s27, 0
    s_add_u32 s30, s30, s56
    buffer_load_dwordx4 v10, s[12:15], s30 offen  lds
    s_add_u32 s35, s34, 86016
    s_mov_b32 m0, s35
    s_add_u32 s30, s27, 262144
    s_add_u32 s30, s30, s56
    buffer_load_dwordx4 v10, s[12:15], s30 offen  lds
    s_add_u32 s35, s34, 90112
    s_mov_b32 m0, s35
    s_add_u32 s30, s28, 0
    s_add_u32 s30, s30, s57
    buffer_load_dwordx4 v11, s[16:19], s30 offen  lds
    s_add_u32 s35, s34, 94208
    s_mov_b32 m0, s35
    s_add_u32 s30, s28, 65536
    s_add_u32 s30, s30, s57
    buffer_load_dwordx4 v11, s[16:19], s30 offen  lds
    s_add_u32 s56, s56, 128
    s_and_b32 s56, s56, 8191
    s_add_u32 s57, s57, 131072
    s_and_b32 s57, s57, 8388607
    v_add_u32 v52, 0x10000, v12
    ds_read_b128 v[36:39], v52 offset:49152
    v_add_u32 v52, 0x10000, v12
    ds_read_b128 v[40:43], v52 offset:53248
    v_add_u32 v53, 0x10000, v16
    ds_read_b64_tr_b16 v[44:45], v53 offset:49152
    v_add_u32 v53, 0x10000, v16
    ds_read_b64_tr_b16 v[46:47], v53 offset:49664
    v_add_u32 v53, 0x10000, v17
    ds_read_b64_tr_b16 v[48:49], v53 offset:49152
    v_add_u32 v53, 0x10000, v17
    ds_read_b64_tr_b16 v[50:51], v53 offset:49664
    s_waitcnt lgkmcnt(6)
    v_mfma_f32_32x32x16_bf16 v[64:79], v[28:31], v[20:23], v[64:79]
    v_mfma_f32_32x32x16_bf16 v[80:95], v[28:31], v[24:27], v[80:95]
    v_mfma_f32_32x32x16_bf16 v[96:111], v[32:35], v[20:23], v[96:111]
    v_mfma_f32_32x32x16_bf16 v[112:127], v[32:35], v[24:27], v[112:127]
    s_waitcnt vmcnt(20)
    s_barrier
    s_add_u32 s35, s34, 98304
    s_mov_b32 m0, s35
    s_add_u32 s30, s27, 0
    s_add_u32 s30, s30, s56
    buffer_load_dwordx4 v10, s[12:15], s30 offen  lds
    s_add_u32 s35, s34, 102400
    s_mov_b32 m0, s35
    s_add_u32 s30, s27, 262144
    s_add_u32 s30, s30, s56
    buffer_load_dwordx4 v10, s[12:15], s30 offen  lds
    s_add_u32 s35, s34, 106496
    s_mov_b32 m0, s35
    s_add_u32 s30, s28, 0
    s_add_u32 s30, s30, s57
    buffer_load_dwordx4 v11, s[16:19], s30 offen  lds
    s_add_u32 s35, s34, 110592
    s_mov_b32 m0, s35
    s_add_u32 s30, s28, 65536
    s_add_u32 s30, s30, s57
    buffer_load_dwordx4 v11, s[16:19], s30 offen  lds
    s_add_u32 s56, s56, 128
    s_and_b32 s56, s56, 8191
    s_add_u32 s57, s57, 131072
    s_and_b32 s57, s57, 8388607
    ds_read_b128 v[20:23], v12 offset:0
    ds_read_b128 v[24:27], v12 offset:4096
    ds_read_b64_tr_b16 v[28:29], v16 offset:0
    ds_read_b64_tr_b16 v[30:31], v16 offset:512
    ds_read_b64_tr_b16 v[32:33], v17 offset:0
    ds_read_b64_tr_b16 v[34:35], v17 offset:512
    s_waitcnt lgkmcnt(6)
    v_mfma_f32_32x32x16_bf16 v[64:79], v[44:47], v[36:39], v[64:79]
    v_mfma_f32_32x32x16_bf16 v[80:95], v[44:47], v[40:43], v[80:95]
    v_mfma_f32_32x32x16_bf16 v[96:111], v[48:51], v[36:39], v[96:111]
    v_mfma_f32_32x32x16_bf16 v[112:127], v[48:51], v[40:43], v[112:127]
    s_mov_b32 s29, 6
L_gqa_oproj_kernel_loop:
    s_waitcnt vmcnt(20)
    s_barrier
    s_add_u32 s35, s34, 114688
    s_mov_b32 m0, s35
    s_add_u32 s30, s27, 0
    s_add_u32 s30, s30, s56
    buffer_load_dwordx4 v10, s[12:15], s30 offen  lds
    s_add_u32 s35, s34, 118784
    s_mov_b32 m0, s35
    s_add_u32 s30, s27, 262144
    s_add_u32 s30, s30, s56
    buffer_load_dwordx4 v10, s[12:15], s30 offen  lds
    s_add_u32 s35, s34, 122880
    s_mov_b32 m0, s35
    s_add_u32 s30, s28, 0
    s_add_u32 s30, s30, s57
    buffer_load_dwordx4 v11, s[16:19], s30 offen  lds
    s_add_u32 s35, s34, 126976
    s_mov_b32 m0, s35
    s_add_u32 s30, s28, 65536
    s_add_u32 s30, s30, s57
    buffer_load_dwordx4 v11, s[16:19], s30 offen  lds
    s_add_u32 s56, s56, 128
    s_and_b32 s56, s56, 8191
    s_add_u32 s57, s57, 131072
    s_and_b32 s57, s57, 8388607
    ds_read_b128 v[36:39], v12 offset:16384
    ds_read_b128 v[40:43], v12 offset:20480
    ds_read_b64_tr_b16 v[44:45], v16 offset:16384
    ds_read_b64_tr_b16 v[46:47], v16 offset:16896
    ds_read_b64_tr_b16 v[48:49], v17 offset:16384
    ds_read_b64_tr_b16 v[50:51], v17 offset:16896
    s_waitcnt lgkmcnt(6)
    v_mfma_f32_32x32x16_bf16 v[64:79], v[28:31], v[20:23], v[64:79]
    v_mfma_f32_32x32x16_bf16 v[80:95], v[28:31], v[24:27], v[80:95]
    v_mfma_f32_32x32x16_bf16 v[96:111], v[32:35], v[20:23], v[96:111]
    v_mfma_f32_32x32x16_bf16 v[112:127], v[32:35], v[24:27], v[112:127]
    s_waitcnt vmcnt(20)
    s_barrier
    s_add_u32 s35, s34, 0
    s_mov_b32 m0, s35
    s_add_u32 s30, s27, 0
    s_add_u32 s30, s30, s56
    buffer_load_dwordx4 v10, s[12:15], s30 offen  lds
    s_add_u32 s35, s34, 4096
    s_mov_b32 m0, s35
    s_add_u32 s30, s27, 262144
    s_add_u32 s30, s30, s56
    buffer_load_dwordx4 v10, s[12:15], s30 offen  lds
    s_add_u32 s35, s34, 8192
    s_mov_b32 m0, s35
    s_add_u32 s30, s28, 0
    s_add_u32 s30, s30, s57
    buffer_load_dwordx4 v11, s[16:19], s30 offen  lds
    s_add_u32 s35, s34, 12288
    s_mov_b32 m0, s35
    s_add_u32 s30, s28, 65536
    s_add_u32 s30, s30, s57
    buffer_load_dwordx4 v11, s[16:19], s30 offen  lds
    s_add_u32 s56, s56, 128
    s_and_b32 s56, s56, 8191
    s_add_u32 s57, s57, 131072
    s_and_b32 s57, s57, 8388607
    ds_read_b128 v[20:23], v12 offset:32768
    ds_read_b128 v[24:27], v12 offset:36864
    ds_read_b64_tr_b16 v[28:29], v16 offset:32768
    ds_read_b64_tr_b16 v[30:31], v16 offset:33280
    ds_read_b64_tr_b16 v[32:33], v17 offset:32768
    ds_read_b64_tr_b16 v[34:35], v17 offset:33280
    s_waitcnt lgkmcnt(6)
    v_mfma_f32_32x32x16_bf16 v[64:79], v[44:47], v[36:39], v[64:79]
    v_mfma_f32_32x32x16_bf16 v[80:95], v[44:47], v[40:43], v[80:95]
    v_mfma_f32_32x32x16_bf16 v[96:111], v[48:51], v[36:39], v[96:111]
    v_mfma_f32_32x32x16_bf16 v[112:127], v[48:51], v[40:43], v[112:127]
    s_waitcnt vmcnt(20)
    s_barrier
    s_add_u32 s35, s34, 16384
    s_mov_b32 m0, s35
    s_add_u32 s30, s27, 0
    s_add_u32 s30, s30, s56
    buffer_load_dwordx4 v10, s[12:15], s30 offen  lds
    s_add_u32 s35, s34, 20480
    s_mov_b32 m0, s35
    s_add_u32 s30, s27, 262144
    s_add_u32 s30, s30, s56
    buffer_load_dwordx4 v10, s[12:15], s30 offen  lds
    s_add_u32 s35, s34, 24576
    s_mov_b32 m0, s35
    s_add_u32 s30, s28, 0
    s_add_u32 s30, s30, s57
    buffer_load_dwordx4 v11, s[16:19], s30 offen  lds
    s_add_u32 s35, s34, 28672
    s_mov_b32 m0, s35
    s_add_u32 s30, s28, 65536
    s_add_u32 s30, s30, s57
    buffer_load_dwordx4 v11, s[16:19], s30 offen  lds
    s_add_u32 s56, s56, 128
    s_and_b32 s56, s56, 8191
    s_add_u32 s57, s57, 131072
    s_and_b32 s57, s57, 8388607
    ds_read_b128 v[36:39], v12 offset:49152
    ds_read_b128 v[40:43], v12 offset:53248
    ds_read_b64_tr_b16 v[44:45], v16 offset:49152
    ds_read_b64_tr_b16 v[46:47], v16 offset:49664
    ds_read_b64_tr_b16 v[48:49], v17 offset:49152
    ds_read_b64_tr_b16 v[50:51], v17 offset:49664
    s_waitcnt lgkmcnt(6)
    v_mfma_f32_32x32x16_bf16 v[64:79], v[28:31], v[20:23], v[64:79]
    v_mfma_f32_32x32x16_bf16 v[80:95], v[28:31], v[24:27], v[80:95]
    v_mfma_f32_32x32x16_bf16 v[96:111], v[32:35], v[20:23], v[96:111]
    v_mfma_f32_32x32x16_bf16 v[112:127], v[32:35], v[24:27], v[112:127]
    s_waitcnt vmcnt(20)
    s_barrier
    s_add_u32 s35, s34, 32768
    s_mov_b32 m0, s35
    s_add_u32 s30, s27, 0
    s_add_u32 s30, s30, s56
    buffer_load_dwordx4 v10, s[12:15], s30 offen  lds
    s_add_u32 s35, s34, 36864
    s_mov_b32 m0, s35
    s_add_u32 s30, s27, 262144
    s_add_u32 s30, s30, s56
    buffer_load_dwordx4 v10, s[12:15], s30 offen  lds
    s_add_u32 s35, s34, 40960
    s_mov_b32 m0, s35
    s_add_u32 s30, s28, 0
    s_add_u32 s30, s30, s57
    buffer_load_dwordx4 v11, s[16:19], s30 offen  lds
    s_add_u32 s35, s34, 45056
    s_mov_b32 m0, s35
    s_add_u32 s30, s28, 65536
    s_add_u32 s30, s30, s57
    buffer_load_dwordx4 v11, s[16:19], s30 offen  lds
    s_add_u32 s56, s56, 128
    s_and_b32 s56, s56, 8191
    s_add_u32 s57, s57, 131072
    s_and_b32 s57, s57, 8388607
    v_add_u32 v52, 0x10000, v12
    ds_read_b128 v[20:23], v52 offset:0
    v_add_u32 v52, 0x10000, v12
    ds_read_b128 v[24:27], v52 offset:4096
    v_add_u32 v53, 0x10000, v16
    ds_read_b64_tr_b16 v[28:29], v53 offset:0
    v_add_u32 v53, 0x10000, v16
    ds_read_b64_tr_b16 v[30:31], v53 offset:512
    v_add_u32 v53, 0x10000, v17
    ds_read_b64_tr_b16 v[32:33], v53 offset:0
    v_add_u32 v53, 0x10000, v17
    ds_read_b64_tr_b16 v[34:35], v53 offset:512
    s_waitcnt lgkmcnt(6)
    v_mfma_f32_32x32x16_bf16 v[64:79], v[44:47], v[36:39], v[64:79]
    v_mfma_f32_32x32x16_bf16 v[80:95], v[44:47], v[40:43], v[80:95]
    v_mfma_f32_32x32x16_bf16 v[96:111], v[48:51], v[36:39], v[96:111]
    v_mfma_f32_32x32x16_bf16 v[112:127], v[48:51], v[40:43], v[112:127]
    s_waitcnt vmcnt(20)
    s_barrier
    s_add_u32 s35, s34, 49152
    s_mov_b32 m0, s35
    s_add_u32 s30, s27, 0
    s_add_u32 s30, s30, s56
    buffer_load_dwordx4 v10, s[12:15], s30 offen  lds
    s_add_u32 s35, s34, 53248
    s_mov_b32 m0, s35
    s_add_u32 s30, s27, 262144
    s_add_u32 s30, s30, s56
    buffer_load_dwordx4 v10, s[12:15], s30 offen  lds
    s_add_u32 s35, s34, 57344
    s_mov_b32 m0, s35
    s_add_u32 s30, s28, 0
    s_add_u32 s30, s30, s57
    buffer_load_dwordx4 v11, s[16:19], s30 offen  lds
    s_add_u32 s35, s34, 61440
    s_mov_b32 m0, s35
    s_add_u32 s30, s28, 65536
    s_add_u32 s30, s30, s57
    buffer_load_dwordx4 v11, s[16:19], s30 offen  lds
    s_add_u32 s56, s56, 128
    s_and_b32 s56, s56, 8191
    s_add_u32 s57, s57, 131072
    s_and_b32 s57, s57, 8388607
    v_add_u32 v52, 0x10000, v12
    ds_read_b128 v[36:39], v52 offset:16384
    v_add_u32 v52, 0x10000, v12
    ds_read_b128 v[40:43], v52 offset:20480
    v_add_u32 v53, 0x10000, v16
    ds_read_b64_tr_b16 v[44:45], v53 offset:16384
    v_add_u32 v53, 0x10000, v16
    ds_read_b64_tr_b16 v[46:47], v53 offset:16896
    v_add_u32 v53, 0x10000, v17
    ds_read_b64_tr_b16 v[48:49], v53 offset:16384
    v_add_u32 v53, 0x10000, v17
    ds_read_b64_tr_b16 v[50:51], v53 offset:16896
    s_waitcnt lgkmcnt(6)
    v_mfma_f32_32x32x16_bf16 v[64:79], v[28:31], v[20:23], v[64:79]
    v_mfma_f32_32x32x16_bf16 v[80:95], v[28:31], v[24:27], v[80:95]
    v_mfma_f32_32x32x16_bf16 v[96:111], v[32:35], v[20:23], v[96:111]
    v_mfma_f32_32x32x16_bf16 v[112:127], v[32:35], v[24:27], v[112:127]
    s_waitcnt vmcnt(20)
    s_barrier
    s_add_u32 s35, s34, 65536
    s_mov_b32 m0, s35
    s_add_u32 s30, s27, 0
    s_add_u32 s30, s30, s56
    buffer_load_dwordx4 v10, s[12:15], s30 offen  lds
    s_add_u32 s35, s34, 69632
    s_mov_b32 m0, s35
    s_add_u32 s30, s27, 262144
    s_add_u32 s30, s30, s56
    buffer_load_dwordx4 v10, s[12:15], s30 offen  lds
    s_add_u32 s35, s34, 73728
    s_mov_b32 m0, s35
    s_add_u32 s30, s28, 0
    s_add_u32 s30, s30, s57
    buffer_load_dwordx4 v11, s[16:19], s30 offen  lds
    s_add_u32 s35, s34, 77824
    s_mov_b32 m0, s35
    s_add_u32 s30, s28, 65536
    s_add_u32 s30, s30, s57
    buffer_load_dwordx4 v11, s[16:19], s30 offen  lds
    s_add_u32 s56, s56, 128
    s_and_b32 s56, s56, 8191
    s_add_u32 s57, s57, 131072
    s_and_b32 s57, s57, 8388607
    v_add_u32 v52, 0x10000, v12
    ds_read_b128 v[20:23], v52 offset:32768
    v_add_u32 v52, 0x10000, v12
    ds_read_b128 v[24:27], v52 offset:36864
    v_add_u32 v53, 0x10000, v16
    ds_read_b64_tr_b16 v[28:29], v53 offset:32768
    v_add_u32 v53, 0x10000, v16
    ds_read_b64_tr_b16 v[30:31], v53 offset:33280
    v_add_u32 v53, 0x10000, v17
    ds_read_b64_tr_b16 v[32:33], v53 offset:32768
    v_add_u32 v53, 0x10000, v17
    ds_read_b64_tr_b16 v[34:35], v53 offset:33280
    s_waitcnt lgkmcnt(6)
    v_mfma_f32_32x32x16_bf16 v[64:79], v[44:47], v[36:39], v[64:79]
    v_mfma_f32_32x32x16_bf16 v[80:95], v[44:47], v[40:43], v[80:95]
    v_mfma_f32_32x32x16_bf16 v[96:111], v[48:51], v[36:39], v[96:111]
    v_mfma_f32_32x32x16_bf16 v[112:127], v[48:51], v[40:43], v[112:127]
    s_waitcnt vmcnt(20)
    s_barrier
    s_add_u32 s35, s34, 81920
    s_mov_b32 m0, s35
    s_add_u32 s30, s27, 0
    s_add_u32 s30, s30, s56
    buffer_load_dwordx4 v10, s[12:15], s30 offen  lds
    s_add_u32 s35, s34, 86016
    s_mov_b32 m0, s35
    s_add_u32 s30, s27, 262144
    s_add_u32 s30, s30, s56
    buffer_load_dwordx4 v10, s[12:15], s30 offen  lds
    s_add_u32 s35, s34, 90112
    s_mov_b32 m0, s35
    s_add_u32 s30, s28, 0
    s_add_u32 s30, s30, s57
    buffer_load_dwordx4 v11, s[16:19], s30 offen  lds
    s_add_u32 s35, s34, 94208
    s_mov_b32 m0, s35
    s_add_u32 s30, s28, 65536
    s_add_u32 s30, s30, s57
    buffer_load_dwordx4 v11, s[16:19], s30 offen  lds
    s_add_u32 s56, s56, 128
    s_and_b32 s56, s56, 8191
    s_add_u32 s57, s57, 131072
    s_and_b32 s57, s57, 8388607
    v_add_u32 v52, 0x10000, v12
    ds_read_b128 v[36:39], v52 offset:49152
    v_add_u32 v52, 0x10000, v12
    ds_read_b128 v[40:43], v52 offset:53248
    v_add_u32 v53, 0x10000, v16
    ds_read_b64_tr_b16 v[44:45], v53 offset:49152
    v_add_u32 v53, 0x10000, v16
    ds_read_b64_tr_b16 v[46:47], v53 offset:49664
    v_add_u32 v53, 0x10000, v17
    ds_read_b64_tr_b16 v[48:49], v53 offset:49152
    v_add_u32 v53, 0x10000, v17
    ds_read_b64_tr_b16 v[50:51], v53 offset:49664
    s_waitcnt lgkmcnt(6)
    v_mfma_f32_32x32x16_bf16 v[64:79], v[28:31], v[20:23], v[64:79]
    v_mfma_f32_32x32x16_bf16 v[80:95], v[28:31], v[24:27], v[80:95]
    v_mfma_f32_32x32x16_bf16 v[96:111], v[32:35], v[20:23], v[96:111]
    v_mfma_f32_32x32x16_bf16 v[112:127], v[32:35], v[24:27], v[112:127]
    s_waitcnt vmcnt(20)
    s_barrier
    s_add_u32 s35, s34, 98304
    s_mov_b32 m0, s35
    s_add_u32 s30, s27, 0
    s_add_u32 s30, s30, s56
    buffer_load_dwordx4 v10, s[12:15], s30 offen  lds
    s_add_u32 s35, s34, 102400
    s_mov_b32 m0, s35
    s_add_u32 s30, s27, 262144
    s_add_u32 s30, s30, s56
    buffer_load_dwordx4 v10, s[12:15], s30 offen  lds
    s_add_u32 s35, s34, 106496
    s_mov_b32 m0, s35
    s_add_u32 s30, s28, 0
    s_add_u32 s30, s30, s57
    buffer_load_dwordx4 v11, s[16:19], s30 offen  lds
    s_add_u32 s35, s34, 110592
    s_mov_b32 m0, s35
    s_add_u32 s30, s28, 65536
    s_add_u32 s30, s30, s57
    buffer_load_dwordx4 v11, s[16:19], s30 offen  lds
    s_add_u32 s56, s56, 128
    s_and_b32 s56, s56, 8191
    s_add_u32 s57, s57, 131072
    s_and_b32 s57, s57, 8388607
    ds_read_b128 v[20:23], v12 offset:0
    ds_read_b128 v[24:27], v12 offset:4096
    ds_read_b64_tr_b16 v[28:29], v16 offset:0
    ds_read_b64_tr_b16 v[30:31], v16 offset:512
    ds_read_b64_tr_b16 v[32:33], v17 offset:0
    ds_read_b64_tr_b16 v[34:35], v17 offset:512
    s_waitcnt lgkmcnt(6)
    v_mfma_f32_32x32x16_bf16 v[64:79], v[44:47], v[36:39], v[64:79]
    v_mfma_f32_32x32x16_bf16 v[80:95], v[44:47], v[40:43], v[80:95]
    v_mfma_f32_32x32x16_bf16 v[96:111], v[48:51], v[36:39], v[96:111]
    v_mfma_f32_32x32x16_bf16 v[112:127], v[48:51], v[40:43], v[112:127]
    s_sub_u32 s29, s29, 1
    s_cmp_lg_u32 s29, 0
    s_cbranch_scc1 L_gqa_oproj_kernel_loop
    s_waitcnt vmcnt(20)
    s_barrier
    s_add_u32 s35, s34, 114688
    s_mov_b32 m0, s35
    s_add_u32 s30, s27, 0
    s_add_u32 s30, s30, s56
    buffer_load_dwordx4 v10, s[12:15], s30 offen  lds
    s_add_u32 s35, s34, 118784
    s_mov_b32 m0, s35
    s_add_u32 s30, s27, 262144
    s_add_u32 s30, s30, s56
    buffer_load_dwordx4 v10, s[12:15], s30 offen  lds
    s_add_u32 s35, s34, 122880
    s_mov_b32 m0, s35
    s_add_u32 s30, s28, 0
    s_add_u32 s30, s30, s57
    buffer_load_dwordx4 v11, s[16:19], s30 offen  lds
    s_add_u32 s35, s34, 126976
    s_mov_b32 m0, s35
    s_add_u32 s30, s28, 65536
    s_add_u32 s30, s30, s57
    buffer_load_dwordx4 v11, s[16:19], s30 offen  lds
    s_add_u32 s56, s56, 128
    s_and_b32 s56, s56, 8191
    s_add_u32 s57, s57, 131072
    s_and_b32 s57, s57, 8388607
    ds_read_b128 v[36:39], v12 offset:16384
    ds_read_b128 v[40:43], v12 offset:20480
    ds_read_b64_tr_b16 v[44:45], v16 offset:16384
    ds_read_b64_tr_b16 v[46:47], v16 offset:16896
    ds_read_b64_tr_b16 v[48:49], v17 offset:16384
    ds_read_b64_tr_b16 v[50:51], v17 offset:16896
    s_waitcnt lgkmcnt(6)
    v_mfma_f32_32x32x16_bf16 v[64:79], v[28:31], v[20:23], v[64:79]
    v_mfma_f32_32x32x16_bf16 v[80:95], v[28:31], v[24:27], v[80:95]
    v_mfma_f32_32x32x16_bf16 v[96:111], v[32:35], v[20:23], v[96:111]
    v_mfma_f32_32x32x16_bf16 v[112:127], v[32:35], v[24:27], v[112:127]
    s_waitcnt vmcnt(20)
    s_barrier
    ds_read_b128 v[20:23], v12 offset:32768
    ds_read_b128 v[24:27], v12 offset:36864
    ds_read_b64_tr_b16 v[28:29], v16 offset:32768
    ds_read_b64_tr_b16 v[30:31], v16 offset:33280
    ds_read_b64_tr_b16 v[32:33], v17 offset:32768
    ds_read_b64_tr_b16 v[34:35], v17 offset:33280
    s_waitcnt lgkmcnt(6)
    v_mfma_f32_32x32x16_bf16 v[64:79], v[44:47], v[36:39], v[64:79]
    v_mfma_f32_32x32x16_bf16 v[80:95], v[44:47], v[40:43], v[80:95]
    v_mfma_f32_32x32x16_bf16 v[96:111], v[48:51], v[36:39], v[96:111]
    v_mfma_f32_32x32x16_bf16 v[112:127], v[48:51], v[40:43], v[112:127]
    s_waitcnt vmcnt(16)
    s_barrier
    ds_read_b128 v[36:39], v12 offset:49152
    ds_read_b128 v[40:43], v12 offset:53248
    ds_read_b64_tr_b16 v[44:45], v16 offset:49152
    ds_read_b64_tr_b16 v[46:47], v16 offset:49664
    ds_read_b64_tr_b16 v[48:49], v17 offset:49152
    ds_read_b64_tr_b16 v[50:51], v17 offset:49664
    s_waitcnt lgkmcnt(6)
    v_mfma_f32_32x32x16_bf16 v[64:79], v[28:31], v[20:23], v[64:79]
    v_mfma_f32_32x32x16_bf16 v[80:95], v[28:31], v[24:27], v[80:95]
    v_mfma_f32_32x32x16_bf16 v[96:111], v[32:35], v[20:23], v[96:111]
    v_mfma_f32_32x32x16_bf16 v[112:127], v[32:35], v[24:27], v[112:127]
    s_waitcnt vmcnt(12)
    s_barrier
    v_add_u32 v52, 0x10000, v12
    ds_read_b128 v[20:23], v52 offset:0
    v_add_u32 v52, 0x10000, v12
    ds_read_b128 v[24:27], v52 offset:4096
    v_add_u32 v53, 0x10000, v16
    ds_read_b64_tr_b16 v[28:29], v53 offset:0
    v_add_u32 v53, 0x10000, v16
    ds_read_b64_tr_b16 v[30:31], v53 offset:512
    v_add_u32 v53, 0x10000, v17
    ds_read_b64_tr_b16 v[32:33], v53 offset:0
    v_add_u32 v53, 0x10000, v17
    ds_read_b64_tr_b16 v[34:35], v53 offset:512
    s_waitcnt lgkmcnt(6)
    v_mfma_f32_32x32x16_bf16 v[64:79], v[44:47], v[36:39], v[64:79]
    v_mfma_f32_32x32x16_bf16 v[80:95], v[44:47], v[40:43], v[80:95]
    v_mfma_f32_32x32x16_bf16 v[96:111], v[48:51], v[36:39], v[96:111]
    v_mfma_f32_32x32x16_bf16 v[112:127], v[48:51], v[40:43], v[112:127]
    s_waitcnt vmcnt(8)
    s_barrier
    v_add_u32 v52, 0x10000, v12
    ds_read_b128 v[36:39], v52 offset:16384
    v_add_u32 v52, 0x10000, v12
    ds_read_b128 v[40:43], v52 offset:20480
    v_add_u32 v53, 0x10000, v16
    ds_read_b64_tr_b16 v[44:45], v53 offset:16384
    v_add_u32 v53, 0x10000, v16
    ds_read_b64_tr_b16 v[46:47], v53 offset:16896
    v_add_u32 v53, 0x10000, v17
    ds_read_b64_tr_b16 v[48:49], v53 offset:16384
    v_add_u32 v53, 0x10000, v17
    ds_read_b64_tr_b16 v[50:51], v53 offset:16896
    s_waitcnt lgkmcnt(6)
    v_mfma_f32_32x32x16_bf16 v[64:79], v[28:31], v[20:23], v[64:79]
    v_mfma_f32_32x32x16_bf16 v[80:95], v[28:31], v[24:27], v[80:95]
    v_mfma_f32_32x32x16_bf16 v[96:111], v[32:35], v[20:23], v[96:111]
    v_mfma_f32_32x32x16_bf16 v[112:127], v[32:35], v[24:27], v[112:127]
    s_waitcnt vmcnt(4)
    s_barrier
    v_add_u32 v52, 0x10000, v12
    ds_read_b128 v[20:23], v52 offset:32768
    v_add_u32 v52, 0x10000, v12
    ds_read_b128 v[24:27], v52 offset:36864
    v_add_u32 v53, 0x10000, v16
    ds_read_b64_tr_b16 v[28:29], v53 offset:32768
    v_add_u32 v53, 0x10000, v16
    ds_read_b64_tr_b16 v[30:31], v53 offset:33280
    v_add_u32 v53, 0x10000, v17
    ds_read_b64_tr_b16 v[32:33], v53 offset:32768
    v_add_u32 v53, 0x10000, v17
    ds_read_b64_tr_b16 v[34:35], v53 offset:33280
    s_waitcnt lgkmcnt(6)
    v_mfma_f32_32x32x16_bf16 v[64:79], v[44:47], v[36:39], v[64:79]
    v_mfma_f32_32x32x16_bf16 v[80:95], v[44:47], v[40:43], v[80:95]
    v_mfma_f32_32x32x16_bf16 v[96:111], v[48:51], v[36:39], v[96:111]
    v_mfma_f32_32x32x16_bf16 v[112:127], v[48:51], v[40:43], v[112:127]
    s_waitcnt vmcnt(0)
    s_barrier
    v_add_u32 v52, 0x10000, v12
    ds_read_b128 v[36:39], v52 offset:49152
    v_add_u32 v52, 0x10000, v12
    ds_read_b128 v[40:43], v52 offset:53248
    v_add_u32 v53, 0x10000, v16
    ds_read_b64_tr_b16 v[44:45], v53 offset:49152
    v_add_u32 v53, 0x10000, v16
    ds_read_b64_tr_b16 v[46:47], v53 offset:49664
    v_add_u32 v53, 0x10000, v17
    ds_read_b64_tr_b16 v[48:49], v53 offset:49152
    v_add_u32 v53, 0x10000, v17
    ds_read_b64_tr_b16 v[50:51], v53 offset:49664
    s_waitcnt lgkmcnt(6)
    v_mfma_f32_32x32x16_bf16 v[64:79], v[28:31], v[20:23], v[64:79]
    v_mfma_f32_32x32x16_bf16 v[80:95], v[28:31], v[24:27], v[80:95]
    v_mfma_f32_32x32x16_bf16 v[96:111], v[32:35], v[20:23], v[96:111]
    v_mfma_f32_32x32x16_bf16 v[112:127], v[32:35], v[24:27], v[112:127]
    s_waitcnt lgkmcnt(0)
    v_mfma_f32_32x32x16_bf16 v[64:79], v[44:47], v[36:39], v[64:79]
    v_mfma_f32_32x32x16_bf16 v[80:95], v[44:47], v[40:43], v[80:95]
    v_mfma_f32_32x32x16_bf16 v[96:111], v[48:51], v[36:39], v[96:111]
    v_mfma_f32_32x32x16_bf16 v[112:127], v[48:51], v[40:43], v[112:127]
    s_nop 15
    s_nop 3
    s_barrier
    v_lshlrev_b32 v2, 4, v1
    s_mul_i32 s30, s24, 16384
    v_add_u32 v2, s30, v2
    ds_write_b128 v2, v[64:67] offset:0
    ds_write_b128 v2, v[68:71] offset:1024
    ds_write_b128 v2, v[72:75] offset:2048
    ds_write_b128 v2, v[76:79] offset:3072
    ds_write_b128 v2, v[80:83] offset:4096
    ds_write_b128 v2, v[84:87] offset:5120
    ds_write_b128 v2, v[88:91] offset:6144
    ds_write_b128 v2, v[92:95] offset:7168
    ds_write_b128 v2, v[96:99] offset:8192
    ds_write_b128 v2, v[100:103] offset:9216
    ds_write_b128 v2, v[104:107] offset:10240
    ds_write_b128 v2, v[108:111] offset:11264
    ds_write_b128 v2, v[112:115] offset:12288
    ds_write_b128 v2, v[116:119] offset:13312
    ds_write_b128 v2, v[120:123] offset:14336
    ds_write_b128 v2, v[124:127] offset:15360
    s_waitcnt lgkmcnt(0)
    s_barrier
    v_lshlrev_b32 v2, 4, v1
    s_lshl_b32 s30, s24, 12
    v_add_u32 v2, s30, v2
    ds_read_b128 v[20:23], v2 offset:0
    ds_read_b128 v[24:27], v2 offset:1024
    ds_read_b128 v[28:31], v2 offset:2048
    ds_read_b128 v[32:35], v2 offset:3072
    ds_read_b128 v[36:39], v2 offset:16384
    ds_read_b128 v[40:43], v2 offset:17408
    ds_read_b128 v[44:47], v2 offset:18432
    ds_read_b128 v[48:51], v2 offset:19456
    ds_read_b128 v[52:55], v2 offset:32768
    ds_read_b128 v[56:59], v2 offset:33792
    ds_read_b128 v[60:63], v2 offset:34816
    ds_read_b128 v[64:67], v2 offset:35840
    ds_read_b128 v[68:71], v2 offset:49152
    ds_read_b128 v[72:75], v2 offset:50176
    ds_read_b128 v[76:79], v2 offset:51200
    ds_read_b128 v[80:83], v2 offset:52224
    s_waitcnt lgkmcnt(0)
    v_add_f32 v84, v20, v36
    v_add_f32 v100, v52, v68
    v_add_f32 v85, v21, v37
    v_add_f32 v101, v53, v69
    v_add_f32 v86, v22, v38
    v_add_f32 v102, v54, v70
    v_add_f32 v87, v23, v39
    v_add_f32 v103, v55, v71
    v_add_f32 v88, v24, v40
    v_add_f32 v104, v56, v72
    v_add_f32 v89, v25, v41
    v_add_f32 v105, v57, v73
    v_add_f32 v90, v26, v42
    v_add_f32 v106, v58, v74
    v_add_f32 v91, v27, v43
    v_add_f32 v107, v59, v75
    v_add_f32 v92, v28, v44
    v_add_f32 v108, v60, v76
    v_add_f32 v93, v29, v45
    v_add_f32 v109, v61, v77
    v_add_f32 v94, v30, v46
    v_add_f32 v110, v62, v78
    v_add_f32 v95, v31, v47
    v_add_f32 v111, v63, v79
    v_add_f32 v96, v32, v48
    v_add_f32 v112, v64, v80
    v_add_f32 v97, v33, v49
    v_add_f32 v113, v65, v81
    v_add_f32 v98, v34, v50
    v_add_f32 v114, v66, v82
    v_add_f32 v99, v35, v51
    v_add_f32 v115, v67, v83
    v_add_f32 v84, v84, v100
    v_add_f32 v85, v85, v101
    v_add_f32 v86, v86, v102
    v_add_f32 v87, v87, v103
    v_add_f32 v88, v88, v104
    v_add_f32 v89, v89, v105
    v_add_f32 v90, v90, v106
    v_add_f32 v91, v91, v107
    v_add_f32 v92, v92, v108
    v_add_f32 v93, v93, v109
    v_add_f32 v94, v94, v110
    v_add_f32 v95, v95, v111
    v_add_f32 v96, v96, v112
    v_add_f32 v97, v97, v113
    v_add_f32 v98, v98, v114
    v_add_f32 v99, v99, v115
    s_and_b32 s30, s24, 1
    s_lshl_b32 s30, s30, 5
    s_add_u32 s30, s30, s25
    s_mul_i32 s30, s30, 2048
    s_lshr_b32 s31, s24, 1
    s_lshl_b32 s31, s31, 5
    s_add_u32 s31, s31, s26
    s_lshl_b32 s31, s31, 1
    s_add_u32 s30, s30, s31
    v_cvt_pk_bf16_f32 v52, v84, v85
    v_cvt_pk_bf16_f32 v53, v86, v87
    v_cvt_pk_bf16_f32 v54, v88, v89
    v_cvt_pk_bf16_f32 v55, v90, v91
    s_nop 1
    v_permlane32_swap_b32 v52, v54
    v_permlane32_swap_b32 v53, v55
    s_nop 0
    buffer_store_dwordx4 v[52:55], v18, s[20:23], s30 offen offset:0
    s_nop 1
    v_cvt_pk_bf16_f32 v52, v92, v93
    v_cvt_pk_bf16_f32 v53, v94, v95
    v_cvt_pk_bf16_f32 v54, v96, v97
    v_cvt_pk_bf16_f32 v55, v98, v99
    s_nop 1
    v_permlane32_swap_b32 v52, v54
    v_permlane32_swap_b32 v53, v55
    s_nop 0
    buffer_store_dwordx4 v[52:55], v18, s[20:23], s30 offen offset:32
    s_nop 1
L_gqa_oproj_kernel_end:
    s_endpgm
.section .rodata,"a"
.p2align 6

.amdhsa_kernel gqa_attn_kernel
  .amdhsa_next_free_vgpr 256
  .amdhsa_next_free_sgpr 102
  .amdhsa_accum_offset 256
  .amdhsa_group_segment_fixed_size 0
  .amdhsa_kernarg_size 64
  .amdhsa_user_sgpr_count 2
  .amdhsa_user_sgpr_kernarg_segment_ptr 1
  .amdhsa_system_sgpr_workgroup_id_x 1
.end_amdhsa_kernel

.amdhsa_kernel gqa_oproj_kernel
  .amdhsa_next_free_vgpr 128
  .amdhsa_next_free_sgpr 102
  .amdhsa_accum_offset 128
  .amdhsa_group_segment_fixed_size 0
  .amdhsa_kernarg_size 64
  .amdhsa_user_sgpr_count 2
  .amdhsa_user_sgpr_kernarg_segment_ptr 1
  .amdhsa_system_sgpr_workgroup_id_x 1
.end_amdhsa_kernel
```
